```python
import torch

def _softmax(x, axis=-1):
    return torch.softmax(x, dim=axis)
def _gelu(x):
    return torch.nn.functional.gelu(x, approximate="tanh")
def _silu(x):
    return torch.nn.functional.silu(x)
def _sigmoid(x):
    return torch.sigmoid(x)
def _layernorm(x, axis=-1, eps=1e-5):
    m = x.mean(dim=axis, keepdim=True)
    v = x.var(dim=axis, keepdim=True, unbiased=False)
    return (x - m) / torch.sqrt(v + eps)
def _scatter_add(tgt, idx, src, axis=0):
    return tgt.clone().index_add_(axis, idx, src)
def _segment_sum(src, seg, n):
    out = torch.zeros((n,) + src.shape[1:], dtype=src.dtype)
    return out.index_add_(0, seg, src)
def _pad(x, pw):
    flat = tuple(v for pair in reversed(pw) for v in pair)
    return torch.nn.functional.pad(x, flat)

kernel_name = 'parallel_sum__sliding_local_dilated__glu_gated_geglu__prompt'

def setup_inputs():

    _w = (lambda a: (lambda t: t.to(torch.bfloat16) if t.is_floating_point() else t)(torch.as_tensor(a)))
    def _A_setup():
        B, S, D = 1, 2048, 640
        return {
            "x": _w((lambda *s: torch.randn(*s, dtype=torch.bfloat16) * 0.05)(B, S, D)),
            "wqkv": _w((lambda *s: torch.randn(*s, dtype=torch.bfloat16) * 0.05)(D, 3 * D)),
            "wo": _w((lambda *s: torch.randn(*s, dtype=torch.bfloat16) * 0.05)(D, D)),
        }
    _A_in = _A_setup()

    def _B_setup():
        B, S, Dm, Df = 1, 2048, 640, 1728
        return {
            "x": _w((lambda *s: torch.randn(*s, dtype=torch.bfloat16) * 0.05)(B, S, Dm)),
            "w_gate": _w((lambda *s: torch.randn(*s, dtype=torch.bfloat16) * 0.8)(Dm, Df) * (Dm ** -0.5)),
            "w_up": _w((lambda *s: torch.randn(*s, dtype=torch.bfloat16) * 0.8)(Dm, Df) * (Dm ** -0.5)),
            "w_down": _w((lambda *s: torch.randn(*s, dtype=torch.bfloat16) * 0.8)(Df, Dm) * (Df ** -0.5)),
        }
    _B_in = _B_setup()

    return {
        "A_x": _A_in["x"],
        "A_wqkv": _A_in["wqkv"],
        "A_wo": _A_in["wo"],
        "B_x": _B_in["x"],
        "B_w_gate": _B_in["w_gate"],
        "B_w_up": _B_in["w_up"],
        "B_w_down": _B_in["w_down"],
    }

def reference(A_x, A_wqkv, A_wo, B_x, B_w_gate, B_w_up, B_w_down):
    def _A_ref(x, wqkv, wo):
        B, S, D = x.shape
        H = 32; Dh = D // H
        W, dil = 8, 2
        qkv = (lambda x, *d: x.permute(*d))((x @ wqkv).reshape(B, S, 3, H, Dh), 2, 0, 3, 1, 4)
        q, k, v = qkv[0], qkv[1], qkv[2]
        scale = Dh ** -0.5
        pos = torch.arange(S)
        off = torch.arange(W) * dil
        idx = pos[:, None] - off[None, :]
        mask = idx >= 0
        idx_c = torch.where(mask, idx, 0).reshape(-1)
        kg = k[:, :, idx_c, :].reshape(B, H, S, W, Dh)
        vg = v[:, :, idx_c, :].reshape(B, H, S, W, Dh)
        logits = torch.einsum("bhsd,bhswd->bhsw", q, kg) * scale
        logits = torch.where(mask[None, None, :, :], logits, -1e9)
        attn = _softmax(logits, axis=-1)
        o = torch.einsum("bhsw,bhswd->bhsd", attn, vg)
        return (lambda x, *d: x.permute(*d))(o, 0, 2, 1, 3).reshape(B, S, D) @ wo

    def _B_ref(x, w_gate, w_up, w_down):
        g = torch.einsum("bsd,df->bsf", x, w_gate)
        u = torch.einsum("bsd,df->bsf", x, w_up)
        h = _gelu(g) * u
        return torch.einsum("bsf,fd->bsd", h, w_down)

    x = A_x
    xn = _layernorm(x, axis=-1)
    return x + _A_ref(xn, A_wqkv, A_wo) + _B_ref(xn, B_w_gate, B_w_up, B_w_down)
```

```asm
; @launch kernel=k1_kernel grid=(256,1,1) block=(512,1,1) lds=163840
; @launch kernel=k2_kernel grid=(256,1,1) block=(256,1,1) lds=86016
.amdgcn_target "amdgcn-amd-amdhsa--gfx950"
.text
.globl k1_kernel
.p2align 8
.type k1_kernel,@function
k1_kernel:
  s_cmp_ge_u32 s2, 256
  s_cbranch_scc1 L1_exit
  s_load_dwordx4 s[4:7], s[0:1], 0
  s_load_dwordx4 s[8:11], s[0:1], 32
  s_load_dwordx2 s[12:13], s[0:1], 72
  v_and_b32 v1, 63, v0
  v_lshrrev_b32 v2, 6, v0
  s_nop 0
  v_readfirstlane_b32 s3, v2
  v_and_b32 v2, 15, v1
  v_lshrrev_b32 v3, 4, v1
  s_cmp_ge_u32 s2, 248
  s_cbranch_scc1 LP_start
  s_cmp_lt_u32 s2, 104
  s_cbranch_scc1 LQ_start
LG_start:
  s_and_b32 s32, s2, 7
  s_lshr_b32 s33, s2, 3
  s_sub_u32 s33, s33, 13
  s_and_b32 s34, s32, 1
  s_mul_i32 s34, s34, 18
  s_add_u32 s34, s34, s33
  s_lshr_b32 s35, s34, 2
  s_and_b32 s36, s34, 3
  s_lshr_b32 s37, s32, 1
  s_lshl_b32 s37, s37, 2
  s_add_u32 s37, s37, s36
  s_lshl_b32 s52, s37, 7
  s_mul_i32 s94, s37, 9
  s_add_u32 s94, s94, s35
  s_add_u32 s94, s94, 104
  s_mul_i32 s38, s35, 3
  s_add_u32 s38, s38, s36
  s_mul_i32 s53, s35, 384
  s_mov_b32 s32, s52
  s_mov_b32 s38, 0
  s_mul_i32 s39, s38, 6554
  s_lshr_b32 s39, s39, 16
  s_mul_i32 s39, s39, 10
  s_sub_u32 s38, s38, s39
  s_mov_b32 s33, s53
  s_mul_i32 s34, s38, 221184
  s_lshl_b32 s35, s38, 7
  s_lshr_b32 s43, s3, 2
  s_and_b32 s44, s3, 3
  v_lshrrev_b32 v15, 3, v1
  s_mul_i32 s41, s3, 16
  v_add_u32 v16, s41, v15
  v_lshrrev_b32 v17, 1, v16
  v_xor_b32 v17, v17, v1
  v_and_b32 v17, 7, v17
  v_add_u32 v16, s32, v16
  v_max_i32 v16, 0, v16
  v_min_i32 v16, 2047, v16
  v_mul_u32_u24 v16, 1280, v16
  v_lshl_add_u32 v8, v17, 4, v16
  v_add_u32 v16, s41, v15
  v_add_u32 v16, 8, v16
  v_lshrrev_b32 v17, 1, v16
  v_xor_b32 v17, v17, v1
  v_and_b32 v17, 7, v17
  v_add_u32 v16, s32, v16
  v_max_i32 v16, 0, v16
  v_min_i32 v16, 2047, v16
  v_mul_u32_u24 v16, 1280, v16
  v_lshl_add_u32 v9, v17, 4, v16
  s_lshl_b32 s41, s44, 3
  v_add_u32 v15, 0, v1
  v_mul_u32_u24 v16, 2731, v15
  v_lshrrev_b32 v16, 16, v16
  v_mul_u32_u24 v17, 24, v16
  v_sub_u32 v15, v15, v17
  v_and_b32 v17, 6, v16
  v_xor_b32 v15, v15, v17
  v_add_u32 v16, s41, v16
  v_and_b32 v18, 19, v16
  v_lshrrev_b32 v19, 1, v16
  v_and_b32 v19, 4, v19
  v_or_b32 v18, v18, v19
  v_lshlrev_b32 v19, 1, v16
  v_and_b32 v19, 8, v19
  v_or_b32 v18, v18, v19
  v_mul_u32_u24 v18, 3456, v18
  v_lshl_add_u32 v18, v15, 4, v18
  v_add_u32 v4, s33, v18
  v_add_u32 v15, 64, v1
  v_mul_u32_u24 v16, 2731, v15
  v_lshrrev_b32 v16, 16, v16
  v_mul_u32_u24 v17, 24, v16
  v_sub_u32 v15, v15, v17
  v_and_b32 v17, 6, v16
  v_xor_b32 v15, v15, v17
  v_add_u32 v16, s41, v16
  v_and_b32 v18, 19, v16
  v_lshrrev_b32 v19, 1, v16
  v_and_b32 v19, 4, v19
  v_or_b32 v18, v18, v19
  v_lshlrev_b32 v19, 1, v16
  v_and_b32 v19, 8, v19
  v_or_b32 v18, v18, v19
  v_mul_u32_u24 v18, 3456, v18
  v_lshl_add_u32 v18, v15, 4, v18
  v_add_u32 v5, s33, v18
  v_add_u32 v15, 128, v1
  v_mul_u32_u24 v16, 2731, v15
  v_lshrrev_b32 v16, 16, v16
  v_mul_u32_u24 v17, 24, v16
  v_sub_u32 v15, v15, v17
  v_and_b32 v17, 6, v16
  v_xor_b32 v15, v15, v17
  v_add_u32 v16, s41, v16
  v_and_b32 v18, 19, v16
  v_lshrrev_b32 v19, 1, v16
  v_and_b32 v19, 4, v19
  v_or_b32 v18, v18, v19
  v_lshlrev_b32 v19, 1, v16
  v_and_b32 v19, 8, v19
  v_or_b32 v18, v18, v19
  v_mul_u32_u24 v18, 3456, v18
  v_lshl_add_u32 v18, v15, 4, v18
  v_add_u32 v6, s33, v18
  s_mul_i32 s37, s3, 3072
  s_mul_i32 s38, s3, 2048
  s_add_u32 s38, s38, 98304
  s_mov_b32 s39, 0
  s_mov_b32 s40, 0
  s_waitcnt lgkmcnt(0)
  s_mov_b32 s16, s4
  s_and_b32 s17, s5, 0xffff
  s_mov_b32 s18, 2621440
  s_mov_b32 s19, 0x20000
  s_cmp_eq_u32 s43, 0
  s_cselect_b32 s20, s8, s10
  s_cselect_b32 s21, s9, s11
  s_and_b32 s21, s21, 0xffff
  s_mov_b32 s22, 2211840
  s_mov_b32 s23, 0x20000
  s_add_u32 s42, s38, s40
  s_add_u32 m0, s42, 0
  s_nop 0
  buffer_load_dwordx4 v8, s[16:19], s35 offen lds
  s_add_u32 s42, s38, s40
  s_add_u32 m0, s42, 1024
  s_nop 0
  buffer_load_dwordx4 v9, s[16:19], s35 offen lds
  s_add_u32 s35, s35, 128
  s_cmp_ge_u32 s35, 1280
  s_cselect_b32 s35, 0, s35
  s_add_u32 s40, s40, 16384
  s_cmp_ge_u32 s40, 49152
  s_cselect_b32 s40, 0, s40
  s_add_u32 s41, s37, s39
  s_add_u32 m0, s41, 0
  s_nop 0
  buffer_load_dwordx4 v4, s[20:23], s34 offen lds
  s_add_u32 m0, s41, 1024
  s_nop 0
  buffer_load_dwordx4 v5, s[20:23], s34 offen lds
  s_add_u32 m0, s41, 2048
  s_nop 0
  buffer_load_dwordx4 v6, s[20:23], s34 offen lds
  s_add_u32 s34, s34, 110592
  s_cmp_ge_u32 s34, 2211840
  s_cselect_b32 s41, 2211840, 0
  s_sub_u32 s34, s34, s41
  s_add_u32 s39, s39, 24576
  s_cmp_ge_u32 s39, 98304
  s_cselect_b32 s39, 0, s39
  s_add_u32 s41, s37, s39
  s_add_u32 m0, s41, 0
  s_nop 0
  buffer_load_dwordx4 v4, s[20:23], s34 offen lds
  s_add_u32 m0, s41, 1024
  s_nop 0
  buffer_load_dwordx4 v5, s[20:23], s34 offen lds
  s_add_u32 m0, s41, 2048
  s_nop 0
  buffer_load_dwordx4 v6, s[20:23], s34 offen lds
  s_add_u32 s34, s34, 110592
  s_cmp_ge_u32 s34, 2211840
  s_cselect_b32 s41, 2211840, 0
  s_sub_u32 s34, s34, s41
  s_add_u32 s39, s39, 24576
  s_cmp_ge_u32 s39, 98304
  s_cselect_b32 s39, 0, s39
  s_lshl_b32 s58, s2, 3
  s_add_u32 s58, s58, s3
  v_lshlrev_b32 v116, 4, v1
  s_mov_b32 s27, 0x20000
  s_mov_b64 s[24:25], s[6:7]
  s_mov_b32 s26, 2457600
  s_mov_b32 s59, 480
  s_cmp_ge_u32 s58, 480
  s_cbranch_scc0 LG_pf
  s_sub_u32 s58, s58, 480
  s_mov_b64 s[24:25], s[8:9]
  s_mov_b32 s26, 2211840
  s_mov_b32 s59, 432
  s_cmp_ge_u32 s58, 432
  s_cbranch_scc0 LG_pf
  s_sub_u32 s58, s58, 432
  s_mov_b64 s[24:25], s[10:11]
  s_mov_b32 s26, 2211840
  s_mov_b32 s59, 432
  s_cmp_ge_u32 s58, 432
  s_cbranch_scc0 LG_pf
  s_sub_u32 s58, s58, 1072
  s_mov_b64 s[24:25], s[4:5]
  s_mov_b32 s26, 2621440
  s_mov_b32 s59, 640
LG_pf:
  s_and_b32 s25, s25, 0xffff
  s_lshl_b32 s58, s58, 10
  s_lshl_b32 s59, s59, 10
  s_add_u32 s58, s58, s59
  buffer_load_dwordx4 v[112:115], v116, s[24:27], s58 offen
  s_add_u32 s58, s58, s59
  buffer_load_dwordx4 v[112:115], v116, s[24:27], s58 offen
  s_mov_b32 s28, s12
  s_and_b32 s29, s13, 0xffff
  s_mov_b32 s30, 9699328
  s_mov_b32 s31, 0x20000
  v_bfe_u32 v15, v1, 2, 2
  v_and_b32 v16, 3, v1
  v_and_b32 v18, 1, v3
  v_lshl_add_u32 v17, v18, 2, v15
  v_lshrrev_b32 v18, 1, v3
  v_lshl_add_u32 v17, v18, 4, v17
  v_bfe_u32 v18, v17, 1, 2
  v_mul_u32_u24 v17, 384, v17
  v_lshl_add_u32 v17, v16, 3, v17
  s_mul_i32 s41, s44, 3
  s_and_b32 s42, s44, 1
  s_add_u32 s50, s41, s42
  s_lshl_b32 s42, s42, 1
  s_add_u32 s51, s41, 2
  s_sub_u32 s51, s51, s42
  s_add_u32 s41, s50, 1
  v_xor_b32 v19, s50, v18
  v_lshl_add_u32 v10, v19, 5, v17
  v_xor_b32 v19, s41, v18
  v_lshl_add_u32 v11, v19, 5, v17
  v_xor_b32 v19, s51, v18
  v_lshl_add_u32 v12, v19, 5, v17
  s_mul_i32 s41, s43, 8192
  s_add_u32 s41, s41, 98304
  v_lshrrev_b32 v15, 1, v2
  v_xor_b32 v15, v15, v3
  v_lshlrev_b32 v16, 7, v2
  v_add_u32 v16, s41, v16
  v_lshl_add_u32 v13, v15, 4, v16
  v_xor_b32 v14, 64, v13
  v_mov_b32 v20, 0x3f803f80
  v_mov_b32 v21, 0x3f803f80
  v_mov_b32 v22, 0x3f803f80
  v_mov_b32 v23, 0x3f803f80
  v_mov_b32 v128, 0
  v_mov_b32 v129, 0
  v_mov_b32 v130, 0
  v_mov_b32 v131, 0
  v_mov_b32 v132, 0
  v_mov_b32 v133, 0
  v_mov_b32 v134, 0
  v_mov_b32 v135, 0
  v_mov_b32 v136, 0
  v_mov_b32 v137, 0
  v_mov_b32 v138, 0
  v_mov_b32 v139, 0
  v_mov_b32 v140, 0
  v_mov_b32 v141, 0
  v_mov_b32 v142, 0
  v_mov_b32 v143, 0
  v_mov_b32 v144, 0
  v_mov_b32 v145, 0
  v_mov_b32 v146, 0
  v_mov_b32 v147, 0
  v_mov_b32 v148, 0
  v_mov_b32 v149, 0
  v_mov_b32 v150, 0
  v_mov_b32 v151, 0
  v_mov_b32 v152, 0
  v_mov_b32 v153, 0
  v_mov_b32 v154, 0
  v_mov_b32 v155, 0
  v_mov_b32 v156, 0
  v_mov_b32 v157, 0
  v_mov_b32 v158, 0
  v_mov_b32 v159, 0
  v_mov_b32 v160, 0
  v_mov_b32 v161, 0
  v_mov_b32 v162, 0
  v_mov_b32 v163, 0
  v_mov_b32 v164, 0
  v_mov_b32 v165, 0
  v_mov_b32 v166, 0
  v_mov_b32 v167, 0
  v_mov_b32 v168, 0
  v_mov_b32 v169, 0
  v_mov_b32 v170, 0
  v_mov_b32 v171, 0
  v_mov_b32 v172, 0
  v_mov_b32 v173, 0
  v_mov_b32 v174, 0
  v_mov_b32 v175, 0
  v_mov_b32 v176, 0
  v_mov_b32 v177, 0
  v_mov_b32 v178, 0
  v_mov_b32 v179, 0
  v_mov_b32 v180, 0
  v_mov_b32 v181, 0
  v_mov_b32 v182, 0
  v_mov_b32 v183, 0
  v_mov_b32 v184, 0
  v_mov_b32 v185, 0
  v_mov_b32 v186, 0
  v_mov_b32 v187, 0
  v_mov_b32 v188, 0
  v_mov_b32 v189, 0
  v_mov_b32 v190, 0
  v_mov_b32 v191, 0
  v_mov_b32 v192, 0
  v_mov_b32 v193, 0
  v_mov_b32 v194, 0
  v_mov_b32 v195, 0
  v_mov_b32 v196, 0
  v_mov_b32 v197, 0
  v_mov_b32 v198, 0
  v_mov_b32 v199, 0
  v_mov_b32 v200, 0
  v_mov_b32 v201, 0
  v_mov_b32 v202, 0
  v_mov_b32 v203, 0
  v_mov_b32 v204, 0
  v_mov_b32 v205, 0
  v_mov_b32 v206, 0
  v_mov_b32 v207, 0
  v_mov_b32 v208, 0
  v_mov_b32 v209, 0
  v_mov_b32 v210, 0
  v_mov_b32 v211, 0
  v_mov_b32 v212, 0
  v_mov_b32 v213, 0
  v_mov_b32 v214, 0
  v_mov_b32 v215, 0
  v_mov_b32 v216, 0
  v_mov_b32 v217, 0
  v_mov_b32 v218, 0
  v_mov_b32 v219, 0
  v_mov_b32 v220, 0
  v_mov_b32 v221, 0
  v_mov_b32 v222, 0
  v_mov_b32 v223, 0
  v_mov_b32 v224, 0
  v_mov_b32 v225, 0
  v_mov_b32 v226, 0
  v_mov_b32 v227, 0
  v_mov_b32 v228, 0
  v_mov_b32 v229, 0
  v_mov_b32 v230, 0
  v_mov_b32 v231, 0
  v_mov_b32 v232, 0
  v_mov_b32 v233, 0
  v_mov_b32 v234, 0
  v_mov_b32 v235, 0
  v_mov_b32 v236, 0
  v_mov_b32 v237, 0
  v_mov_b32 v238, 0
  v_mov_b32 v239, 0
  v_mov_b32 v240, 0
  v_mov_b32 v241, 0
  v_mov_b32 v242, 0
  v_mov_b32 v243, 0
  s_mov_b32 s54, 0
  s_mov_b32 s55, 0
  s_mov_b32 s56, 24576
  s_mov_b32 s57, 16384
  s_waitcnt vmcnt(5)
  s_barrier
  ds_read_b128 v[24:27], v13 offset:0
  ds_read_b128 v[28:31], v13 offset:2048
  ds_read_b128 v[32:35], v13 offset:4096
  ds_read_b128 v[36:39], v13 offset:6144
  ds_read_b64_tr_b16 v[56:57], v10 offset:0
  ds_read_b64_tr_b16 v[58:59], v10 offset:3072
  ds_read_b64_tr_b16 v[60:61], v11 offset:0
  ds_read_b64_tr_b16 v[62:63], v11 offset:3072
  ds_read_b64_tr_b16 v[64:65], v12 offset:0
  ds_read_b64_tr_b16 v[66:67], v12 offset:3072
  ds_read_b64_tr_b16 v[68:69], v10 offset:12288
  ds_read_b64_tr_b16 v[70:71], v10 offset:15360
  ds_read_b64_tr_b16 v[72:73], v11 offset:12288
  ds_read_b64_tr_b16 v[74:75], v11 offset:15360
  ds_read_b64_tr_b16 v[76:77], v12 offset:12288
  ds_read_b64_tr_b16 v[78:79], v12 offset:15360
  s_add_u32 s54, s54, 24576
  s_cmp_ge_u32 s54, 98304
  s_cselect_b32 s42, 4294893568, s56
  s_cselect_b32 s54, 0, s54
  v_add_u32 v10, s42, v10
  v_add_u32 v11, s42, v11
  v_add_u32 v12, s42, v12
  s_waitcnt vmcnt(2) lgkmcnt(0)
  s_barrier
  v_mfma_f32_16x16x32_bf16 v[200:203], v[56:59], v[36:39], v[200:203]
  ds_read_b128 v[40:43], v14 offset:0
  v_mfma_f32_16x16x32_bf16 v[176:179], v[56:59], v[32:35], v[176:179]
  ds_read_b128 v[44:47], v14 offset:2048
  s_add_u32 s42, s38, s40
  s_add_u32 m0, s42, 0
  s_nop 0
  buffer_load_dwordx4 v8, s[16:19], s35 offen lds
  v_mfma_f32_16x16x32_bf16 v[152:155], v[56:59], v[28:31], v[152:155]
  ds_read_b128 v[48:51], v14 offset:4096
  v_mfma_f32_16x16x32_bf16 v[128:131], v[56:59], v[24:27], v[128:131]
  ds_read_b128 v[52:55], v14 offset:6144
  s_add_u32 s42, s38, s40
  s_add_u32 m0, s42, 1024
  s_nop 0
  buffer_load_dwordx4 v9, s[16:19], s35 offen lds
  s_add_u32 s35, s35, 128
  s_cmp_ge_u32 s35, 1280
  s_cselect_b32 s35, 0, s35
  s_add_u32 s40, s40, 16384
  s_cmp_ge_u32 s40, 49152
  s_cselect_b32 s40, 0, s40
  v_mfma_f32_16x16x32_bf16 v[204:207], v[60:63], v[36:39], v[204:207]
  ds_read_b64_tr_b16 v[80:81], v10 offset:0
  v_mfma_f32_16x16x32_bf16 v[180:183], v[60:63], v[32:35], v[180:183]
  ds_read_b64_tr_b16 v[82:83], v10 offset:3072
  s_add_u32 s41, s37, s39
  s_add_u32 m0, s41, 0
  s_nop 0
  buffer_load_dwordx4 v4, s[20:23], s34 offen lds
  v_mfma_f32_16x16x32_bf16 v[156:159], v[60:63], v[28:31], v[156:159]
  ds_read_b64_tr_b16 v[84:85], v11 offset:0
  v_mfma_f32_16x16x32_bf16 v[132:135], v[60:63], v[24:27], v[132:135]
  ds_read_b64_tr_b16 v[86:87], v11 offset:3072
  s_add_u32 m0, s41, 1024
  s_nop 0
  buffer_load_dwordx4 v5, s[20:23], s34 offen lds
  v_mfma_f32_16x16x32_bf16 v[208:211], v[64:67], v[36:39], v[208:211]
  ds_read_b64_tr_b16 v[88:89], v12 offset:0
  v_mfma_f32_16x16x32_bf16 v[184:187], v[64:67], v[32:35], v[184:187]
  ds_read_b64_tr_b16 v[90:91], v12 offset:3072
  s_add_u32 m0, s41, 2048
  s_nop 0
  buffer_load_dwordx4 v6, s[20:23], s34 offen lds
  s_add_u32 s34, s34, 110592
  s_cmp_ge_u32 s34, 2211840
  s_cselect_b32 s41, 2211840, 0
  s_sub_u32 s34, s34, s41
  s_add_u32 s39, s39, 24576
  s_cmp_ge_u32 s39, 98304
  s_cselect_b32 s39, 0, s39
  v_mfma_f32_16x16x32_bf16 v[160:163], v[64:67], v[28:31], v[160:163]
  ds_read_b64_tr_b16 v[92:93], v10 offset:12288
  v_mfma_f32_16x16x32_bf16 v[136:139], v[64:67], v[24:27], v[136:139]
  ds_read_b64_tr_b16 v[94:95], v10 offset:15360
  s_cmp_eq_u32 s43, 0
  s_cbranch_scc0 LGv0_m1_h0
  v_dot2c_f32_bf16 v224, v56, v20
  v_dot2c_f32_bf16 v225, v60, v20
  v_dot2c_f32_bf16 v226, v64, v20
  v_dot2c_f32_bf16 v224, v57, v20
  v_dot2c_f32_bf16 v225, v61, v20
  v_dot2c_f32_bf16 v226, v65, v20
  v_dot2c_f32_bf16 v224, v58, v20
  v_dot2c_f32_bf16 v225, v62, v20
  v_dot2c_f32_bf16 v226, v66, v20
  v_dot2c_f32_bf16 v224, v59, v20
  v_dot2c_f32_bf16 v225, v63, v20
  v_dot2c_f32_bf16 v226, v67, v20
  s_branch LGv0_mj_h0
LGv0_m1_h0:
  v_dot2c_f32_bf16 v224, v68, v20
  v_dot2c_f32_bf16 v225, v72, v20
  v_dot2c_f32_bf16 v226, v76, v20
  v_dot2c_f32_bf16 v224, v69, v20
  v_dot2c_f32_bf16 v225, v73, v20
  v_dot2c_f32_bf16 v226, v77, v20
  v_dot2c_f32_bf16 v224, v70, v20
  v_dot2c_f32_bf16 v225, v74, v20
  v_dot2c_f32_bf16 v226, v78, v20
  v_dot2c_f32_bf16 v224, v71, v20
  v_dot2c_f32_bf16 v225, v75, v20
  v_dot2c_f32_bf16 v226, v79, v20
LGv0_mj_h0:
  s_cmp_eq_u32 s44, 0
  s_cbranch_scc0 LGv0_n1_h0
  v_dot2c_f32_bf16 v227, v24, v20
  v_dot2c_f32_bf16 v228, v24, v24
  v_dot2c_f32_bf16 v229, v25, v20
  v_dot2c_f32_bf16 v230, v25, v25
  v_dot2c_f32_bf16 v227, v26, v20
  v_dot2c_f32_bf16 v228, v26, v26
  v_dot2c_f32_bf16 v229, v27, v20
  v_dot2c_f32_bf16 v230, v27, v27
  s_branch LGv0_nj_h0
LGv0_n1_h0:
  s_cmp_eq_u32 s44, 1
  s_cbranch_scc0 LGv0_n2_h0
  v_dot2c_f32_bf16 v227, v28, v20
  v_dot2c_f32_bf16 v228, v28, v28
  v_dot2c_f32_bf16 v229, v29, v20
  v_dot2c_f32_bf16 v230, v29, v29
  v_dot2c_f32_bf16 v227, v30, v20
  v_dot2c_f32_bf16 v228, v30, v30
  v_dot2c_f32_bf16 v229, v31, v20
  v_dot2c_f32_bf16 v230, v31, v31
  s_branch LGv0_nj_h0
LGv0_n2_h0:
  s_cmp_eq_u32 s44, 2
  s_cbranch_scc0 LGv0_n3_h0
  v_dot2c_f32_bf16 v227, v32, v20
  v_dot2c_f32_bf16 v228, v32, v32
  v_dot2c_f32_bf16 v229, v33, v20
  v_dot2c_f32_bf16 v230, v33, v33
  v_dot2c_f32_bf16 v227, v34, v20
  v_dot2c_f32_bf16 v228, v34, v34
  v_dot2c_f32_bf16 v229, v35, v20
  v_dot2c_f32_bf16 v230, v35, v35
  s_branch LGv0_nj_h0
LGv0_n3_h0:
  v_dot2c_f32_bf16 v227, v36, v20
  v_dot2c_f32_bf16 v228, v36, v36
  v_dot2c_f32_bf16 v229, v37, v20
  v_dot2c_f32_bf16 v230, v37, v37
  v_dot2c_f32_bf16 v227, v38, v20
  v_dot2c_f32_bf16 v228, v38, v38
  v_dot2c_f32_bf16 v229, v39, v20
  v_dot2c_f32_bf16 v230, v39, v39
LGv0_nj_h0:
  v_mfma_f32_16x16x32_bf16 v[212:215], v[68:71], v[36:39], v[212:215]
  ds_read_b64_tr_b16 v[96:97], v11 offset:12288
  s_add_u32 s41, s37, s39
  s_add_u32 m0, s41, 0
  s_nop 0
  buffer_load_dwordx4 v4, s[20:23], s34 offen lds
  v_mfma_f32_16x16x32_bf16 v[188:191], v[68:71], v[32:35], v[188:191]
  ds_read_b64_tr_b16 v[98:99], v11 offset:15360
  v_mfma_f32_16x16x32_bf16 v[164:167], v[68:71], v[28:31], v[164:167]
  ds_read_b64_tr_b16 v[100:101], v12 offset:12288
  s_add_u32 m0, s41, 1024
  s_nop 0
  buffer_load_dwordx4 v5, s[20:23], s34 offen lds
  v_mfma_f32_16x16x32_bf16 v[140:143], v[68:71], v[24:27], v[140:143]
  ds_read_b64_tr_b16 v[102:103], v12 offset:15360
  v_mfma_f32_16x16x32_bf16 v[216:219], v[72:75], v[36:39], v[216:219]
  s_add_u32 s54, s54, 24576
  s_cmp_ge_u32 s54, 98304
  s_cselect_b32 s42, 4294893568, s56
  s_cselect_b32 s54, 0, s54
  v_add_u32 v10, s42, v10
  v_add_u32 v11, s42, v11
  v_add_u32 v12, s42, v12
  s_add_u32 m0, s41, 2048
  s_nop 0
  buffer_load_dwordx4 v6, s[20:23], s34 offen lds
  s_add_u32 s34, s34, 110592
  s_cmp_ge_u32 s34, 2211840
  s_cselect_b32 s41, 2211840, 0
  s_sub_u32 s34, s34, s41
  s_add_u32 s39, s39, 24576
  s_cmp_ge_u32 s39, 98304
  s_cselect_b32 s39, 0, s39
  v_mfma_f32_16x16x32_bf16 v[192:195], v[72:75], v[32:35], v[192:195]
  v_mfma_f32_16x16x32_bf16 v[168:171], v[72:75], v[28:31], v[168:171]
  s_add_u32 s58, s58, s59
  buffer_load_dwordx4 v[112:115], v116, s[24:27], s58 offen
  v_mfma_f32_16x16x32_bf16 v[144:147], v[72:75], v[24:27], v[144:147]
  v_mfma_f32_16x16x32_bf16 v[220:223], v[76:79], v[36:39], v[220:223]
  s_add_u32 s58, s58, s59
  buffer_load_dwordx4 v[112:115], v116, s[24:27], s58 offen
  v_mfma_f32_16x16x32_bf16 v[196:199], v[76:79], v[32:35], v[196:199]
  v_mfma_f32_16x16x32_bf16 v[172:175], v[76:79], v[28:31], v[172:175]
  v_mfma_f32_16x16x32_bf16 v[148:151], v[76:79], v[24:27], v[148:151]
  s_waitcnt vmcnt(5) lgkmcnt(0)
  s_barrier
  v_mfma_f32_16x16x32_bf16 v[200:203], v[80:83], v[52:55], v[200:203]
  s_add_u32 s55, s55, 16384
  s_cmp_ge_u32 s55, 49152
  s_cselect_b32 s42, 4294934528, s57
  s_cselect_b32 s55, 0, s55
  v_add_u32 v13, s42, v13
  v_add_u32 v14, s42, v14
  v_mfma_f32_16x16x32_bf16 v[176:179], v[80:83], v[48:51], v[176:179]
  ds_read_b128 v[24:27], v13 offset:0
  s_add_u32 s42, s38, s40
  s_add_u32 m0, s42, 0
  s_nop 0
  buffer_load_dwordx4 v8, s[16:19], s35 offen lds
  v_mfma_f32_16x16x32_bf16 v[152:155], v[80:83], v[44:47], v[152:155]
  ds_read_b128 v[28:31], v13 offset:2048
  v_mfma_f32_16x16x32_bf16 v[128:131], v[80:83], v[40:43], v[128:131]
  ds_read_b128 v[32:35], v13 offset:4096
  s_add_u32 s41, s37, s39
  s_add_u32 m0, s41, 0
  s_nop 0
  buffer_load_dwordx4 v4, s[20:23], s34 offen lds
  v_mfma_f32_16x16x32_bf16 v[204:207], v[84:87], v[52:55], v[204:207]
  ds_read_b128 v[36:39], v13 offset:6144
  v_mfma_f32_16x16x32_bf16 v[180:183], v[84:87], v[48:51], v[180:183]
  ds_read_b64_tr_b16 v[56:57], v10 offset:0
  s_add_u32 m0, s41, 1024
  s_nop 0
  buffer_load_dwordx4 v5, s[20:23], s34 offen lds
  v_mfma_f32_16x16x32_bf16 v[156:159], v[84:87], v[44:47], v[156:159]
  ds_read_b64_tr_b16 v[58:59], v10 offset:3072
  v_mfma_f32_16x16x32_bf16 v[132:135], v[84:87], v[40:43], v[132:135]
  ds_read_b64_tr_b16 v[60:61], v11 offset:0
  v_mfma_f32_16x16x32_bf16 v[208:211], v[88:91], v[52:55], v[208:211]
  ds_read_b64_tr_b16 v[62:63], v11 offset:3072
  s_add_u32 m0, s41, 2048
  s_nop 0
  buffer_load_dwordx4 v6, s[20:23], s34 offen lds
  s_add_u32 s34, s34, 110592
  s_cmp_ge_u32 s34, 2211840
  s_cselect_b32 s41, 2211840, 0
  s_sub_u32 s34, s34, s41
  s_add_u32 s39, s39, 24576
  s_cmp_ge_u32 s39, 98304
  s_cselect_b32 s39, 0, s39
  v_mfma_f32_16x16x32_bf16 v[184:187], v[88:91], v[48:51], v[184:187]
  ds_read_b64_tr_b16 v[64:65], v12 offset:0
  v_mfma_f32_16x16x32_bf16 v[160:163], v[88:91], v[44:47], v[160:163]
  ds_read_b64_tr_b16 v[66:67], v12 offset:3072
  s_add_u32 s42, s38, s40
  s_add_u32 m0, s42, 1024
  s_nop 0
  buffer_load_dwordx4 v9, s[16:19], s35 offen lds
  s_add_u32 s35, s35, 128
  s_cmp_ge_u32 s35, 1280
  s_cselect_b32 s35, 0, s35
  s_add_u32 s40, s40, 16384
  s_cmp_ge_u32 s40, 49152
  s_cselect_b32 s40, 0, s40
  v_mfma_f32_16x16x32_bf16 v[136:139], v[88:91], v[40:43], v[136:139]
  ds_read_b64_tr_b16 v[68:69], v10 offset:12288
  s_cmp_eq_u32 s43, 0
  s_cbranch_scc0 LGv0_m1_h1
  v_dot2c_f32_bf16 v224, v80, v20
  v_dot2c_f32_bf16 v225, v84, v20
  v_dot2c_f32_bf16 v226, v88, v20
  v_dot2c_f32_bf16 v224, v81, v20
  v_dot2c_f32_bf16 v225, v85, v20
  v_dot2c_f32_bf16 v226, v89, v20
  v_dot2c_f32_bf16 v224, v82, v20
  v_dot2c_f32_bf16 v225, v86, v20
  v_dot2c_f32_bf16 v226, v90, v20
  v_dot2c_f32_bf16 v224, v83, v20
  v_dot2c_f32_bf16 v225, v87, v20
  v_dot2c_f32_bf16 v226, v91, v20
  s_branch LGv0_mj_h1
LGv0_m1_h1:
  v_dot2c_f32_bf16 v224, v92, v20
  v_dot2c_f32_bf16 v225, v96, v20
  v_dot2c_f32_bf16 v226, v100, v20
  v_dot2c_f32_bf16 v224, v93, v20
  v_dot2c_f32_bf16 v225, v97, v20
  v_dot2c_f32_bf16 v226, v101, v20
  v_dot2c_f32_bf16 v224, v94, v20
  v_dot2c_f32_bf16 v225, v98, v20
  v_dot2c_f32_bf16 v226, v102, v20
  v_dot2c_f32_bf16 v224, v95, v20
  v_dot2c_f32_bf16 v225, v99, v20
  v_dot2c_f32_bf16 v226, v103, v20
LGv0_mj_h1:
  s_cmp_eq_u32 s44, 0
  s_cbranch_scc0 LGv0_n1_h1
  v_dot2c_f32_bf16 v227, v40, v20
  v_dot2c_f32_bf16 v228, v40, v40
  v_dot2c_f32_bf16 v229, v41, v20
  v_dot2c_f32_bf16 v230, v41, v41
  v_dot2c_f32_bf16 v227, v42, v20
  v_dot2c_f32_bf16 v228, v42, v42
  v_dot2c_f32_bf16 v229, v43, v20
  v_dot2c_f32_bf16 v230, v43, v43
  s_branch LGv0_nj_h1
LGv0_n1_h1:
  s_cmp_eq_u32 s44, 1
  s_cbranch_scc0 LGv0_n2_h1
  v_dot2c_f32_bf16 v227, v44, v20
  v_dot2c_f32_bf16 v228, v44, v44
  v_dot2c_f32_bf16 v229, v45, v20
  v_dot2c_f32_bf16 v230, v45, v45
  v_dot2c_f32_bf16 v227, v46, v20
  v_dot2c_f32_bf16 v228, v46, v46
  v_dot2c_f32_bf16 v229, v47, v20
  v_dot2c_f32_bf16 v230, v47, v47
  s_branch LGv0_nj_h1
LGv0_n2_h1:
  s_cmp_eq_u32 s44, 2
  s_cbranch_scc0 LGv0_n3_h1
  v_dot2c_f32_bf16 v227, v48, v20
  v_dot2c_f32_bf16 v228, v48, v48
  v_dot2c_f32_bf16 v229, v49, v20
  v_dot2c_f32_bf16 v230, v49, v49
  v_dot2c_f32_bf16 v227, v50, v20
  v_dot2c_f32_bf16 v228, v50, v50
  v_dot2c_f32_bf16 v229, v51, v20
  v_dot2c_f32_bf16 v230, v51, v51
  s_branch LGv0_nj_h1
LGv0_n3_h1:
  v_dot2c_f32_bf16 v227, v52, v20
  v_dot2c_f32_bf16 v228, v52, v52
  v_dot2c_f32_bf16 v229, v53, v20
  v_dot2c_f32_bf16 v230, v53, v53
  v_dot2c_f32_bf16 v227, v54, v20
  v_dot2c_f32_bf16 v228, v54, v54
  v_dot2c_f32_bf16 v229, v55, v20
  v_dot2c_f32_bf16 v230, v55, v55
LGv0_nj_h1:
  v_mfma_f32_16x16x32_bf16 v[212:215], v[92:95], v[52:55], v[212:215]
  ds_read_b64_tr_b16 v[70:71], v10 offset:15360
  v_mfma_f32_16x16x32_bf16 v[188:191], v[92:95], v[48:51], v[188:191]
  ds_read_b64_tr_b16 v[72:73], v11 offset:12288
  s_add_u32 s41, s37, s39
  s_add_u32 m0, s41, 0
  s_nop 0
  buffer_load_dwordx4 v4, s[20:23], s34 offen lds
  v_mfma_f32_16x16x32_bf16 v[164:167], v[92:95], v[44:47], v[164:167]
  ds_read_b64_tr_b16 v[74:75], v11 offset:15360
  v_mfma_f32_16x16x32_bf16 v[140:143], v[92:95], v[40:43], v[140:143]
  ds_read_b64_tr_b16 v[76:77], v12 offset:12288
  s_add_u32 m0, s41, 1024
  s_nop 0
  buffer_load_dwordx4 v5, s[20:23], s34 offen lds
  v_mfma_f32_16x16x32_bf16 v[216:219], v[96:99], v[52:55], v[216:219]
  ds_read_b64_tr_b16 v[78:79], v12 offset:15360
  v_mfma_f32_16x16x32_bf16 v[192:195], v[96:99], v[48:51], v[192:195]
  s_add_u32 s54, s54, 24576
  s_cmp_ge_u32 s54, 98304
  s_cselect_b32 s42, 4294893568, s56
  s_cselect_b32 s54, 0, s54
  v_add_u32 v10, s42, v10
  v_add_u32 v11, s42, v11
  v_add_u32 v12, s42, v12
  v_mfma_f32_16x16x32_bf16 v[168:171], v[96:99], v[44:47], v[168:171]
  s_add_u32 m0, s41, 2048
  s_nop 0
  buffer_load_dwordx4 v6, s[20:23], s34 offen lds
  s_add_u32 s34, s34, 110592
  s_cmp_ge_u32 s34, 2211840
  s_cselect_b32 s41, 2211840, 0
  s_sub_u32 s34, s34, s41
  s_add_u32 s39, s39, 24576
  s_cmp_ge_u32 s39, 98304
  s_cselect_b32 s39, 0, s39
  v_mfma_f32_16x16x32_bf16 v[144:147], v[96:99], v[40:43], v[144:147]
  v_mfma_f32_16x16x32_bf16 v[220:223], v[100:103], v[52:55], v[220:223]
  s_add_u32 s42, s38, s40
  s_add_u32 m0, s42, 0
  s_nop 0
  buffer_load_dwordx4 v8, s[16:19], s35 offen lds
  v_mfma_f32_16x16x32_bf16 v[196:199], v[100:103], v[48:51], v[196:199]
  v_mfma_f32_16x16x32_bf16 v[172:175], v[100:103], v[44:47], v[172:175]
  v_mfma_f32_16x16x32_bf16 v[148:151], v[100:103], v[40:43], v[148:151]
  s_mov_b32 s36, 6
LG_loop:
  s_waitcnt vmcnt(9) lgkmcnt(0)
  s_barrier
  v_mfma_f32_16x16x32_bf16 v[200:203], v[56:59], v[36:39], v[200:203]
  ds_read_b128 v[40:43], v14 offset:0
  v_mfma_f32_16x16x32_bf16 v[176:179], v[56:59], v[32:35], v[176:179]
  ds_read_b128 v[44:47], v14 offset:2048
  s_add_u32 s41, s37, s39
  s_add_u32 m0, s41, 0
  s_nop 0
  buffer_load_dwordx4 v4, s[20:23], s34 offen lds
  v_mfma_f32_16x16x32_bf16 v[152:155], v[56:59], v[28:31], v[152:155]
  ds_read_b128 v[48:51], v14 offset:4096
  v_mfma_f32_16x16x32_bf16 v[128:131], v[56:59], v[24:27], v[128:131]
  ds_read_b128 v[52:55], v14 offset:6144
  v_mfma_f32_16x16x32_bf16 v[204:207], v[60:63], v[36:39], v[204:207]
  ds_read_b64_tr_b16 v[80:81], v10 offset:0
  v_mfma_f32_16x16x32_bf16 v[180:183], v[60:63], v[32:35], v[180:183]
  ds_read_b64_tr_b16 v[82:83], v10 offset:3072
  v_mfma_f32_16x16x32_bf16 v[156:159], v[60:63], v[28:31], v[156:159]
  ds_read_b64_tr_b16 v[84:85], v11 offset:0
  s_add_u32 m0, s41, 1024
  s_nop 0
  buffer_load_dwordx4 v5, s[20:23], s34 offen lds
  v_mfma_f32_16x16x32_bf16 v[132:135], v[60:63], v[24:27], v[132:135]
  ds_read_b64_tr_b16 v[86:87], v11 offset:3072
  v_mfma_f32_16x16x32_bf16 v[208:211], v[64:67], v[36:39], v[208:211]
  ds_read_b64_tr_b16 v[88:89], v12 offset:0
  v_mfma_f32_16x16x32_bf16 v[184:187], v[64:67], v[32:35], v[184:187]
  ds_read_b64_tr_b16 v[90:91], v12 offset:3072
  v_mfma_f32_16x16x32_bf16 v[160:163], v[64:67], v[28:31], v[160:163]
  ds_read_b64_tr_b16 v[92:93], v10 offset:12288
  v_mfma_f32_16x16x32_bf16 v[136:139], v[64:67], v[24:27], v[136:139]
  ds_read_b64_tr_b16 v[94:95], v10 offset:15360
  s_cmp_eq_u32 s43, 0
  s_cbranch_scc0 LGv0_m1_a
  v_dot2c_f32_bf16 v224, v56, v20
  v_dot2c_f32_bf16 v225, v60, v20
  v_dot2c_f32_bf16 v226, v64, v20
  v_dot2c_f32_bf16 v224, v57, v20
  v_dot2c_f32_bf16 v225, v61, v20
  v_dot2c_f32_bf16 v226, v65, v20
  v_dot2c_f32_bf16 v224, v58, v20
  v_dot2c_f32_bf16 v225, v62, v20
  v_dot2c_f32_bf16 v226, v66, v20
  v_dot2c_f32_bf16 v224, v59, v20
  v_dot2c_f32_bf16 v225, v63, v20
  v_dot2c_f32_bf16 v226, v67, v20
  s_branch LGv0_mj_a
LGv0_m1_a:
  v_dot2c_f32_bf16 v224, v68, v20
  v_dot2c_f32_bf16 v225, v72, v20
  v_dot2c_f32_bf16 v226, v76, v20
  v_dot2c_f32_bf16 v224, v69, v20
  v_dot2c_f32_bf16 v225, v73, v20
  v_dot2c_f32_bf16 v226, v77, v20
  v_dot2c_f32_bf16 v224, v70, v20
  v_dot2c_f32_bf16 v225, v74, v20
  v_dot2c_f32_bf16 v226, v78, v20
  v_dot2c_f32_bf16 v224, v71, v20
  v_dot2c_f32_bf16 v225, v75, v20
  v_dot2c_f32_bf16 v226, v79, v20
LGv0_mj_a:
  s_cmp_eq_u32 s44, 0
  s_cbranch_scc0 LGv0_n1_a
  v_dot2c_f32_bf16 v227, v24, v20
  v_dot2c_f32_bf16 v228, v24, v24
  v_dot2c_f32_bf16 v229, v25, v20
  v_dot2c_f32_bf16 v230, v25, v25
  v_dot2c_f32_bf16 v227, v26, v20
  v_dot2c_f32_bf16 v228, v26, v26
  v_dot2c_f32_bf16 v229, v27, v20
  v_dot2c_f32_bf16 v230, v27, v27
  s_branch LGv0_nj_a
LGv0_n1_a:
  s_cmp_eq_u32 s44, 1
  s_cbranch_scc0 LGv0_n2_a
  v_dot2c_f32_bf16 v227, v28, v20
  v_dot2c_f32_bf16 v228, v28, v28
  v_dot2c_f32_bf16 v229, v29, v20
  v_dot2c_f32_bf16 v230, v29, v29
  v_dot2c_f32_bf16 v227, v30, v20
  v_dot2c_f32_bf16 v228, v30, v30
  v_dot2c_f32_bf16 v229, v31, v20
  v_dot2c_f32_bf16 v230, v31, v31
  s_branch LGv0_nj_a
LGv0_n2_a:
  s_cmp_eq_u32 s44, 2
  s_cbranch_scc0 LGv0_n3_a
  v_dot2c_f32_bf16 v227, v32, v20
  v_dot2c_f32_bf16 v228, v32, v32
  v_dot2c_f32_bf16 v229, v33, v20
  v_dot2c_f32_bf16 v230, v33, v33
  v_dot2c_f32_bf16 v227, v34, v20
  v_dot2c_f32_bf16 v228, v34, v34
  v_dot2c_f32_bf16 v229, v35, v20
  v_dot2c_f32_bf16 v230, v35, v35
  s_branch LGv0_nj_a
LGv0_n3_a:
  v_dot2c_f32_bf16 v227, v36, v20
  v_dot2c_f32_bf16 v228, v36, v36
  v_dot2c_f32_bf16 v229, v37, v20
  v_dot2c_f32_bf16 v230, v37, v37
  v_dot2c_f32_bf16 v227, v38, v20
  v_dot2c_f32_bf16 v228, v38, v38
  v_dot2c_f32_bf16 v229, v39, v20
  v_dot2c_f32_bf16 v230, v39, v39
LGv0_nj_a:
  v_mfma_f32_16x16x32_bf16 v[212:215], v[68:71], v[36:39], v[212:215]
  ds_read_b64_tr_b16 v[96:97], v11 offset:12288
  s_add_u32 m0, s41, 2048
  s_nop 0
  buffer_load_dwordx4 v6, s[20:23], s34 offen lds
  s_add_u32 s34, s34, 110592
  s_cmp_ge_u32 s34, 2211840
  s_cselect_b32 s41, 2211840, 0
  s_sub_u32 s34, s34, s41
  s_add_u32 s39, s39, 24576
  s_cmp_ge_u32 s39, 98304
  s_cselect_b32 s39, 0, s39
  v_mfma_f32_16x16x32_bf16 v[188:191], v[68:71], v[32:35], v[188:191]
  ds_read_b64_tr_b16 v[98:99], v11 offset:15360
  v_mfma_f32_16x16x32_bf16 v[164:167], v[68:71], v[28:31], v[164:167]
  ds_read_b64_tr_b16 v[100:101], v12 offset:12288
  v_mfma_f32_16x16x32_bf16 v[140:143], v[68:71], v[24:27], v[140:143]
  ds_read_b64_tr_b16 v[102:103], v12 offset:15360
  v_mfma_f32_16x16x32_bf16 v[216:219], v[72:75], v[36:39], v[216:219]
  s_add_u32 s54, s54, 24576
  s_cmp_ge_u32 s54, 98304
  s_cselect_b32 s42, 4294893568, s56
  s_cselect_b32 s54, 0, s54
  v_add_u32 v10, s42, v10
  v_add_u32 v11, s42, v11
  v_add_u32 v12, s42, v12
  v_mfma_f32_16x16x32_bf16 v[192:195], v[72:75], v[32:35], v[192:195]
  s_add_u32 s42, s38, s40
  s_add_u32 m0, s42, 1024
  s_nop 0
  buffer_load_dwordx4 v9, s[16:19], s35 offen lds
  s_add_u32 s35, s35, 128
  s_cmp_ge_u32 s35, 1280
  s_cselect_b32 s35, 0, s35
  s_add_u32 s40, s40, 16384
  s_cmp_ge_u32 s40, 49152
  s_cselect_b32 s40, 0, s40
  v_mfma_f32_16x16x32_bf16 v[168:171], v[72:75], v[28:31], v[168:171]
  v_mfma_f32_16x16x32_bf16 v[144:147], v[72:75], v[24:27], v[144:147]
  v_mfma_f32_16x16x32_bf16 v[220:223], v[76:79], v[36:39], v[220:223]
  v_mfma_f32_16x16x32_bf16 v[196:199], v[76:79], v[32:35], v[196:199]
  v_mfma_f32_16x16x32_bf16 v[172:175], v[76:79], v[28:31], v[172:175]
  v_mfma_f32_16x16x32_bf16 v[148:151], v[76:79], v[24:27], v[148:151]
  s_waitcnt vmcnt(8) lgkmcnt(0)
  s_barrier
  v_mfma_f32_16x16x32_bf16 v[200:203], v[80:83], v[52:55], v[200:203]
  s_add_u32 s55, s55, 16384
  s_cmp_ge_u32 s55, 49152
  s_cselect_b32 s42, 4294934528, s57
  s_cselect_b32 s55, 0, s55
  v_add_u32 v13, s42, v13
  v_add_u32 v14, s42, v14
  v_mfma_f32_16x16x32_bf16 v[176:179], v[80:83], v[48:51], v[176:179]
  ds_read_b128 v[24:27], v13 offset:0
  s_add_u32 s41, s37, s39
  s_add_u32 m0, s41, 0
  s_nop 0
  buffer_load_dwordx4 v4, s[20:23], s34 offen lds
  v_mfma_f32_16x16x32_bf16 v[152:155], v[80:83], v[44:47], v[152:155]
  ds_read_b128 v[28:31], v13 offset:2048
  v_mfma_f32_16x16x32_bf16 v[128:131], v[80:83], v[40:43], v[128:131]
  ds_read_b128 v[32:35], v13 offset:4096
  v_mfma_f32_16x16x32_bf16 v[204:207], v[84:87], v[52:55], v[204:207]
  ds_read_b128 v[36:39], v13 offset:6144
  v_mfma_f32_16x16x32_bf16 v[180:183], v[84:87], v[48:51], v[180:183]
  ds_read_b64_tr_b16 v[56:57], v10 offset:0
  v_mfma_f32_16x16x32_bf16 v[156:159], v[84:87], v[44:47], v[156:159]
  ds_read_b64_tr_b16 v[58:59], v10 offset:3072
  s_add_u32 m0, s41, 1024
  s_nop 0
  buffer_load_dwordx4 v5, s[20:23], s34 offen lds
  v_mfma_f32_16x16x32_bf16 v[132:135], v[84:87], v[40:43], v[132:135]
  ds_read_b64_tr_b16 v[60:61], v11 offset:0
  v_mfma_f32_16x16x32_bf16 v[208:211], v[88:91], v[52:55], v[208:211]
  ds_read_b64_tr_b16 v[62:63], v11 offset:3072
  v_mfma_f32_16x16x32_bf16 v[184:187], v[88:91], v[48:51], v[184:187]
  ds_read_b64_tr_b16 v[64:65], v12 offset:0
  v_mfma_f32_16x16x32_bf16 v[160:163], v[88:91], v[44:47], v[160:163]
  ds_read_b64_tr_b16 v[66:67], v12 offset:3072
  v_mfma_f32_16x16x32_bf16 v[136:139], v[88:91], v[40:43], v[136:139]
  ds_read_b64_tr_b16 v[68:69], v10 offset:12288
  s_cmp_eq_u32 s43, 0
  s_cbranch_scc0 LGv0_m1_b
  v_dot2c_f32_bf16 v224, v80, v20
  v_dot2c_f32_bf16 v225, v84, v20
  v_dot2c_f32_bf16 v226, v88, v20
  v_dot2c_f32_bf16 v224, v81, v20
  v_dot2c_f32_bf16 v225, v85, v20
  v_dot2c_f32_bf16 v226, v89, v20
  v_dot2c_f32_bf16 v224, v82, v20
  v_dot2c_f32_bf16 v225, v86, v20
  v_dot2c_f32_bf16 v226, v90, v20
  v_dot2c_f32_bf16 v224, v83, v20
  v_dot2c_f32_bf16 v225, v87, v20
  v_dot2c_f32_bf16 v226, v91, v20
  s_branch LGv0_mj_b
LGv0_m1_b:
  v_dot2c_f32_bf16 v224, v92, v20
  v_dot2c_f32_bf16 v225, v96, v20
  v_dot2c_f32_bf16 v226, v100, v20
  v_dot2c_f32_bf16 v224, v93, v20
  v_dot2c_f32_bf16 v225, v97, v20
  v_dot2c_f32_bf16 v226, v101, v20
  v_dot2c_f32_bf16 v224, v94, v20
  v_dot2c_f32_bf16 v225, v98, v20
  v_dot2c_f32_bf16 v226, v102, v20
  v_dot2c_f32_bf16 v224, v95, v20
  v_dot2c_f32_bf16 v225, v99, v20
  v_dot2c_f32_bf16 v226, v103, v20
LGv0_mj_b:
  s_cmp_eq_u32 s44, 0
  s_cbranch_scc0 LGv0_n1_b
  v_dot2c_f32_bf16 v227, v40, v20
  v_dot2c_f32_bf16 v228, v40, v40
  v_dot2c_f32_bf16 v229, v41, v20
  v_dot2c_f32_bf16 v230, v41, v41
  v_dot2c_f32_bf16 v227, v42, v20
  v_dot2c_f32_bf16 v228, v42, v42
  v_dot2c_f32_bf16 v229, v43, v20
  v_dot2c_f32_bf16 v230, v43, v43
  s_branch LGv0_nj_b
LGv0_n1_b:
  s_cmp_eq_u32 s44, 1
  s_cbranch_scc0 LGv0_n2_b
  v_dot2c_f32_bf16 v227, v44, v20
  v_dot2c_f32_bf16 v228, v44, v44
  v_dot2c_f32_bf16 v229, v45, v20
  v_dot2c_f32_bf16 v230, v45, v45
  v_dot2c_f32_bf16 v227, v46, v20
  v_dot2c_f32_bf16 v228, v46, v46
  v_dot2c_f32_bf16 v229, v47, v20
  v_dot2c_f32_bf16 v230, v47, v47
  s_branch LGv0_nj_b
LGv0_n2_b:
  s_cmp_eq_u32 s44, 2
  s_cbranch_scc0 LGv0_n3_b
  v_dot2c_f32_bf16 v227, v48, v20
  v_dot2c_f32_bf16 v228, v48, v48
  v_dot2c_f32_bf16 v229, v49, v20
  v_dot2c_f32_bf16 v230, v49, v49
  v_dot2c_f32_bf16 v227, v50, v20
  v_dot2c_f32_bf16 v228, v50, v50
  v_dot2c_f32_bf16 v229, v51, v20
  v_dot2c_f32_bf16 v230, v51, v51
  s_branch LGv0_nj_b
LGv0_n3_b:
  v_dot2c_f32_bf16 v227, v52, v20
  v_dot2c_f32_bf16 v228, v52, v52
  v_dot2c_f32_bf16 v229, v53, v20
  v_dot2c_f32_bf16 v230, v53, v53
  v_dot2c_f32_bf16 v227, v54, v20
  v_dot2c_f32_bf16 v228, v54, v54
  v_dot2c_f32_bf16 v229, v55, v20
  v_dot2c_f32_bf16 v230, v55, v55
LGv0_nj_b:
  v_mfma_f32_16x16x32_bf16 v[212:215], v[92:95], v[52:55], v[212:215]
  ds_read_b64_tr_b16 v[70:71], v10 offset:15360
  s_add_u32 m0, s41, 2048
  s_nop 0
  buffer_load_dwordx4 v6, s[20:23], s34 offen lds
  s_add_u32 s34, s34, 110592
  s_cmp_ge_u32 s34, 2211840
  s_cselect_b32 s41, 2211840, 0
  s_sub_u32 s34, s34, s41
  s_add_u32 s39, s39, 24576
  s_cmp_ge_u32 s39, 98304
  s_cselect_b32 s39, 0, s39
  v_mfma_f32_16x16x32_bf16 v[188:191], v[92:95], v[48:51], v[188:191]
  ds_read_b64_tr_b16 v[72:73], v11 offset:12288
  v_mfma_f32_16x16x32_bf16 v[164:167], v[92:95], v[44:47], v[164:167]
  ds_read_b64_tr_b16 v[74:75], v11 offset:15360
  v_mfma_f32_16x16x32_bf16 v[140:143], v[92:95], v[40:43], v[140:143]
  ds_read_b64_tr_b16 v[76:77], v12 offset:12288
  v_mfma_f32_16x16x32_bf16 v[216:219], v[96:99], v[52:55], v[216:219]
  ds_read_b64_tr_b16 v[78:79], v12 offset:15360
  v_mfma_f32_16x16x32_bf16 v[192:195], v[96:99], v[48:51], v[192:195]
  s_add_u32 s54, s54, 24576
  s_cmp_ge_u32 s54, 98304
  s_cselect_b32 s42, 4294893568, s56
  s_cselect_b32 s54, 0, s54
  v_add_u32 v10, s42, v10
  v_add_u32 v11, s42, v11
  v_add_u32 v12, s42, v12
  s_add_u32 s42, s38, s40
  s_add_u32 m0, s42, 0
  s_nop 0
  buffer_load_dwordx4 v8, s[16:19], s35 offen lds
  v_mfma_f32_16x16x32_bf16 v[168:171], v[96:99], v[44:47], v[168:171]
  v_mfma_f32_16x16x32_bf16 v[144:147], v[96:99], v[40:43], v[144:147]
  v_mfma_f32_16x16x32_bf16 v[220:223], v[100:103], v[52:55], v[220:223]
  v_mfma_f32_16x16x32_bf16 v[196:199], v[100:103], v[48:51], v[196:199]
  v_mfma_f32_16x16x32_bf16 v[172:175], v[100:103], v[44:47], v[172:175]
  v_mfma_f32_16x16x32_bf16 v[148:151], v[100:103], v[40:43], v[148:151]
  s_sub_u32 s36, s36, 1
  s_cmp_lg_u32 s36, 0
  s_cbranch_scc1 LG_loop
  s_waitcnt vmcnt(9) lgkmcnt(0)
  s_barrier
  v_mfma_f32_16x16x32_bf16 v[200:203], v[56:59], v[36:39], v[200:203]
  ds_read_b128 v[40:43], v14 offset:0
  v_mfma_f32_16x16x32_bf16 v[176:179], v[56:59], v[32:35], v[176:179]
  ds_read_b128 v[44:47], v14 offset:2048
  s_add_u32 s41, s37, s39
  s_add_u32 m0, s41, 0
  s_nop 0
  buffer_load_dwordx4 v4, s[20:23], s34 offen lds
  v_mfma_f32_16x16x32_bf16 v[152:155], v[56:59], v[28:31], v[152:155]
  ds_read_b128 v[48:51], v14 offset:4096
  v_mfma_f32_16x16x32_bf16 v[128:131], v[56:59], v[24:27], v[128:131]
  ds_read_b128 v[52:55], v14 offset:6144
  v_mfma_f32_16x16x32_bf16 v[204:207], v[60:63], v[36:39], v[204:207]
  ds_read_b64_tr_b16 v[80:81], v10 offset:0
  v_mfma_f32_16x16x32_bf16 v[180:183], v[60:63], v[32:35], v[180:183]
  ds_read_b64_tr_b16 v[82:83], v10 offset:3072
  v_mfma_f32_16x16x32_bf16 v[156:159], v[60:63], v[28:31], v[156:159]
  ds_read_b64_tr_b16 v[84:85], v11 offset:0
  s_add_u32 m0, s41, 1024
  s_nop 0
  buffer_load_dwordx4 v5, s[20:23], s34 offen lds
  v_mfma_f32_16x16x32_bf16 v[132:135], v[60:63], v[24:27], v[132:135]
  ds_read_b64_tr_b16 v[86:87], v11 offset:3072
  v_mfma_f32_16x16x32_bf16 v[208:211], v[64:67], v[36:39], v[208:211]
  ds_read_b64_tr_b16 v[88:89], v12 offset:0
  v_mfma_f32_16x16x32_bf16 v[184:187], v[64:67], v[32:35], v[184:187]
  ds_read_b64_tr_b16 v[90:91], v12 offset:3072
  v_mfma_f32_16x16x32_bf16 v[160:163], v[64:67], v[28:31], v[160:163]
  ds_read_b64_tr_b16 v[92:93], v10 offset:12288
  v_mfma_f32_16x16x32_bf16 v[136:139], v[64:67], v[24:27], v[136:139]
  ds_read_b64_tr_b16 v[94:95], v10 offset:15360
  s_cmp_eq_u32 s43, 0
  s_cbranch_scc0 LGv0_m1_t14
  v_dot2c_f32_bf16 v224, v56, v20
  v_dot2c_f32_bf16 v225, v60, v20
  v_dot2c_f32_bf16 v226, v64, v20
  v_dot2c_f32_bf16 v224, v57, v20
  v_dot2c_f32_bf16 v225, v61, v20
  v_dot2c_f32_bf16 v226, v65, v20
  v_dot2c_f32_bf16 v224, v58, v20
  v_dot2c_f32_bf16 v225, v62, v20
  v_dot2c_f32_bf16 v226, v66, v20
  v_dot2c_f32_bf16 v224, v59, v20
  v_dot2c_f32_bf16 v225, v63, v20
  v_dot2c_f32_bf16 v226, v67, v20
  s_branch LGv0_mj_t14
LGv0_m1_t14:
  v_dot2c_f32_bf16 v224, v68, v20
  v_dot2c_f32_bf16 v225, v72, v20
  v_dot2c_f32_bf16 v226, v76, v20
  v_dot2c_f32_bf16 v224, v69, v20
  v_dot2c_f32_bf16 v225, v73, v20
  v_dot2c_f32_bf16 v226, v77, v20
  v_dot2c_f32_bf16 v224, v70, v20
  v_dot2c_f32_bf16 v225, v74, v20
  v_dot2c_f32_bf16 v226, v78, v20
  v_dot2c_f32_bf16 v224, v71, v20
  v_dot2c_f32_bf16 v225, v75, v20
  v_dot2c_f32_bf16 v226, v79, v20
LGv0_mj_t14:
  s_cmp_eq_u32 s44, 0
  s_cbranch_scc0 LGv0_n1_t14
  v_dot2c_f32_bf16 v227, v24, v20
  v_dot2c_f32_bf16 v228, v24, v24
  v_dot2c_f32_bf16 v229, v25, v20
  v_dot2c_f32_bf16 v230, v25, v25
  v_dot2c_f32_bf16 v227, v26, v20
  v_dot2c_f32_bf16 v228, v26, v26
  v_dot2c_f32_bf16 v229, v27, v20
  v_dot2c_f32_bf16 v230, v27, v27
  s_branch LGv0_nj_t14
LGv0_n1_t14:
  s_cmp_eq_u32 s44, 1
  s_cbranch_scc0 LGv0_n2_t14
  v_dot2c_f32_bf16 v227, v28, v20
  v_dot2c_f32_bf16 v228, v28, v28
  v_dot2c_f32_bf16 v229, v29, v20
  v_dot2c_f32_bf16 v230, v29, v29
  v_dot2c_f32_bf16 v227, v30, v20
  v_dot2c_f32_bf16 v228, v30, v30
  v_dot2c_f32_bf16 v229, v31, v20
  v_dot2c_f32_bf16 v230, v31, v31
  s_branch LGv0_nj_t14
LGv0_n2_t14:
  s_cmp_eq_u32 s44, 2
  s_cbranch_scc0 LGv0_n3_t14
  v_dot2c_f32_bf16 v227, v32, v20
  v_dot2c_f32_bf16 v228, v32, v32
  v_dot2c_f32_bf16 v229, v33, v20
  v_dot2c_f32_bf16 v230, v33, v33
  v_dot2c_f32_bf16 v227, v34, v20
  v_dot2c_f32_bf16 v228, v34, v34
  v_dot2c_f32_bf16 v229, v35, v20
  v_dot2c_f32_bf16 v230, v35, v35
  s_branch LGv0_nj_t14
LGv0_n3_t14:
  v_dot2c_f32_bf16 v227, v36, v20
  v_dot2c_f32_bf16 v228, v36, v36
  v_dot2c_f32_bf16 v229, v37, v20
  v_dot2c_f32_bf16 v230, v37, v37
  v_dot2c_f32_bf16 v227, v38, v20
  v_dot2c_f32_bf16 v228, v38, v38
  v_dot2c_f32_bf16 v229, v39, v20
  v_dot2c_f32_bf16 v230, v39, v39
LGv0_nj_t14:
  v_mfma_f32_16x16x32_bf16 v[212:215], v[68:71], v[36:39], v[212:215]
  ds_read_b64_tr_b16 v[96:97], v11 offset:12288
  s_add_u32 m0, s41, 2048
  s_nop 0
  buffer_load_dwordx4 v6, s[20:23], s34 offen lds
  s_add_u32 s34, s34, 110592
  s_cmp_ge_u32 s34, 2211840
  s_cselect_b32 s41, 2211840, 0
  s_sub_u32 s34, s34, s41
  s_add_u32 s39, s39, 24576
  s_cmp_ge_u32 s39, 98304
  s_cselect_b32 s39, 0, s39
  v_mfma_f32_16x16x32_bf16 v[188:191], v[68:71], v[32:35], v[188:191]
  ds_read_b64_tr_b16 v[98:99], v11 offset:15360
  v_mfma_f32_16x16x32_bf16 v[164:167], v[68:71], v[28:31], v[164:167]
  ds_read_b64_tr_b16 v[100:101], v12 offset:12288
  v_mfma_f32_16x16x32_bf16 v[140:143], v[68:71], v[24:27], v[140:143]
  ds_read_b64_tr_b16 v[102:103], v12 offset:15360
  v_mfma_f32_16x16x32_bf16 v[216:219], v[72:75], v[36:39], v[216:219]
  s_add_u32 s54, s54, 24576
  s_cmp_ge_u32 s54, 98304
  s_cselect_b32 s42, 4294893568, s56
  s_cselect_b32 s54, 0, s54
  v_add_u32 v10, s42, v10
  v_add_u32 v11, s42, v11
  v_add_u32 v12, s42, v12
  v_mfma_f32_16x16x32_bf16 v[192:195], v[72:75], v[32:35], v[192:195]
  s_add_u32 s42, s38, s40
  s_add_u32 m0, s42, 1024
  s_nop 0
  buffer_load_dwordx4 v9, s[16:19], s35 offen lds
  s_add_u32 s35, s35, 128
  s_cmp_ge_u32 s35, 1280
  s_cselect_b32 s35, 0, s35
  s_add_u32 s40, s40, 16384
  s_cmp_ge_u32 s40, 49152
  s_cselect_b32 s40, 0, s40
  v_mfma_f32_16x16x32_bf16 v[168:171], v[72:75], v[28:31], v[168:171]
  v_mfma_f32_16x16x32_bf16 v[144:147], v[72:75], v[24:27], v[144:147]
  v_mfma_f32_16x16x32_bf16 v[220:223], v[76:79], v[36:39], v[220:223]
  v_mfma_f32_16x16x32_bf16 v[196:199], v[76:79], v[32:35], v[196:199]
  v_mfma_f32_16x16x32_bf16 v[172:175], v[76:79], v[28:31], v[172:175]
  v_mfma_f32_16x16x32_bf16 v[148:151], v[76:79], v[24:27], v[148:151]
  s_waitcnt vmcnt(8) lgkmcnt(0)
  s_barrier
  v_mfma_f32_16x16x32_bf16 v[200:203], v[80:83], v[52:55], v[200:203]
  s_add_u32 s55, s55, 16384
  s_cmp_ge_u32 s55, 49152
  s_cselect_b32 s42, 4294934528, s57
  s_cselect_b32 s55, 0, s55
  v_add_u32 v13, s42, v13
  v_add_u32 v14, s42, v14
  v_mfma_f32_16x16x32_bf16 v[176:179], v[80:83], v[48:51], v[176:179]
  ds_read_b128 v[24:27], v13 offset:0
  s_add_u32 s41, s37, s39
  s_add_u32 m0, s41, 0
  s_nop 0
  buffer_load_dwordx4 v4, s[20:23], s34 offen lds
  v_mfma_f32_16x16x32_bf16 v[152:155], v[80:83], v[44:47], v[152:155]
  ds_read_b128 v[28:31], v13 offset:2048
  v_mfma_f32_16x16x32_bf16 v[128:131], v[80:83], v[40:43], v[128:131]
  ds_read_b128 v[32:35], v13 offset:4096
  v_mfma_f32_16x16x32_bf16 v[204:207], v[84:87], v[52:55], v[204:207]
  ds_read_b128 v[36:39], v13 offset:6144
  v_mfma_f32_16x16x32_bf16 v[180:183], v[84:87], v[48:51], v[180:183]
  ds_read_b64_tr_b16 v[56:57], v10 offset:0
  v_mfma_f32_16x16x32_bf16 v[156:159], v[84:87], v[44:47], v[156:159]
  ds_read_b64_tr_b16 v[58:59], v10 offset:3072
  v_mfma_f32_16x16x32_bf16 v[132:135], v[84:87], v[40:43], v[132:135]
  ds_read_b64_tr_b16 v[60:61], v11 offset:0
  v_mfma_f32_16x16x32_bf16 v[208:211], v[88:91], v[52:55], v[208:211]
  ds_read_b64_tr_b16 v[62:63], v11 offset:3072
  s_add_u32 m0, s41, 1024
  s_nop 0
  buffer_load_dwordx4 v5, s[20:23], s34 offen lds
  v_mfma_f32_16x16x32_bf16 v[184:187], v[88:91], v[48:51], v[184:187]
  ds_read_b64_tr_b16 v[64:65], v12 offset:0
  v_mfma_f32_16x16x32_bf16 v[160:163], v[88:91], v[44:47], v[160:163]
  ds_read_b64_tr_b16 v[66:67], v12 offset:3072
  v_mfma_f32_16x16x32_bf16 v[136:139], v[88:91], v[40:43], v[136:139]
  ds_read_b64_tr_b16 v[68:69], v10 offset:12288
  s_cmp_eq_u32 s43, 0
  s_cbranch_scc0 LGv0_m1_t15
  v_dot2c_f32_bf16 v224, v80, v20
  v_dot2c_f32_bf16 v225, v84, v20
  v_dot2c_f32_bf16 v226, v88, v20
  v_dot2c_f32_bf16 v224, v81, v20
  v_dot2c_f32_bf16 v225, v85, v20
  v_dot2c_f32_bf16 v226, v89, v20
  v_dot2c_f32_bf16 v224, v82, v20
  v_dot2c_f32_bf16 v225, v86, v20
  v_dot2c_f32_bf16 v226, v90, v20
  v_dot2c_f32_bf16 v224, v83, v20
  v_dot2c_f32_bf16 v225, v87, v20
  v_dot2c_f32_bf16 v226, v91, v20
  s_branch LGv0_mj_t15
LGv0_m1_t15:
  v_dot2c_f32_bf16 v224, v92, v20
  v_dot2c_f32_bf16 v225, v96, v20
  v_dot2c_f32_bf16 v226, v100, v20
  v_dot2c_f32_bf16 v224, v93, v20
  v_dot2c_f32_bf16 v225, v97, v20
  v_dot2c_f32_bf16 v226, v101, v20
  v_dot2c_f32_bf16 v224, v94, v20
  v_dot2c_f32_bf16 v225, v98, v20
  v_dot2c_f32_bf16 v226, v102, v20
  v_dot2c_f32_bf16 v224, v95, v20
  v_dot2c_f32_bf16 v225, v99, v20
  v_dot2c_f32_bf16 v226, v103, v20
LGv0_mj_t15:
  s_cmp_eq_u32 s44, 0
  s_cbranch_scc0 LGv0_n1_t15
  v_dot2c_f32_bf16 v227, v40, v20
  v_dot2c_f32_bf16 v228, v40, v40
  v_dot2c_f32_bf16 v229, v41, v20
  v_dot2c_f32_bf16 v230, v41, v41
  v_dot2c_f32_bf16 v227, v42, v20
  v_dot2c_f32_bf16 v228, v42, v42
  v_dot2c_f32_bf16 v229, v43, v20
  v_dot2c_f32_bf16 v230, v43, v43
  s_branch LGv0_nj_t15
LGv0_n1_t15:
  s_cmp_eq_u32 s44, 1
  s_cbranch_scc0 LGv0_n2_t15
  v_dot2c_f32_bf16 v227, v44, v20
  v_dot2c_f32_bf16 v228, v44, v44
  v_dot2c_f32_bf16 v229, v45, v20
  v_dot2c_f32_bf16 v230, v45, v45
  v_dot2c_f32_bf16 v227, v46, v20
  v_dot2c_f32_bf16 v228, v46, v46
  v_dot2c_f32_bf16 v229, v47, v20
  v_dot2c_f32_bf16 v230, v47, v47
  s_branch LGv0_nj_t15
LGv0_n2_t15:
  s_cmp_eq_u32 s44, 2
  s_cbranch_scc0 LGv0_n3_t15
  v_dot2c_f32_bf16 v227, v48, v20
  v_dot2c_f32_bf16 v228, v48, v48
  v_dot2c_f32_bf16 v229, v49, v20
  v_dot2c_f32_bf16 v230, v49, v49
  v_dot2c_f32_bf16 v227, v50, v20
  v_dot2c_f32_bf16 v228, v50, v50
  v_dot2c_f32_bf16 v229, v51, v20
  v_dot2c_f32_bf16 v230, v51, v51
  s_branch LGv0_nj_t15
LGv0_n3_t15:
  v_dot2c_f32_bf16 v227, v52, v20
  v_dot2c_f32_bf16 v228, v52, v52
  v_dot2c_f32_bf16 v229, v53, v20
  v_dot2c_f32_bf16 v230, v53, v53
  v_dot2c_f32_bf16 v227, v54, v20
  v_dot2c_f32_bf16 v228, v54, v54
  v_dot2c_f32_bf16 v229, v55, v20
  v_dot2c_f32_bf16 v230, v55, v55
LGv0_nj_t15:
  v_mfma_f32_16x16x32_bf16 v[212:215], v[92:95], v[52:55], v[212:215]
  ds_read_b64_tr_b16 v[70:71], v10 offset:15360
  v_mfma_f32_16x16x32_bf16 v[188:191], v[92:95], v[48:51], v[188:191]
  ds_read_b64_tr_b16 v[72:73], v11 offset:12288
  v_mfma_f32_16x16x32_bf16 v[164:167], v[92:95], v[44:47], v[164:167]
  ds_read_b64_tr_b16 v[74:75], v11 offset:15360
  v_mfma_f32_16x16x32_bf16 v[140:143], v[92:95], v[40:43], v[140:143]
  ds_read_b64_tr_b16 v[76:77], v12 offset:12288
  s_add_u32 m0, s41, 2048
  s_nop 0
  buffer_load_dwordx4 v6, s[20:23], s34 offen lds
  s_add_u32 s34, s34, 110592
  s_cmp_ge_u32 s34, 2211840
  s_cselect_b32 s41, 2211840, 0
  s_sub_u32 s34, s34, s41
  s_add_u32 s39, s39, 24576
  s_cmp_ge_u32 s39, 98304
  s_cselect_b32 s39, 0, s39
  v_mfma_f32_16x16x32_bf16 v[216:219], v[96:99], v[52:55], v[216:219]
  ds_read_b64_tr_b16 v[78:79], v12 offset:15360
  v_mfma_f32_16x16x32_bf16 v[192:195], v[96:99], v[48:51], v[192:195]
  s_add_u32 s54, s54, 24576
  s_cmp_ge_u32 s54, 98304
  s_cselect_b32 s42, 4294893568, s56
  s_cselect_b32 s54, 0, s54
  v_add_u32 v10, s42, v10
  v_add_u32 v11, s42, v11
  v_add_u32 v12, s42, v12
  v_mfma_f32_16x16x32_bf16 v[168:171], v[96:99], v[44:47], v[168:171]
  v_mfma_f32_16x16x32_bf16 v[144:147], v[96:99], v[40:43], v[144:147]
  v_mfma_f32_16x16x32_bf16 v[220:223], v[100:103], v[52:55], v[220:223]
  v_mfma_f32_16x16x32_bf16 v[196:199], v[100:103], v[48:51], v[196:199]
  v_mfma_f32_16x16x32_bf16 v[172:175], v[100:103], v[44:47], v[172:175]
  v_mfma_f32_16x16x32_bf16 v[148:151], v[100:103], v[40:43], v[148:151]
  s_waitcnt vmcnt(8) lgkmcnt(0)
  s_barrier
  v_mfma_f32_16x16x32_bf16 v[200:203], v[56:59], v[36:39], v[200:203]
  ds_read_b128 v[40:43], v14 offset:0
  v_mfma_f32_16x16x32_bf16 v[176:179], v[56:59], v[32:35], v[176:179]
  ds_read_b128 v[44:47], v14 offset:2048
  v_mfma_f32_16x16x32_bf16 v[152:155], v[56:59], v[28:31], v[152:155]
  ds_read_b128 v[48:51], v14 offset:4096
  v_mfma_f32_16x16x32_bf16 v[128:131], v[56:59], v[24:27], v[128:131]
  ds_read_b128 v[52:55], v14 offset:6144
  v_mfma_f32_16x16x32_bf16 v[204:207], v[60:63], v[36:39], v[204:207]
  ds_read_b64_tr_b16 v[80:81], v10 offset:0
  v_mfma_f32_16x16x32_bf16 v[180:183], v[60:63], v[32:35], v[180:183]
  ds_read_b64_tr_b16 v[82:83], v10 offset:3072
  v_mfma_f32_16x16x32_bf16 v[156:159], v[60:63], v[28:31], v[156:159]
  ds_read_b64_tr_b16 v[84:85], v11 offset:0
  v_mfma_f32_16x16x32_bf16 v[132:135], v[60:63], v[24:27], v[132:135]
  ds_read_b64_tr_b16 v[86:87], v11 offset:3072
  v_mfma_f32_16x16x32_bf16 v[208:211], v[64:67], v[36:39], v[208:211]
  ds_read_b64_tr_b16 v[88:89], v12 offset:0
  v_mfma_f32_16x16x32_bf16 v[184:187], v[64:67], v[32:35], v[184:187]
  ds_read_b64_tr_b16 v[90:91], v12 offset:3072
  v_mfma_f32_16x16x32_bf16 v[160:163], v[64:67], v[28:31], v[160:163]
  ds_read_b64_tr_b16 v[92:93], v10 offset:12288
  v_mfma_f32_16x16x32_bf16 v[136:139], v[64:67], v[24:27], v[136:139]
  ds_read_b64_tr_b16 v[94:95], v10 offset:15360
  s_cmp_eq_u32 s43, 0
  s_cbranch_scc0 LGv0_m1_t16
  v_dot2c_f32_bf16 v224, v56, v20
  v_dot2c_f32_bf16 v225, v60, v20
  v_dot2c_f32_bf16 v226, v64, v20
  v_dot2c_f32_bf16 v224, v57, v20
  v_dot2c_f32_bf16 v225, v61, v20
  v_dot2c_f32_bf16 v226, v65, v20
  v_dot2c_f32_bf16 v224, v58, v20
  v_dot2c_f32_bf16 v225, v62, v20
  v_dot2c_f32_bf16 v226, v66, v20
  v_dot2c_f32_bf16 v224, v59, v20
  v_dot2c_f32_bf16 v225, v63, v20
  v_dot2c_f32_bf16 v226, v67, v20
  s_branch LGv0_mj_t16
LGv0_m1_t16:
  v_dot2c_f32_bf16 v224, v68, v20
  v_dot2c_f32_bf16 v225, v72, v20
  v_dot2c_f32_bf16 v226, v76, v20
  v_dot2c_f32_bf16 v224, v69, v20
  v_dot2c_f32_bf16 v225, v73, v20
  v_dot2c_f32_bf16 v226, v77, v20
  v_dot2c_f32_bf16 v224, v70, v20
  v_dot2c_f32_bf16 v225, v74, v20
  v_dot2c_f32_bf16 v226, v78, v20
  v_dot2c_f32_bf16 v224, v71, v20
  v_dot2c_f32_bf16 v225, v75, v20
  v_dot2c_f32_bf16 v226, v79, v20
LGv0_mj_t16:
  s_cmp_eq_u32 s44, 0
  s_cbranch_scc0 LGv0_n1_t16
  v_dot2c_f32_bf16 v227, v24, v20
  v_dot2c_f32_bf16 v228, v24, v24
  v_dot2c_f32_bf16 v229, v25, v20
  v_dot2c_f32_bf16 v230, v25, v25
  v_dot2c_f32_bf16 v227, v26, v20
  v_dot2c_f32_bf16 v228, v26, v26
  v_dot2c_f32_bf16 v229, v27, v20
  v_dot2c_f32_bf16 v230, v27, v27
  s_branch LGv0_nj_t16
LGv0_n1_t16:
  s_cmp_eq_u32 s44, 1
  s_cbranch_scc0 LGv0_n2_t16
  v_dot2c_f32_bf16 v227, v28, v20
  v_dot2c_f32_bf16 v228, v28, v28
  v_dot2c_f32_bf16 v229, v29, v20
  v_dot2c_f32_bf16 v230, v29, v29
  v_dot2c_f32_bf16 v227, v30, v20
  v_dot2c_f32_bf16 v228, v30, v30
  v_dot2c_f32_bf16 v229, v31, v20
  v_dot2c_f32_bf16 v230, v31, v31
  s_branch LGv0_nj_t16
LGv0_n2_t16:
  s_cmp_eq_u32 s44, 2
  s_cbranch_scc0 LGv0_n3_t16
  v_dot2c_f32_bf16 v227, v32, v20
  v_dot2c_f32_bf16 v228, v32, v32
  v_dot2c_f32_bf16 v229, v33, v20
  v_dot2c_f32_bf16 v230, v33, v33
  v_dot2c_f32_bf16 v227, v34, v20
  v_dot2c_f32_bf16 v228, v34, v34
  v_dot2c_f32_bf16 v229, v35, v20
  v_dot2c_f32_bf16 v230, v35, v35
  s_branch LGv0_nj_t16
LGv0_n3_t16:
  v_dot2c_f32_bf16 v227, v36, v20
  v_dot2c_f32_bf16 v228, v36, v36
  v_dot2c_f32_bf16 v229, v37, v20
  v_dot2c_f32_bf16 v230, v37, v37
  v_dot2c_f32_bf16 v227, v38, v20
  v_dot2c_f32_bf16 v228, v38, v38
  v_dot2c_f32_bf16 v229, v39, v20
  v_dot2c_f32_bf16 v230, v39, v39
LGv0_nj_t16:
  v_mfma_f32_16x16x32_bf16 v[212:215], v[68:71], v[36:39], v[212:215]
  ds_read_b64_tr_b16 v[96:97], v11 offset:12288
  v_mfma_f32_16x16x32_bf16 v[188:191], v[68:71], v[32:35], v[188:191]
  ds_read_b64_tr_b16 v[98:99], v11 offset:15360
  v_mfma_f32_16x16x32_bf16 v[164:167], v[68:71], v[28:31], v[164:167]
  ds_read_b64_tr_b16 v[100:101], v12 offset:12288
  v_mfma_f32_16x16x32_bf16 v[140:143], v[68:71], v[24:27], v[140:143]
  ds_read_b64_tr_b16 v[102:103], v12 offset:15360
  v_mfma_f32_16x16x32_bf16 v[216:219], v[72:75], v[36:39], v[216:219]
  s_add_u32 s54, s54, 24576
  s_cmp_ge_u32 s54, 98304
  s_cselect_b32 s42, 4294893568, s56
  s_cselect_b32 s54, 0, s54
  v_add_u32 v10, s42, v10
  v_add_u32 v11, s42, v11
  v_add_u32 v12, s42, v12
  v_mfma_f32_16x16x32_bf16 v[192:195], v[72:75], v[32:35], v[192:195]
  v_mfma_f32_16x16x32_bf16 v[168:171], v[72:75], v[28:31], v[168:171]
  v_mfma_f32_16x16x32_bf16 v[144:147], v[72:75], v[24:27], v[144:147]
  v_mfma_f32_16x16x32_bf16 v[220:223], v[76:79], v[36:39], v[220:223]
  v_mfma_f32_16x16x32_bf16 v[196:199], v[76:79], v[32:35], v[196:199]
  v_mfma_f32_16x16x32_bf16 v[172:175], v[76:79], v[28:31], v[172:175]
  v_mfma_f32_16x16x32_bf16 v[148:151], v[76:79], v[24:27], v[148:151]
  s_waitcnt vmcnt(3) lgkmcnt(0)
  s_barrier
  v_mfma_f32_16x16x32_bf16 v[200:203], v[80:83], v[52:55], v[200:203]
  s_add_u32 s55, s55, 16384
  s_cmp_ge_u32 s55, 49152
  s_cselect_b32 s42, 4294934528, s57
  s_cselect_b32 s55, 0, s55
  v_add_u32 v13, s42, v13
  v_add_u32 v14, s42, v14
  v_mfma_f32_16x16x32_bf16 v[176:179], v[80:83], v[48:51], v[176:179]
  ds_read_b128 v[24:27], v13 offset:0
  v_mfma_f32_16x16x32_bf16 v[152:155], v[80:83], v[44:47], v[152:155]
  ds_read_b128 v[28:31], v13 offset:2048
  v_mfma_f32_16x16x32_bf16 v[128:131], v[80:83], v[40:43], v[128:131]
  ds_read_b128 v[32:35], v13 offset:4096
  v_mfma_f32_16x16x32_bf16 v[204:207], v[84:87], v[52:55], v[204:207]
  ds_read_b128 v[36:39], v13 offset:6144
  v_mfma_f32_16x16x32_bf16 v[180:183], v[84:87], v[48:51], v[180:183]
  ds_read_b64_tr_b16 v[56:57], v10 offset:0
  v_mfma_f32_16x16x32_bf16 v[156:159], v[84:87], v[44:47], v[156:159]
  ds_read_b64_tr_b16 v[58:59], v10 offset:3072
  v_mfma_f32_16x16x32_bf16 v[132:135], v[84:87], v[40:43], v[132:135]
  ds_read_b64_tr_b16 v[60:61], v11 offset:0
  v_mfma_f32_16x16x32_bf16 v[208:211], v[88:91], v[52:55], v[208:211]
  ds_read_b64_tr_b16 v[62:63], v11 offset:3072
  v_mfma_f32_16x16x32_bf16 v[184:187], v[88:91], v[48:51], v[184:187]
  ds_read_b64_tr_b16 v[64:65], v12 offset:0
  v_mfma_f32_16x16x32_bf16 v[160:163], v[88:91], v[44:47], v[160:163]
  ds_read_b64_tr_b16 v[66:67], v12 offset:3072
  v_mfma_f32_16x16x32_bf16 v[136:139], v[88:91], v[40:43], v[136:139]
  ds_read_b64_tr_b16 v[68:69], v10 offset:12288
  s_cmp_eq_u32 s43, 0
  s_cbranch_scc0 LGv0_m1_t17
  v_dot2c_f32_bf16 v224, v80, v20
  v_dot2c_f32_bf16 v225, v84, v20
  v_dot2c_f32_bf16 v226, v88, v20
  v_dot2c_f32_bf16 v224, v81, v20
  v_dot2c_f32_bf16 v225, v85, v20
  v_dot2c_f32_bf16 v226, v89, v20
  v_dot2c_f32_bf16 v224, v82, v20
  v_dot2c_f32_bf16 v225, v86, v20
  v_dot2c_f32_bf16 v226, v90, v20
  v_dot2c_f32_bf16 v224, v83, v20
  v_dot2c_f32_bf16 v225, v87, v20
  v_dot2c_f32_bf16 v226, v91, v20
  s_branch LGv0_mj_t17
LGv0_m1_t17:
  v_dot2c_f32_bf16 v224, v92, v20
  v_dot2c_f32_bf16 v225, v96, v20
  v_dot2c_f32_bf16 v226, v100, v20
  v_dot2c_f32_bf16 v224, v93, v20
  v_dot2c_f32_bf16 v225, v97, v20
  v_dot2c_f32_bf16 v226, v101, v20
  v_dot2c_f32_bf16 v224, v94, v20
  v_dot2c_f32_bf16 v225, v98, v20
  v_dot2c_f32_bf16 v226, v102, v20
  v_dot2c_f32_bf16 v224, v95, v20
  v_dot2c_f32_bf16 v225, v99, v20
  v_dot2c_f32_bf16 v226, v103, v20
LGv0_mj_t17:
  s_cmp_eq_u32 s44, 0
  s_cbranch_scc0 LGv0_n1_t17
  v_dot2c_f32_bf16 v227, v40, v20
  v_dot2c_f32_bf16 v228, v40, v40
  v_dot2c_f32_bf16 v229, v41, v20
  v_dot2c_f32_bf16 v230, v41, v41
  v_dot2c_f32_bf16 v227, v42, v20
  v_dot2c_f32_bf16 v228, v42, v42
  v_dot2c_f32_bf16 v229, v43, v20
  v_dot2c_f32_bf16 v230, v43, v43
  s_branch LGv0_nj_t17
LGv0_n1_t17:
  s_cmp_eq_u32 s44, 1
  s_cbranch_scc0 LGv0_n2_t17
  v_dot2c_f32_bf16 v227, v44, v20
  v_dot2c_f32_bf16 v228, v44, v44
  v_dot2c_f32_bf16 v229, v45, v20
  v_dot2c_f32_bf16 v230, v45, v45
  v_dot2c_f32_bf16 v227, v46, v20
  v_dot2c_f32_bf16 v228, v46, v46
  v_dot2c_f32_bf16 v229, v47, v20
  v_dot2c_f32_bf16 v230, v47, v47
  s_branch LGv0_nj_t17
LGv0_n2_t17:
  s_cmp_eq_u32 s44, 2
  s_cbranch_scc0 LGv0_n3_t17
  v_dot2c_f32_bf16 v227, v48, v20
  v_dot2c_f32_bf16 v228, v48, v48
  v_dot2c_f32_bf16 v229, v49, v20
  v_dot2c_f32_bf16 v230, v49, v49
  v_dot2c_f32_bf16 v227, v50, v20
  v_dot2c_f32_bf16 v228, v50, v50
  v_dot2c_f32_bf16 v229, v51, v20
  v_dot2c_f32_bf16 v230, v51, v51
  s_branch LGv0_nj_t17
LGv0_n3_t17:
  v_dot2c_f32_bf16 v227, v52, v20
  v_dot2c_f32_bf16 v228, v52, v52
  v_dot2c_f32_bf16 v229, v53, v20
  v_dot2c_f32_bf16 v230, v53, v53
  v_dot2c_f32_bf16 v227, v54, v20
  v_dot2c_f32_bf16 v228, v54, v54
  v_dot2c_f32_bf16 v229, v55, v20
  v_dot2c_f32_bf16 v230, v55, v55
LGv0_nj_t17:
  v_mfma_f32_16x16x32_bf16 v[212:215], v[92:95], v[52:55], v[212:215]
  ds_read_b64_tr_b16 v[70:71], v10 offset:15360
  v_mfma_f32_16x16x32_bf16 v[188:191], v[92:95], v[48:51], v[188:191]
  ds_read_b64_tr_b16 v[72:73], v11 offset:12288
  v_mfma_f32_16x16x32_bf16 v[164:167], v[92:95], v[44:47], v[164:167]
  ds_read_b64_tr_b16 v[74:75], v11 offset:15360
  v_mfma_f32_16x16x32_bf16 v[140:143], v[92:95], v[40:43], v[140:143]
  ds_read_b64_tr_b16 v[76:77], v12 offset:12288
  v_mfma_f32_16x16x32_bf16 v[216:219], v[96:99], v[52:55], v[216:219]
  ds_read_b64_tr_b16 v[78:79], v12 offset:15360
  v_mfma_f32_16x16x32_bf16 v[192:195], v[96:99], v[48:51], v[192:195]
  s_add_u32 s54, s54, 24576
  s_cmp_ge_u32 s54, 98304
  s_cselect_b32 s42, 4294893568, s56
  s_cselect_b32 s54, 0, s54
  v_add_u32 v10, s42, v10
  v_add_u32 v11, s42, v11
  v_add_u32 v12, s42, v12
  v_mfma_f32_16x16x32_bf16 v[168:171], v[96:99], v[44:47], v[168:171]
  v_mfma_f32_16x16x32_bf16 v[144:147], v[96:99], v[40:43], v[144:147]
  v_mfma_f32_16x16x32_bf16 v[220:223], v[100:103], v[52:55], v[220:223]
  v_mfma_f32_16x16x32_bf16 v[196:199], v[100:103], v[48:51], v[196:199]
  v_mfma_f32_16x16x32_bf16 v[172:175], v[100:103], v[44:47], v[172:175]
  v_mfma_f32_16x16x32_bf16 v[148:151], v[100:103], v[40:43], v[148:151]
  s_waitcnt vmcnt(0) lgkmcnt(0)
  s_barrier
  v_mfma_f32_16x16x32_bf16 v[200:203], v[56:59], v[36:39], v[200:203]
  ds_read_b128 v[40:43], v14 offset:0
  v_mfma_f32_16x16x32_bf16 v[176:179], v[56:59], v[32:35], v[176:179]
  ds_read_b128 v[44:47], v14 offset:2048
  v_mfma_f32_16x16x32_bf16 v[152:155], v[56:59], v[28:31], v[152:155]
  ds_read_b128 v[48:51], v14 offset:4096
  v_mfma_f32_16x16x32_bf16 v[128:131], v[56:59], v[24:27], v[128:131]
  ds_read_b128 v[52:55], v14 offset:6144
  v_mfma_f32_16x16x32_bf16 v[204:207], v[60:63], v[36:39], v[204:207]
  ds_read_b64_tr_b16 v[80:81], v10 offset:0
  v_mfma_f32_16x16x32_bf16 v[180:183], v[60:63], v[32:35], v[180:183]
  ds_read_b64_tr_b16 v[82:83], v10 offset:3072
  v_mfma_f32_16x16x32_bf16 v[156:159], v[60:63], v[28:31], v[156:159]
  ds_read_b64_tr_b16 v[84:85], v11 offset:0
  v_mfma_f32_16x16x32_bf16 v[132:135], v[60:63], v[24:27], v[132:135]
  ds_read_b64_tr_b16 v[86:87], v11 offset:3072
  v_mfma_f32_16x16x32_bf16 v[208:211], v[64:67], v[36:39], v[208:211]
  ds_read_b64_tr_b16 v[88:89], v12 offset:0
  v_mfma_f32_16x16x32_bf16 v[184:187], v[64:67], v[32:35], v[184:187]
  ds_read_b64_tr_b16 v[90:91], v12 offset:3072
  v_mfma_f32_16x16x32_bf16 v[160:163], v[64:67], v[28:31], v[160:163]
  ds_read_b64_tr_b16 v[92:93], v10 offset:12288
  v_mfma_f32_16x16x32_bf16 v[136:139], v[64:67], v[24:27], v[136:139]
  ds_read_b64_tr_b16 v[94:95], v10 offset:15360
  s_cmp_eq_u32 s43, 0
  s_cbranch_scc0 LGv0_m1_t18
  v_dot2c_f32_bf16 v224, v56, v20
  v_dot2c_f32_bf16 v225, v60, v20
  v_dot2c_f32_bf16 v226, v64, v20
  v_dot2c_f32_bf16 v224, v57, v20
  v_dot2c_f32_bf16 v225, v61, v20
  v_dot2c_f32_bf16 v226, v65, v20
  v_dot2c_f32_bf16 v224, v58, v20
  v_dot2c_f32_bf16 v225, v62, v20
  v_dot2c_f32_bf16 v226, v66, v20
  v_dot2c_f32_bf16 v224, v59, v20
  v_dot2c_f32_bf16 v225, v63, v20
  v_dot2c_f32_bf16 v226, v67, v20
  s_branch LGv0_mj_t18
LGv0_m1_t18:
  v_dot2c_f32_bf16 v224, v68, v20
  v_dot2c_f32_bf16 v225, v72, v20
  v_dot2c_f32_bf16 v226, v76, v20
  v_dot2c_f32_bf16 v224, v69, v20
  v_dot2c_f32_bf16 v225, v73, v20
  v_dot2c_f32_bf16 v226, v77, v20
  v_dot2c_f32_bf16 v224, v70, v20
  v_dot2c_f32_bf16 v225, v74, v20
  v_dot2c_f32_bf16 v226, v78, v20
  v_dot2c_f32_bf16 v224, v71, v20
  v_dot2c_f32_bf16 v225, v75, v20
  v_dot2c_f32_bf16 v226, v79, v20
LGv0_mj_t18:
  s_cmp_eq_u32 s44, 0
  s_cbranch_scc0 LGv0_n1_t18
  v_dot2c_f32_bf16 v227, v24, v20
  v_dot2c_f32_bf16 v228, v24, v24
  v_dot2c_f32_bf16 v229, v25, v20
  v_dot2c_f32_bf16 v230, v25, v25
  v_dot2c_f32_bf16 v227, v26, v20
  v_dot2c_f32_bf16 v228, v26, v26
  v_dot2c_f32_bf16 v229, v27, v20
  v_dot2c_f32_bf16 v230, v27, v27
  s_branch LGv0_nj_t18
LGv0_n1_t18:
  s_cmp_eq_u32 s44, 1
  s_cbranch_scc0 LGv0_n2_t18
  v_dot2c_f32_bf16 v227, v28, v20
  v_dot2c_f32_bf16 v228, v28, v28
  v_dot2c_f32_bf16 v229, v29, v20
  v_dot2c_f32_bf16 v230, v29, v29
  v_dot2c_f32_bf16 v227, v30, v20
  v_dot2c_f32_bf16 v228, v30, v30
  v_dot2c_f32_bf16 v229, v31, v20
  v_dot2c_f32_bf16 v230, v31, v31
  s_branch LGv0_nj_t18
LGv0_n2_t18:
  s_cmp_eq_u32 s44, 2
  s_cbranch_scc0 LGv0_n3_t18
  v_dot2c_f32_bf16 v227, v32, v20
  v_dot2c_f32_bf16 v228, v32, v32
  v_dot2c_f32_bf16 v229, v33, v20
  v_dot2c_f32_bf16 v230, v33, v33
  v_dot2c_f32_bf16 v227, v34, v20
  v_dot2c_f32_bf16 v228, v34, v34
  v_dot2c_f32_bf16 v229, v35, v20
  v_dot2c_f32_bf16 v230, v35, v35
  s_branch LGv0_nj_t18
LGv0_n3_t18:
  v_dot2c_f32_bf16 v227, v36, v20
  v_dot2c_f32_bf16 v228, v36, v36
  v_dot2c_f32_bf16 v229, v37, v20
  v_dot2c_f32_bf16 v230, v37, v37
  v_dot2c_f32_bf16 v227, v38, v20
  v_dot2c_f32_bf16 v228, v38, v38
  v_dot2c_f32_bf16 v229, v39, v20
  v_dot2c_f32_bf16 v230, v39, v39
LGv0_nj_t18:
  v_mfma_f32_16x16x32_bf16 v[212:215], v[68:71], v[36:39], v[212:215]
  ds_read_b64_tr_b16 v[96:97], v11 offset:12288
  v_mfma_f32_16x16x32_bf16 v[188:191], v[68:71], v[32:35], v[188:191]
  ds_read_b64_tr_b16 v[98:99], v11 offset:15360
  v_mfma_f32_16x16x32_bf16 v[164:167], v[68:71], v[28:31], v[164:167]
  ds_read_b64_tr_b16 v[100:101], v12 offset:12288
  v_mfma_f32_16x16x32_bf16 v[140:143], v[68:71], v[24:27], v[140:143]
  ds_read_b64_tr_b16 v[102:103], v12 offset:15360
  v_mfma_f32_16x16x32_bf16 v[216:219], v[72:75], v[36:39], v[216:219]
  s_add_u32 s54, s54, 24576
  s_cmp_ge_u32 s54, 98304
  s_cselect_b32 s42, 4294893568, s56
  s_cselect_b32 s54, 0, s54
  v_add_u32 v10, s42, v10
  v_add_u32 v11, s42, v11
  v_add_u32 v12, s42, v12
  v_mfma_f32_16x16x32_bf16 v[192:195], v[72:75], v[32:35], v[192:195]
  v_mfma_f32_16x16x32_bf16 v[168:171], v[72:75], v[28:31], v[168:171]
  v_mfma_f32_16x16x32_bf16 v[144:147], v[72:75], v[24:27], v[144:147]
  v_mfma_f32_16x16x32_bf16 v[220:223], v[76:79], v[36:39], v[220:223]
  v_mfma_f32_16x16x32_bf16 v[196:199], v[76:79], v[32:35], v[196:199]
  v_mfma_f32_16x16x32_bf16 v[172:175], v[76:79], v[28:31], v[172:175]
  v_mfma_f32_16x16x32_bf16 v[148:151], v[76:79], v[24:27], v[148:151]
  s_waitcnt lgkmcnt(0)
  s_cmp_eq_u32 s43, 0
  s_cbranch_scc0 LG_m1_t19
  v_dot2c_f32_bf16 v224, v80, v20
  v_dot2c_f32_bf16 v225, v84, v20
  v_dot2c_f32_bf16 v226, v88, v20
  v_dot2c_f32_bf16 v224, v81, v20
  v_dot2c_f32_bf16 v225, v85, v20
  v_dot2c_f32_bf16 v226, v89, v20
  v_dot2c_f32_bf16 v224, v82, v20
  v_dot2c_f32_bf16 v225, v86, v20
  v_dot2c_f32_bf16 v226, v90, v20
  v_dot2c_f32_bf16 v224, v83, v20
  v_dot2c_f32_bf16 v225, v87, v20
  v_dot2c_f32_bf16 v226, v91, v20
  s_branch LG_mj_t19
LG_m1_t19:
  v_dot2c_f32_bf16 v224, v92, v20
  v_dot2c_f32_bf16 v225, v96, v20
  v_dot2c_f32_bf16 v226, v100, v20
  v_dot2c_f32_bf16 v224, v93, v20
  v_dot2c_f32_bf16 v225, v97, v20
  v_dot2c_f32_bf16 v226, v101, v20
  v_dot2c_f32_bf16 v224, v94, v20
  v_dot2c_f32_bf16 v225, v98, v20
  v_dot2c_f32_bf16 v226, v102, v20
  v_dot2c_f32_bf16 v224, v95, v20
  v_dot2c_f32_bf16 v225, v99, v20
  v_dot2c_f32_bf16 v226, v103, v20
LG_mj_t19:
  s_cmp_eq_u32 s44, 0
  s_cbranch_scc0 LG_n1_t19
  v_dot2c_f32_bf16 v227, v40, v20
  v_dot2c_f32_bf16 v228, v40, v40
  v_dot2c_f32_bf16 v229, v41, v20
  v_dot2c_f32_bf16 v230, v41, v41
  v_dot2c_f32_bf16 v227, v42, v20
  v_dot2c_f32_bf16 v228, v42, v42
  v_dot2c_f32_bf16 v229, v43, v20
  v_dot2c_f32_bf16 v230, v43, v43
  s_branch LG_nj_t19
LG_n1_t19:
  s_cmp_eq_u32 s44, 1
  s_cbranch_scc0 LG_n2_t19
  v_dot2c_f32_bf16 v227, v44, v20
  v_dot2c_f32_bf16 v228, v44, v44
  v_dot2c_f32_bf16 v229, v45, v20
  v_dot2c_f32_bf16 v230, v45, v45
  v_dot2c_f32_bf16 v227, v46, v20
  v_dot2c_f32_bf16 v228, v46, v46
  v_dot2c_f32_bf16 v229, v47, v20
  v_dot2c_f32_bf16 v230, v47, v47
  s_branch LG_nj_t19
LG_n2_t19:
  s_cmp_eq_u32 s44, 2
  s_cbranch_scc0 LG_n3_t19
  v_dot2c_f32_bf16 v227, v48, v20
  v_dot2c_f32_bf16 v228, v48, v48
  v_dot2c_f32_bf16 v229, v49, v20
  v_dot2c_f32_bf16 v230, v49, v49
  v_dot2c_f32_bf16 v227, v50, v20
  v_dot2c_f32_bf16 v228, v50, v50
  v_dot2c_f32_bf16 v229, v51, v20
  v_dot2c_f32_bf16 v230, v51, v51
  s_branch LG_nj_t19
LG_n3_t19:
  v_dot2c_f32_bf16 v227, v52, v20
  v_dot2c_f32_bf16 v228, v52, v52
  v_dot2c_f32_bf16 v229, v53, v20
  v_dot2c_f32_bf16 v230, v53, v53
  v_dot2c_f32_bf16 v227, v54, v20
  v_dot2c_f32_bf16 v228, v54, v54
  v_dot2c_f32_bf16 v229, v55, v20
  v_dot2c_f32_bf16 v230, v55, v55
LG_nj_t19:
  v_mfma_f32_16x16x32_bf16 v[200:203], v[80:83], v[52:55], v[200:203]
  v_mfma_f32_16x16x32_bf16 v[176:179], v[80:83], v[48:51], v[176:179]
  v_mfma_f32_16x16x32_bf16 v[152:155], v[80:83], v[44:47], v[152:155]
  v_lshlrev_b32 v15, 6, v2
  v_lshl_add_u32 v15, v3, 4, v15
  v_lshlrev_b32 v16, 2, v2
  v_lshlrev_b32 v17, 4, v3
  s_nop 7
  s_lshl_b32 s41, s43, 2
  s_add_u32 s41, s41, s44
  s_lshl_b32 s42, s41, 10
  s_add_u32 s42, s42, 147456
  v_add_u32 v15, s42, v15
  v_add_f32 v227, v227, v229
  v_add_f32 v228, v228, v230
  v_mov_b32 v232, v224
  v_mov_b32 v233, v225
  v_mov_b32 v234, v226
  v_mov_b32 v235, v227
  v_mov_b32 v236, v228
  s_nop 0
  v_permlane32_swap_b32 v224, v232
  v_permlane32_swap_b32 v225, v233
  v_permlane32_swap_b32 v226, v234
  v_permlane32_swap_b32 v227, v235
  v_permlane32_swap_b32 v228, v236
  s_nop 0
  v_add_f32 v224, v224, v232
  v_add_f32 v225, v225, v233
  v_add_f32 v226, v226, v234
  v_add_f32 v227, v227, v235
  v_add_f32 v228, v228, v236
  v_mov_b32 v232, v224
  v_mov_b32 v233, v225
  v_mov_b32 v234, v226
  v_mov_b32 v235, v227
  v_mov_b32 v236, v228
  s_nop 0
  v_permlane16_swap_b32 v224, v232
  v_permlane16_swap_b32 v225, v233
  v_permlane16_swap_b32 v226, v234
  v_permlane16_swap_b32 v227, v235
  v_permlane16_swap_b32 v228, v236
  s_nop 0
  v_add_f32 v224, v224, v232
  v_add_f32 v225, v225, v233
  v_add_f32 v226, v226, v234
  v_add_f32 v227, v227, v235
  v_add_f32 v228, v228, v236
  v_mul_u32_u24 v15, 68, v2
  v_add_u32 v15, s42, v15
  ds_write_b32 v15, v228
  s_lshl_b32 s42, s41, 6
  s_add_u32 s42, s42, 155648
  v_add_u32 v19, s42, v16
  ds_write_b32 v19, v227
  s_mul_i32 s41, s44, 6
  s_mul_i32 s42, s43, 3
  s_add_u32 s42, s42, s41
  s_lshl_b32 s42, s42, 6
  s_add_u32 s42, s42, 156160
  v_add_u32 v18, s42, v16
  ds_write_b32 v18, v224 offset:0
  ds_write_b32 v18, v225 offset:64
  ds_write_b32 v18, v226 offset:128
  v_mfma_f32_16x16x32_bf16 v[128:131], v[80:83], v[40:43], v[128:131]
  v_mfma_f32_16x16x32_bf16 v[204:207], v[84:87], v[52:55], v[204:207]
  v_mfma_f32_16x16x32_bf16 v[180:183], v[84:87], v[48:51], v[180:183]
  v_mfma_f32_16x16x32_bf16 v[156:159], v[84:87], v[44:47], v[156:159]
  v_mfma_f32_16x16x32_bf16 v[132:135], v[84:87], v[40:43], v[132:135]
  s_waitcnt lgkmcnt(0)
  s_barrier
  s_lshl_b32 s41, s41, 6
  s_add_u32 s41, s41, 156160
  v_add_u32 v18, s41, v17
  s_mul_i32 s41, s43, 4
  s_lshl_b32 s42, s41, 10
  s_add_u32 s42, s42, 147456
  v_mul_u32_u24 v15, 68, v2
  v_add_u32 v15, s42, v15
  s_lshl_b32 s42, s41, 6
  s_add_u32 s42, s42, 155648
  v_lshlrev_b32 v16, 2, v2
  v_add_u32 v16, s42, v16
  ds_read_b32 v104, v15 offset:0
  ds_read_b32 v112, v16 offset:0
  ds_read_b32 v106, v15 offset:1024
  ds_read_b32 v114, v16 offset:64
  ds_read_b32 v108, v15 offset:2048
  ds_read_b32 v116, v16 offset:128
  ds_read_b32 v110, v15 offset:3072
  ds_read_b32 v118, v16 offset:192
  ds_read_b128 v[56:59], v18 offset:0
  ds_read_b128 v[60:63], v18 offset:64
  ds_read_b128 v[64:67], v18 offset:128
  ds_read_b128 v[68:71], v18 offset:192
  ds_read_b128 v[72:75], v18 offset:256
  ds_read_b128 v[76:79], v18 offset:320
  s_mov_b32 s41, 0x3acccccd
  v_mfma_f32_16x16x32_bf16 v[208:211], v[88:91], v[52:55], v[208:211]
  v_mfma_f32_16x16x32_bf16 v[184:187], v[88:91], v[48:51], v[184:187]
  v_mfma_f32_16x16x32_bf16 v[160:163], v[88:91], v[44:47], v[160:163]
  v_mfma_f32_16x16x32_bf16 v[136:139], v[88:91], v[40:43], v[136:139]
  s_waitcnt lgkmcnt(6)
  v_mul_f32 v112, s41, v112
  v_mul_f32 v114, s41, v114
  v_mul_f32 v116, s41, v116
  v_mul_f32 v118, s41, v118
  v_mul_f32 v104, s41, v104
  v_mul_f32 v106, s41, v106
  v_mfma_f32_16x16x32_bf16 v[212:215], v[92:95], v[52:55], v[212:215]
  v_mul_f32 v108, s41, v108
  v_mul_f32 v110, s41, v110
  v_fma_f32 v104, -v112, v112, v104
  v_fma_f32 v106, -v114, v114, v106
  v_fma_f32 v108, -v116, v116, v108
  v_fma_f32 v110, -v118, v118, v110
  v_max_f32 v104, 0, v104
  v_mfma_f32_16x16x32_bf16 v[188:191], v[92:95], v[48:51], v[188:191]
  v_max_f32 v106, 0, v106
  v_max_f32 v108, 0, v108
  v_max_f32 v110, 0, v110
  v_cvt_pk_bf16_f32 v120, v104, v112
  v_cvt_pk_bf16_f32 v122, v106, v114
  v_cvt_pk_bf16_f32 v124, v108, v116
  v_cvt_pk_bf16_f32 v126, v110, v118
  v_mfma_f32_16x16x32_bf16 v[164:167], v[92:95], v[44:47], v[164:167]
  v_lshlrev_b32 v104, 16, v120
  v_and_b32 v112, 0xffff0000, v120
  v_lshlrev_b32 v106, 16, v122
  v_and_b32 v114, 0xffff0000, v122
  v_lshlrev_b32 v108, 16, v124
  v_and_b32 v116, 0xffff0000, v124
  v_lshlrev_b32 v110, 16, v126
  v_mfma_f32_16x16x32_bf16 v[140:143], v[92:95], v[40:43], v[140:143]
  v_and_b32 v118, 0xffff0000, v126
  v_add_f32 v104, 0x3727c5ac, v104
  v_add_f32 v106, 0x3727c5ac, v106
  v_add_f32 v108, 0x3727c5ac, v108
  v_add_f32 v110, 0x3727c5ac, v110
  v_cvt_pk_bf16_f32 v120, v104, v104
  v_cvt_pk_bf16_f32 v122, v106, v106
  v_mfma_f32_16x16x32_bf16 v[216:219], v[96:99], v[52:55], v[216:219]
  v_cvt_pk_bf16_f32 v124, v108, v108
  v_cvt_pk_bf16_f32 v126, v110, v110
  v_lshlrev_b32 v104, 16, v120
  v_lshlrev_b32 v106, 16, v122
  v_lshlrev_b32 v108, 16, v124
  v_lshlrev_b32 v110, 16, v126
  v_sqrt_f32 v104, v104
  v_mfma_f32_16x16x32_bf16 v[192:195], v[96:99], v[48:51], v[192:195]
  v_sqrt_f32 v106, v106
  v_sqrt_f32 v108, v108
  v_sqrt_f32 v110, v110
  s_nop 0
  v_cvt_pk_bf16_f32 v120, v104, v104
  v_cvt_pk_bf16_f32 v122, v106, v106
  v_cvt_pk_bf16_f32 v124, v108, v108
  v_mfma_f32_16x16x32_bf16 v[168:171], v[96:99], v[44:47], v[168:171]
  v_cvt_pk_bf16_f32 v126, v110, v110
  v_lshlrev_b32 v120, 16, v120
  v_lshlrev_b32 v122, 16, v122
  v_lshlrev_b32 v124, 16, v124
  v_lshlrev_b32 v126, 16, v126
  v_rcp_f32 v104, v120
  v_rcp_f32 v106, v122
  v_mfma_f32_16x16x32_bf16 v[144:147], v[96:99], v[40:43], v[144:147]
  v_rcp_f32 v108, v124
  v_rcp_f32 v110, v126
  v_sub_f32 v112, 0, v112
  v_mov_b32 v121, v120
  v_sub_f32 v114, 0, v114
  v_mov_b32 v123, v122
  v_sub_f32 v116, 0, v116
  v_mfma_f32_16x16x32_bf16 v[220:223], v[100:103], v[52:55], v[220:223]
  v_mov_b32 v125, v124
  v_sub_f32 v118, 0, v118
  v_mov_b32 v127, v126
  v_mov_b32 v105, v104
  v_mov_b32 v113, v112
  v_mov_b32 v107, v106
  v_mov_b32 v115, v114
  v_mfma_f32_16x16x32_bf16 v[196:199], v[100:103], v[48:51], v[196:199]
  v_mov_b32 v109, v108
  v_mov_b32 v117, v116
  v_mov_b32 v111, v110
  v_mov_b32 v119, v118
  v_mfma_f32_16x16x32_bf16 v[172:175], v[100:103], v[44:47], v[172:175]
  v_mfma_f32_16x16x32_bf16 v[148:151], v[100:103], v[40:43], v[148:151]
  s_nop 7
  s_waitcnt lgkmcnt(0)
  v_mov_b32 v24, 0xc0135761
  v_mov_b32 v26, 0xbdd2d3e8
  v_mov_b32 v25, 0xc0135761
  v_mov_b32 v27, 0xbdd2d3e8
  s_lshr_b32 s41, s52, 4
  s_lshl_b32 s42, s43, 2
  s_add_u32 s41, s41, s42
  s_mul_i32 s41, s41, 75776
  v_lshlrev_b32 v80, 4, v1
  v_add_u32 v80, s41, v80
  s_lshr_b32 s41, s33, 5
  s_add_u32 s41, s41, 40
  s_add_u32 s58, s41, s50
  s_lshl_b32 s58, s58, 9
  s_add_u32 s59, s41, s51
  s_and_b32 s42, s59, 1
  s_lshr_b32 s59, s59, 1
  s_lshl_b32 s59, s59, 10
  s_lshr_b32 s41, s3, 1
  s_lshl_b32 s41, s41, 12
  v_lshlrev_b32 v15, 4, v1
  v_add_u32 v15, s41, v15
  s_lshl_b32 s41, s42, 11
  v_add_u32 v16, s41, v15
  s_lshl_b32 s41, s42, 3
  v_add_u32 v15, s41, v15
  s_mul_i32 s42, s42, 151552
  s_add_u32 s59, s59, s42
  v_pk_fma_f32 v[128:129], v[56:57], v[112:113], v[128:129]
  v_pk_fma_f32 v[130:131], v[58:59], v[112:113], v[130:131]
  v_pk_fma_f32 v[132:133], v[60:61], v[112:113], v[132:133]
  v_pk_fma_f32 v[134:135], v[62:63], v[112:113], v[134:135]
  v_pk_fma_f32 v[136:137], v[64:65], v[112:113], v[136:137]
  v_pk_fma_f32 v[138:139], v[66:67], v[112:113], v[138:139]
  v_pk_mul_f32 v[128:129], v[128:129], v[104:105]
  v_pk_mul_f32 v[130:131], v[130:131], v[104:105]
  v_pk_mul_f32 v[132:133], v[132:133], v[104:105]
  v_pk_mul_f32 v[134:135], v[134:135], v[104:105]
  v_pk_mul_f32 v[136:137], v[136:137], v[104:105]
  v_pk_mul_f32 v[138:139], v[138:139], v[104:105]
  v_pk_mul_f32 v[28:29], v[128:129], v[128:129]
  v_pk_mul_f32 v[30:31], v[130:131], v[130:131]
  v_pk_mul_f32 v[32:33], v[132:133], v[132:133]
  v_pk_mul_f32 v[34:35], v[134:135], v[134:135]
  v_pk_mul_f32 v[36:37], v[136:137], v[136:137]
  v_pk_mul_f32 v[38:39], v[138:139], v[138:139]
  v_pk_fma_f32 v[28:29], v[28:29], v[26:27], v[24:25]
  v_pk_fma_f32 v[30:31], v[30:31], v[26:27], v[24:25]
  v_pk_fma_f32 v[32:33], v[32:33], v[26:27], v[24:25]
  v_pk_fma_f32 v[34:35], v[34:35], v[26:27], v[24:25]
  v_pk_fma_f32 v[36:37], v[36:37], v[26:27], v[24:25]
  v_pk_fma_f32 v[38:39], v[38:39], v[26:27], v[24:25]
  v_pk_mul_f32 v[28:29], v[28:29], v[128:129]
  v_pk_mul_f32 v[30:31], v[30:31], v[130:131]
  v_pk_mul_f32 v[32:33], v[32:33], v[132:133]
  v_pk_mul_f32 v[34:35], v[34:35], v[134:135]
  v_pk_mul_f32 v[36:37], v[36:37], v[136:137]
  v_pk_mul_f32 v[38:39], v[38:39], v[138:139]
  v_exp_f32 v28, v28
  v_exp_f32 v29, v29
  v_exp_f32 v30, v30
  v_exp_f32 v31, v31
  v_exp_f32 v32, v32
  v_exp_f32 v33, v33
  v_exp_f32 v34, v34
  v_exp_f32 v35, v35
  v_exp_f32 v36, v36
  v_exp_f32 v37, v37
  v_exp_f32 v38, v38
  v_exp_f32 v39, v39
  v_pk_fma_f32 v[140:141], v[68:69], v[112:113], v[140:141]
  v_pk_fma_f32 v[142:143], v[70:71], v[112:113], v[142:143]
  v_pk_fma_f32 v[144:145], v[72:73], v[112:113], v[144:145]
  v_pk_fma_f32 v[146:147], v[74:75], v[112:113], v[146:147]
  v_pk_fma_f32 v[148:149], v[76:77], v[112:113], v[148:149]
  v_pk_fma_f32 v[150:151], v[78:79], v[112:113], v[150:151]
  v_pk_fma_f32 v[28:29], v[28:29], v[120:121], v[120:121]
  v_pk_fma_f32 v[30:31], v[30:31], v[120:121], v[120:121]
  v_pk_fma_f32 v[32:33], v[32:33], v[120:121], v[120:121]
  v_pk_fma_f32 v[34:35], v[34:35], v[120:121], v[120:121]
  v_pk_fma_f32 v[36:37], v[36:37], v[120:121], v[120:121]
  v_pk_fma_f32 v[38:39], v[38:39], v[120:121], v[120:121]
  v_rcp_f32 v28, v28
  v_rcp_f32 v29, v29
  v_rcp_f32 v30, v30
  v_rcp_f32 v31, v31
  v_rcp_f32 v32, v32
  v_rcp_f32 v33, v33
  v_rcp_f32 v34, v34
  v_rcp_f32 v35, v35
  v_rcp_f32 v36, v36
  v_rcp_f32 v37, v37
  v_rcp_f32 v38, v38
  v_rcp_f32 v39, v39
  v_pk_mul_f32 v[140:141], v[140:141], v[128:129]
  v_pk_mul_f32 v[142:143], v[142:143], v[130:131]
  v_pk_mul_f32 v[144:145], v[144:145], v[132:133]
  v_pk_mul_f32 v[146:147], v[146:147], v[134:135]
  v_pk_mul_f32 v[148:149], v[148:149], v[136:137]
  v_pk_mul_f32 v[150:151], v[150:151], v[138:139]
  v_pk_mul_f32 v[140:141], v[140:141], v[28:29]
  v_pk_mul_f32 v[142:143], v[142:143], v[30:31]
  v_pk_mul_f32 v[144:145], v[144:145], v[32:33]
  v_pk_mul_f32 v[146:147], v[146:147], v[34:35]
  v_pk_mul_f32 v[148:149], v[148:149], v[36:37]
  v_pk_mul_f32 v[150:151], v[150:151], v[38:39]
  v_cvt_pk_bf16_f32 v40, v140, v141
  v_cvt_pk_bf16_f32 v41, v142, v143
  v_cvt_pk_bf16_f32 v42, v144, v145
  v_cvt_pk_bf16_f32 v43, v146, v147
  v_cvt_pk_bf16_f32 v44, v148, v149
  v_cvt_pk_bf16_f32 v45, v150, v151
  buffer_store_dwordx4 v[40:43], v80, s[28:31], s58 offen sc0 sc1
  s_add_u32 s58, s58, 75776
  ds_write_b64 v15, v[44:45] offset:0
  v_pk_fma_f32 v[152:153], v[56:57], v[114:115], v[152:153]
  v_pk_fma_f32 v[154:155], v[58:59], v[114:115], v[154:155]
  v_pk_fma_f32 v[156:157], v[60:61], v[114:115], v[156:157]
  v_pk_fma_f32 v[158:159], v[62:63], v[114:115], v[158:159]
  v_pk_fma_f32 v[160:161], v[64:65], v[114:115], v[160:161]
  v_pk_fma_f32 v[162:163], v[66:67], v[114:115], v[162:163]
  v_pk_mul_f32 v[152:153], v[152:153], v[106:107]
  v_pk_mul_f32 v[154:155], v[154:155], v[106:107]
  v_pk_mul_f32 v[156:157], v[156:157], v[106:107]
  v_pk_mul_f32 v[158:159], v[158:159], v[106:107]
  v_pk_mul_f32 v[160:161], v[160:161], v[106:107]
  v_pk_mul_f32 v[162:163], v[162:163], v[106:107]
  v_pk_mul_f32 v[28:29], v[152:153], v[152:153]
  v_pk_mul_f32 v[30:31], v[154:155], v[154:155]
  v_pk_mul_f32 v[32:33], v[156:157], v[156:157]
  v_pk_mul_f32 v[34:35], v[158:159], v[158:159]
  v_pk_mul_f32 v[36:37], v[160:161], v[160:161]
  v_pk_mul_f32 v[38:39], v[162:163], v[162:163]
  v_pk_fma_f32 v[28:29], v[28:29], v[26:27], v[24:25]
  v_pk_fma_f32 v[30:31], v[30:31], v[26:27], v[24:25]
  v_pk_fma_f32 v[32:33], v[32:33], v[26:27], v[24:25]
  v_pk_fma_f32 v[34:35], v[34:35], v[26:27], v[24:25]
  v_pk_fma_f32 v[36:37], v[36:37], v[26:27], v[24:25]
  v_pk_fma_f32 v[38:39], v[38:39], v[26:27], v[24:25]
  v_pk_mul_f32 v[28:29], v[28:29], v[152:153]
  v_pk_mul_f32 v[30:31], v[30:31], v[154:155]
  v_pk_mul_f32 v[32:33], v[32:33], v[156:157]
  v_pk_mul_f32 v[34:35], v[34:35], v[158:159]
  v_pk_mul_f32 v[36:37], v[36:37], v[160:161]
  v_pk_mul_f32 v[38:39], v[38:39], v[162:163]
  v_exp_f32 v28, v28
  v_exp_f32 v29, v29
  v_exp_f32 v30, v30
  v_exp_f32 v31, v31
  v_exp_f32 v32, v32
  v_exp_f32 v33, v33
  v_exp_f32 v34, v34
  v_exp_f32 v35, v35
  v_exp_f32 v36, v36
  v_exp_f32 v37, v37
  v_exp_f32 v38, v38
  v_exp_f32 v39, v39
  v_pk_fma_f32 v[164:165], v[68:69], v[114:115], v[164:165]
  v_pk_fma_f32 v[166:167], v[70:71], v[114:115], v[166:167]
  v_pk_fma_f32 v[168:169], v[72:73], v[114:115], v[168:169]
  v_pk_fma_f32 v[170:171], v[74:75], v[114:115], v[170:171]
  v_pk_fma_f32 v[172:173], v[76:77], v[114:115], v[172:173]
  v_pk_fma_f32 v[174:175], v[78:79], v[114:115], v[174:175]
  v_pk_fma_f32 v[28:29], v[28:29], v[122:123], v[122:123]
  v_pk_fma_f32 v[30:31], v[30:31], v[122:123], v[122:123]
  v_pk_fma_f32 v[32:33], v[32:33], v[122:123], v[122:123]
  v_pk_fma_f32 v[34:35], v[34:35], v[122:123], v[122:123]
  v_pk_fma_f32 v[36:37], v[36:37], v[122:123], v[122:123]
  v_pk_fma_f32 v[38:39], v[38:39], v[122:123], v[122:123]
  v_rcp_f32 v28, v28
  v_rcp_f32 v29, v29
  v_rcp_f32 v30, v30
  v_rcp_f32 v31, v31
  v_rcp_f32 v32, v32
  v_rcp_f32 v33, v33
  v_rcp_f32 v34, v34
  v_rcp_f32 v35, v35
  v_rcp_f32 v36, v36
  v_rcp_f32 v37, v37
  v_rcp_f32 v38, v38
  v_rcp_f32 v39, v39
  v_pk_mul_f32 v[164:165], v[164:165], v[152:153]
  v_pk_mul_f32 v[166:167], v[166:167], v[154:155]
  v_pk_mul_f32 v[168:169], v[168:169], v[156:157]
  v_pk_mul_f32 v[170:171], v[170:171], v[158:159]
  v_pk_mul_f32 v[172:173], v[172:173], v[160:161]
  v_pk_mul_f32 v[174:175], v[174:175], v[162:163]
  v_pk_mul_f32 v[164:165], v[164:165], v[28:29]
  v_pk_mul_f32 v[166:167], v[166:167], v[30:31]
  v_pk_mul_f32 v[168:169], v[168:169], v[32:33]
  v_pk_mul_f32 v[170:171], v[170:171], v[34:35]
  v_pk_mul_f32 v[172:173], v[172:173], v[36:37]
  v_pk_mul_f32 v[174:175], v[174:175], v[38:39]
  v_cvt_pk_bf16_f32 v48, v164, v165
  v_cvt_pk_bf16_f32 v49, v166, v167
  v_cvt_pk_bf16_f32 v50, v168, v169
  v_cvt_pk_bf16_f32 v51, v170, v171
  v_cvt_pk_bf16_f32 v52, v172, v173
  v_cvt_pk_bf16_f32 v53, v174, v175
  buffer_store_dwordx4 v[48:51], v80, s[28:31], s58 offen sc0 sc1
  s_add_u32 s58, s58, 75776
  ds_write_b64 v15, v[52:53] offset:1024
  v_pk_fma_f32 v[176:177], v[56:57], v[116:117], v[176:177]
  v_pk_fma_f32 v[178:179], v[58:59], v[116:117], v[178:179]
  v_pk_fma_f32 v[180:181], v[60:61], v[116:117], v[180:181]
  v_pk_fma_f32 v[182:183], v[62:63], v[116:117], v[182:183]
  v_pk_fma_f32 v[184:185], v[64:65], v[116:117], v[184:185]
  v_pk_fma_f32 v[186:187], v[66:67], v[116:117], v[186:187]
  v_pk_mul_f32 v[176:177], v[176:177], v[108:109]
  v_pk_mul_f32 v[178:179], v[178:179], v[108:109]
  v_pk_mul_f32 v[180:181], v[180:181], v[108:109]
  v_pk_mul_f32 v[182:183], v[182:183], v[108:109]
  v_pk_mul_f32 v[184:185], v[184:185], v[108:109]
  v_pk_mul_f32 v[186:187], v[186:187], v[108:109]
  v_pk_mul_f32 v[28:29], v[176:177], v[176:177]
  v_pk_mul_f32 v[30:31], v[178:179], v[178:179]
  v_pk_mul_f32 v[32:33], v[180:181], v[180:181]
  v_pk_mul_f32 v[34:35], v[182:183], v[182:183]
  v_pk_mul_f32 v[36:37], v[184:185], v[184:185]
  v_pk_mul_f32 v[38:39], v[186:187], v[186:187]
  v_pk_fma_f32 v[28:29], v[28:29], v[26:27], v[24:25]
  v_pk_fma_f32 v[30:31], v[30:31], v[26:27], v[24:25]
  v_pk_fma_f32 v[32:33], v[32:33], v[26:27], v[24:25]
  v_pk_fma_f32 v[34:35], v[34:35], v[26:27], v[24:25]
  v_pk_fma_f32 v[36:37], v[36:37], v[26:27], v[24:25]
  v_pk_fma_f32 v[38:39], v[38:39], v[26:27], v[24:25]
  v_pk_mul_f32 v[28:29], v[28:29], v[176:177]
  v_pk_mul_f32 v[30:31], v[30:31], v[178:179]
  v_pk_mul_f32 v[32:33], v[32:33], v[180:181]
  v_pk_mul_f32 v[34:35], v[34:35], v[182:183]
  v_pk_mul_f32 v[36:37], v[36:37], v[184:185]
  v_pk_mul_f32 v[38:39], v[38:39], v[186:187]
  v_exp_f32 v28, v28
  v_exp_f32 v29, v29
  v_exp_f32 v30, v30
  v_exp_f32 v31, v31
  v_exp_f32 v32, v32
  v_exp_f32 v33, v33
  v_exp_f32 v34, v34
  v_exp_f32 v35, v35
  v_exp_f32 v36, v36
  v_exp_f32 v37, v37
  v_exp_f32 v38, v38
  v_exp_f32 v39, v39
  v_pk_fma_f32 v[188:189], v[68:69], v[116:117], v[188:189]
  v_pk_fma_f32 v[190:191], v[70:71], v[116:117], v[190:191]
  v_pk_fma_f32 v[192:193], v[72:73], v[116:117], v[192:193]
  v_pk_fma_f32 v[194:195], v[74:75], v[116:117], v[194:195]
  v_pk_fma_f32 v[196:197], v[76:77], v[116:117], v[196:197]
  v_pk_fma_f32 v[198:199], v[78:79], v[116:117], v[198:199]
  v_pk_fma_f32 v[28:29], v[28:29], v[124:125], v[124:125]
  v_pk_fma_f32 v[30:31], v[30:31], v[124:125], v[124:125]
  v_pk_fma_f32 v[32:33], v[32:33], v[124:125], v[124:125]
  v_pk_fma_f32 v[34:35], v[34:35], v[124:125], v[124:125]
  v_pk_fma_f32 v[36:37], v[36:37], v[124:125], v[124:125]
  v_pk_fma_f32 v[38:39], v[38:39], v[124:125], v[124:125]
  v_rcp_f32 v28, v28
  v_rcp_f32 v29, v29
  v_rcp_f32 v30, v30
  v_rcp_f32 v31, v31
  v_rcp_f32 v32, v32
  v_rcp_f32 v33, v33
  v_rcp_f32 v34, v34
  v_rcp_f32 v35, v35
  v_rcp_f32 v36, v36
  v_rcp_f32 v37, v37
  v_rcp_f32 v38, v38
  v_rcp_f32 v39, v39
  v_pk_mul_f32 v[188:189], v[188:189], v[176:177]
  v_pk_mul_f32 v[190:191], v[190:191], v[178:179]
  v_pk_mul_f32 v[192:193], v[192:193], v[180:181]
  v_pk_mul_f32 v[194:195], v[194:195], v[182:183]
  v_pk_mul_f32 v[196:197], v[196:197], v[184:185]
  v_pk_mul_f32 v[198:199], v[198:199], v[186:187]
  v_pk_mul_f32 v[188:189], v[188:189], v[28:29]
  v_pk_mul_f32 v[190:191], v[190:191], v[30:31]
  v_pk_mul_f32 v[192:193], v[192:193], v[32:33]
  v_pk_mul_f32 v[194:195], v[194:195], v[34:35]
  v_pk_mul_f32 v[196:197], v[196:197], v[36:37]
  v_pk_mul_f32 v[198:199], v[198:199], v[38:39]
  v_cvt_pk_bf16_f32 v40, v188, v189
  v_cvt_pk_bf16_f32 v41, v190, v191
  v_cvt_pk_bf16_f32 v42, v192, v193
  v_cvt_pk_bf16_f32 v43, v194, v195
  v_cvt_pk_bf16_f32 v44, v196, v197
  v_cvt_pk_bf16_f32 v45, v198, v199
  buffer_store_dwordx4 v[40:43], v80, s[28:31], s58 offen sc0 sc1
  s_add_u32 s58, s58, 75776
  ds_write_b64 v15, v[44:45] offset:2048
  v_pk_fma_f32 v[200:201], v[56:57], v[118:119], v[200:201]
  v_pk_fma_f32 v[202:203], v[58:59], v[118:119], v[202:203]
  v_pk_fma_f32 v[204:205], v[60:61], v[118:119], v[204:205]
  v_pk_fma_f32 v[206:207], v[62:63], v[118:119], v[206:207]
  v_pk_fma_f32 v[208:209], v[64:65], v[118:119], v[208:209]
  v_pk_fma_f32 v[210:211], v[66:67], v[118:119], v[210:211]
  v_pk_mul_f32 v[200:201], v[200:201], v[110:111]
  v_pk_mul_f32 v[202:203], v[202:203], v[110:111]
  v_pk_mul_f32 v[204:205], v[204:205], v[110:111]
  v_pk_mul_f32 v[206:207], v[206:207], v[110:111]
  v_pk_mul_f32 v[208:209], v[208:209], v[110:111]
  v_pk_mul_f32 v[210:211], v[210:211], v[110:111]
  v_pk_mul_f32 v[28:29], v[200:201], v[200:201]
  v_pk_mul_f32 v[30:31], v[202:203], v[202:203]
  v_pk_mul_f32 v[32:33], v[204:205], v[204:205]
  v_pk_mul_f32 v[34:35], v[206:207], v[206:207]
  v_pk_mul_f32 v[36:37], v[208:209], v[208:209]
  v_pk_mul_f32 v[38:39], v[210:211], v[210:211]
  v_pk_fma_f32 v[28:29], v[28:29], v[26:27], v[24:25]
  v_pk_fma_f32 v[30:31], v[30:31], v[26:27], v[24:25]
  v_pk_fma_f32 v[32:33], v[32:33], v[26:27], v[24:25]
  v_pk_fma_f32 v[34:35], v[34:35], v[26:27], v[24:25]
  v_pk_fma_f32 v[36:37], v[36:37], v[26:27], v[24:25]
  v_pk_fma_f32 v[38:39], v[38:39], v[26:27], v[24:25]
  v_pk_mul_f32 v[28:29], v[28:29], v[200:201]
  v_pk_mul_f32 v[30:31], v[30:31], v[202:203]
  v_pk_mul_f32 v[32:33], v[32:33], v[204:205]
  v_pk_mul_f32 v[34:35], v[34:35], v[206:207]
  v_pk_mul_f32 v[36:37], v[36:37], v[208:209]
  v_pk_mul_f32 v[38:39], v[38:39], v[210:211]
  v_exp_f32 v28, v28
  v_exp_f32 v29, v29
  v_exp_f32 v30, v30
  v_exp_f32 v31, v31
  v_exp_f32 v32, v32
  v_exp_f32 v33, v33
  v_exp_f32 v34, v34
  v_exp_f32 v35, v35
  v_exp_f32 v36, v36
  v_exp_f32 v37, v37
  v_exp_f32 v38, v38
  v_exp_f32 v39, v39
  v_pk_fma_f32 v[212:213], v[68:69], v[118:119], v[212:213]
  v_pk_fma_f32 v[214:215], v[70:71], v[118:119], v[214:215]
  v_pk_fma_f32 v[216:217], v[72:73], v[118:119], v[216:217]
  v_pk_fma_f32 v[218:219], v[74:75], v[118:119], v[218:219]
  v_pk_fma_f32 v[220:221], v[76:77], v[118:119], v[220:221]
  v_pk_fma_f32 v[222:223], v[78:79], v[118:119], v[222:223]
  v_pk_fma_f32 v[28:29], v[28:29], v[126:127], v[126:127]
  v_pk_fma_f32 v[30:31], v[30:31], v[126:127], v[126:127]
  v_pk_fma_f32 v[32:33], v[32:33], v[126:127], v[126:127]
  v_pk_fma_f32 v[34:35], v[34:35], v[126:127], v[126:127]
  v_pk_fma_f32 v[36:37], v[36:37], v[126:127], v[126:127]
  v_pk_fma_f32 v[38:39], v[38:39], v[126:127], v[126:127]
  v_rcp_f32 v28, v28
  v_rcp_f32 v29, v29
  v_rcp_f32 v30, v30
  v_rcp_f32 v31, v31
  v_rcp_f32 v32, v32
  v_rcp_f32 v33, v33
  v_rcp_f32 v34, v34
  v_rcp_f32 v35, v35
  v_rcp_f32 v36, v36
  v_rcp_f32 v37, v37
  v_rcp_f32 v38, v38
  v_rcp_f32 v39, v39
  v_pk_mul_f32 v[212:213], v[212:213], v[200:201]
  v_pk_mul_f32 v[214:215], v[214:215], v[202:203]
  v_pk_mul_f32 v[216:217], v[216:217], v[204:205]
  v_pk_mul_f32 v[218:219], v[218:219], v[206:207]
  v_pk_mul_f32 v[220:221], v[220:221], v[208:209]
  v_pk_mul_f32 v[222:223], v[222:223], v[210:211]
  v_pk_mul_f32 v[212:213], v[212:213], v[28:29]
  v_pk_mul_f32 v[214:215], v[214:215], v[30:31]
  v_pk_mul_f32 v[216:217], v[216:217], v[32:33]
  v_pk_mul_f32 v[218:219], v[218:219], v[34:35]
  v_pk_mul_f32 v[220:221], v[220:221], v[36:37]
  v_pk_mul_f32 v[222:223], v[222:223], v[38:39]
  v_cvt_pk_bf16_f32 v48, v212, v213
  v_cvt_pk_bf16_f32 v49, v214, v215
  v_cvt_pk_bf16_f32 v50, v216, v217
  v_cvt_pk_bf16_f32 v51, v218, v219
  v_cvt_pk_bf16_f32 v52, v220, v221
  v_cvt_pk_bf16_f32 v53, v222, v223
  buffer_store_dwordx4 v[48:51], v80, s[28:31], s58 offen sc0 sc1
  s_add_u32 s58, s58, 75776
  ds_write_b64 v15, v[52:53] offset:3072
  s_waitcnt lgkmcnt(0)
  s_barrier
  ds_read_b128 v[28:31], v16 offset:0
  ds_read_b128 v[32:35], v16 offset:1024
  s_waitcnt lgkmcnt(1)
  buffer_store_dwordx4 v[28:31], v80, s[28:31], s59 offen sc0 sc1
  s_add_u32 s59, s59, 75776
  s_waitcnt lgkmcnt(0)
  buffer_store_dwordx4 v[32:35], v80, s[28:31], s59 offen sc0 sc1
  s_add_u32 s59, s59, 75776
  s_endpgm
LQ_start:
  s_and_b32 s32, s2, 7
  s_lshr_b32 s33, s2, 3
  s_lshr_b32 s37, s32, 1
  s_mul_i32 s37, s37, 13
  s_add_u32 s37, s37, s33
  s_and_b32 s35, s32, 1
  s_lshl_b32 s35, s35, 1
  s_and_b32 s34, s37, 1
  s_add_u32 s35, s35, s34
  s_lshr_b32 s37, s37, 1
  s_mul_i32 s52, s37, 80
  s_lshl_b32 s94, s37, 2
  s_add_u32 s94, s94, s35
  s_mov_b32 s38, s33
  s_mul_i32 s53, s35, 320
  s_sub_u32 s32, s52, 16
  s_mov_b32 s38, 0
  s_mul_i32 s39, s38, 6554
  s_lshr_b32 s39, s39, 16
  s_mul_i32 s39, s39, 10
  s_sub_u32 s38, s38, s39
  s_mov_b32 s33, s53
  s_mul_i32 s34, s38, 245760
  s_lshl_b32 s35, s38, 7
  s_lshr_b32 s43, s3, 2
  s_and_b32 s44, s3, 3
  v_lshrrev_b32 v15, 3, v1
  s_mul_i32 s41, s3, 12
  v_add_u32 v16, s41, v15
  v_lshrrev_b32 v17, 1, v16
  v_xor_b32 v17, v17, v1
  v_and_b32 v17, 7, v17
  v_add_u32 v16, s32, v16
  v_max_i32 v16, 0, v16
  v_min_i32 v16, 2047, v16
  v_mul_u32_u24 v16, 1280, v16
  v_lshl_add_u32 v8, v17, 4, v16
  v_add_u32 v16, s41, v15
  v_add_u32 v16, 8, v16
  v_lshrrev_b32 v17, 1, v16
  v_xor_b32 v17, v17, v1
  v_and_b32 v17, 7, v17
  v_add_u32 v16, s32, v16
  v_max_i32 v16, 0, v16
  v_min_i32 v16, 2047, v16
  v_mul_u32_u24 v16, 1280, v16
  v_lshl_add_u32 v9, v17, 4, v16
  v_mul_u32_u24 v15, 3277, v1
  v_lshrrev_b32 v15, 16, v15
  v_mul_u32_u24 v16, 20, v15
  v_sub_u32 v16, v1, v16
  v_mul_u32_u24 v15, 1280, v15
  v_lshl_add_u32 v15, v16, 4, v15
  v_add_u32 v15, s33, v15
  s_lshl_b32 s41, s3, 2
  v_mov_b32 v17, s41
  v_and_b32 v18, 19, v17
  v_lshrrev_b32 v19, 1, v17
  v_and_b32 v19, 4, v19
  v_or_b32 v18, v18, v19
  v_lshlrev_b32 v19, 1, v17
  v_and_b32 v19, 8, v19
  v_or_b32 v18, v18, v19
  v_mul_u32_u24 v18, 3840, v18
  v_add_u32 v4, v15, v18
  v_mov_b32 v17, s41
  v_add_u32 v17, 1, v17
  v_and_b32 v18, 19, v17
  v_lshrrev_b32 v19, 1, v17
  v_and_b32 v19, 4, v19
  v_or_b32 v18, v18, v19
  v_lshlrev_b32 v19, 1, v17
  v_and_b32 v19, 8, v19
  v_or_b32 v18, v18, v19
  v_mul_u32_u24 v18, 3840, v18
  v_add_u32 v5, v15, v18
  v_mov_b32 v17, s41
  v_add_u32 v17, 2, v17
  v_and_b32 v18, 19, v17
  v_lshrrev_b32 v19, 1, v17
  v_and_b32 v19, 4, v19
  v_or_b32 v18, v18, v19
  v_lshlrev_b32 v19, 1, v17
  v_and_b32 v19, 8, v19
  v_or_b32 v18, v18, v19
  v_mul_u32_u24 v18, 3840, v18
  v_add_u32 v6, v15, v18
  v_mov_b32 v17, s41
  v_add_u32 v17, 3, v17
  v_and_b32 v18, 19, v17
  v_lshrrev_b32 v19, 1, v17
  v_and_b32 v19, 4, v19
  v_or_b32 v18, v18, v19
  v_lshlrev_b32 v19, 1, v17
  v_and_b32 v19, 8, v19
  v_or_b32 v18, v18, v19
  v_mul_u32_u24 v18, 3840, v18
  v_add_u32 v7, v15, v18
  s_mov_b32 s46, -1
  s_mov_b32 s47, 0x0fffffff
  s_mul_i32 s37, s3, 3968
  s_mul_i32 s38, s3, 1536
  s_add_u32 s38, s38, 126976
  s_mov_b32 s39, 0
  s_mov_b32 s40, 0
  s_waitcnt lgkmcnt(0)
  s_mov_b32 s16, s4
  s_and_b32 s17, s5, 0xffff
  s_mov_b32 s18, 2621440
  s_mov_b32 s19, 0x20000
  s_mov_b32 s20, s6
  s_and_b32 s21, s7, 0xffff
  s_mov_b32 s22, 2457600
  s_mov_b32 s23, 0x20000
  s_add_u32 s42, s38, s40
  s_add_u32 m0, s42, 0
  s_nop 0
  buffer_load_dwordx4 v8, s[16:19], s35 offen lds
  s_add_u32 s42, s38, s40
  s_add_u32 m0, s42, 1024
  s_mov_b32 exec_hi, 0
  buffer_load_dwordx4 v9, s[16:19], s35 offen lds
  s_mov_b32 exec_hi, -1
  s_add_u32 s35, s35, 128
  s_cmp_ge_u32 s35, 1280
  s_cselect_b32 s35, 0, s35
  s_add_u32 s40, s40, 12288
  s_cmp_ge_u32 s40, 36864
  s_cselect_b32 s40, 0, s40
  s_add_u32 s41, s37, s39
  s_add_u32 m0, s41, 0
  s_mov_b64 exec, s[46:47]
  buffer_load_dwordx4 v4, s[20:23], s34 offen lds
  s_mov_b64 exec, -1
  s_add_u32 m0, s41, 992
  s_mov_b64 exec, s[46:47]
  buffer_load_dwordx4 v5, s[20:23], s34 offen lds
  s_mov_b64 exec, -1
  s_add_u32 m0, s41, 1984
  s_mov_b64 exec, s[46:47]
  buffer_load_dwordx4 v6, s[20:23], s34 offen lds
  s_mov_b64 exec, -1
  s_add_u32 m0, s41, 2976
  s_mov_b64 exec, s[46:47]
  buffer_load_dwordx4 v7, s[20:23], s34 offen lds
  s_mov_b64 exec, -1
  s_add_u32 s34, s34, 122880
  s_cmp_ge_u32 s34, 2457600
  s_cselect_b32 s41, 2457600, 0
  s_sub_u32 s34, s34, s41
  s_add_u32 s39, s39, 31744
  s_cmp_ge_u32 s39, 126976
  s_cselect_b32 s39, 0, s39
  s_add_u32 s41, s37, s39
  s_add_u32 m0, s41, 0
  s_mov_b64 exec, s[46:47]
  buffer_load_dwordx4 v4, s[20:23], s34 offen lds
  s_mov_b64 exec, -1
  s_add_u32 m0, s41, 992
  s_mov_b64 exec, s[46:47]
  buffer_load_dwordx4 v5, s[20:23], s34 offen lds
  s_mov_b64 exec, -1
  s_add_u32 m0, s41, 1984
  s_mov_b64 exec, s[46:47]
  buffer_load_dwordx4 v6, s[20:23], s34 offen lds
  s_mov_b64 exec, -1
  s_add_u32 m0, s41, 2976
  s_mov_b64 exec, s[46:47]
  buffer_load_dwordx4 v7, s[20:23], s34 offen lds
  s_mov_b64 exec, -1
  s_add_u32 s34, s34, 122880
  s_cmp_ge_u32 s34, 2457600
  s_cselect_b32 s41, 2457600, 0
  s_sub_u32 s34, s34, s41
  s_add_u32 s39, s39, 31744
  s_cmp_ge_u32 s39, 126976
  s_cselect_b32 s39, 0, s39
  s_lshl_b32 s58, s2, 3
  s_add_u32 s58, s58, s3
  v_lshlrev_b32 v116, 4, v1
  s_mov_b32 s27, 0x20000
  s_mov_b64 s[24:25], s[6:7]
  s_mov_b32 s26, 2457600
  s_mov_b32 s59, 480
  s_cmp_ge_u32 s58, 480
  s_cbranch_scc0 LQ_pf
  s_sub_u32 s58, s58, 480
  s_mov_b64 s[24:25], s[8:9]
  s_mov_b32 s26, 2211840
  s_mov_b32 s59, 432
  s_cmp_ge_u32 s58, 432
  s_cbranch_scc0 LQ_pf
  s_sub_u32 s58, s58, 432
  s_mov_b64 s[24:25], s[10:11]
  s_mov_b32 s26, 2211840
  s_mov_b32 s59, 432
  s_cmp_ge_u32 s58, 432
  s_cbranch_scc0 LQ_pf
  s_sub_u32 s58, s58, 1072
  s_mov_b64 s[24:25], s[4:5]
  s_mov_b32 s26, 2621440
  s_mov_b32 s59, 640
LQ_pf:
  s_and_b32 s25, s25, 0xffff
  s_lshl_b32 s58, s58, 10
  s_lshl_b32 s59, s59, 10
  s_add_u32 s58, s58, s59
  buffer_load_dwordx4 v[112:115], v116, s[24:27], s58 offen
  s_add_u32 s58, s58, s59
  buffer_load_dwordx4 v[112:115], v116, s[24:27], s58 offen
  s_mov_b32 s28, s12
  s_and_b32 s29, s13, 0xffff
  s_mov_b32 s30, 9699328
  s_mov_b32 s31, 0x20000
  v_bfe_u32 v15, v1, 2, 2
  v_and_b32 v16, 3, v1
  v_and_b32 v18, 1, v3
  v_lshl_add_u32 v17, v18, 2, v15
  v_lshrrev_b32 v18, 1, v3
  v_lshl_add_u32 v17, v18, 4, v17
  v_mul_u32_u24 v17, 992, v17
  v_lshl_add_u32 v17, v16, 3, v17
  s_lshl_b32 s41, s44, 8
  v_add_u32 v10, s41, v17
  s_cmp_eq_u32 s43, 0
  s_cselect_b32 s48, 0x10001, 0
  s_mov_b32 s49, s48
  s_mul_i32 s41, s43, 6144
  s_add_u32 s41, s41, 126976
  v_lshrrev_b32 v15, 1, v2
  v_xor_b32 v15, v15, v3
  v_lshlrev_b32 v16, 7, v2
  v_add_u32 v16, s41, v16
  v_lshl_add_u32 v13, v15, 4, v16
  v_xor_b32 v14, 64, v13
  v_mov_b32 v20, 0x3f803f80
  v_mov_b32 v21, 0x3f803f80
  v_mov_b32 v22, 0x3f803f80
  v_mov_b32 v23, 0x3f803f80
  v_mov_b32 v128, 0
  v_mov_b32 v129, 0
  v_mov_b32 v130, 0
  v_mov_b32 v131, 0
  v_mov_b32 v132, 0
  v_mov_b32 v133, 0
  v_mov_b32 v134, 0
  v_mov_b32 v135, 0
  v_mov_b32 v136, 0
  v_mov_b32 v137, 0
  v_mov_b32 v138, 0
  v_mov_b32 v139, 0
  v_mov_b32 v140, 0
  v_mov_b32 v141, 0
  v_mov_b32 v142, 0
  v_mov_b32 v143, 0
  v_mov_b32 v144, 0
  v_mov_b32 v145, 0
  v_mov_b32 v146, 0
  v_mov_b32 v147, 0
  v_mov_b32 v148, 0
  v_mov_b32 v149, 0
  v_mov_b32 v150, 0
  v_mov_b32 v151, 0
  v_mov_b32 v152, 0
  v_mov_b32 v153, 0
  v_mov_b32 v154, 0
  v_mov_b32 v155, 0
  v_mov_b32 v156, 0
  v_mov_b32 v157, 0
  v_mov_b32 v158, 0
  v_mov_b32 v159, 0
  v_mov_b32 v160, 0
  v_mov_b32 v161, 0
  v_mov_b32 v162, 0
  v_mov_b32 v163, 0
  v_mov_b32 v164, 0
  v_mov_b32 v165, 0
  v_mov_b32 v166, 0
  v_mov_b32 v167, 0
  v_mov_b32 v168, 0
  v_mov_b32 v169, 0
  v_mov_b32 v170, 0
  v_mov_b32 v171, 0
  v_mov_b32 v172, 0
  v_mov_b32 v173, 0
  v_mov_b32 v174, 0
  v_mov_b32 v175, 0
  v_mov_b32 v176, 0
  v_mov_b32 v177, 0
  v_mov_b32 v178, 0
  v_mov_b32 v179, 0
  v_mov_b32 v180, 0
  v_mov_b32 v181, 0
  v_mov_b32 v182, 0
  v_mov_b32 v183, 0
  v_mov_b32 v184, 0
  v_mov_b32 v185, 0
  v_mov_b32 v186, 0
  v_mov_b32 v187, 0
  v_mov_b32 v188, 0
  v_mov_b32 v189, 0
  v_mov_b32 v190, 0
  v_mov_b32 v191, 0
  v_mov_b32 v192, 0
  v_mov_b32 v193, 0
  v_mov_b32 v194, 0
  v_mov_b32 v195, 0
  v_mov_b32 v196, 0
  v_mov_b32 v197, 0
  v_mov_b32 v198, 0
  v_mov_b32 v199, 0
  v_mov_b32 v200, 0
  v_mov_b32 v201, 0
  v_mov_b32 v202, 0
  v_mov_b32 v203, 0
  v_mov_b32 v204, 0
  v_mov_b32 v205, 0
  v_mov_b32 v206, 0
  v_mov_b32 v207, 0
  v_mov_b32 v208, 0
  v_mov_b32 v209, 0
  v_mov_b32 v210, 0
  v_mov_b32 v211, 0
  v_mov_b32 v212, 0
  v_mov_b32 v213, 0
  v_mov_b32 v214, 0
  v_mov_b32 v215, 0
  v_mov_b32 v216, 0
  v_mov_b32 v217, 0
  v_mov_b32 v218, 0
  v_mov_b32 v219, 0
  v_mov_b32 v220, 0
  v_mov_b32 v221, 0
  v_mov_b32 v222, 0
  v_mov_b32 v223, 0
  s_mov_b32 s54, 0
  s_mov_b32 s55, 0
  s_mov_b32 s56, 31744
  s_mov_b32 s57, 12288
  v_mov_b32 v236, 0
  v_mov_b32 v237, 0
  v_mov_b32 v238, 0
  v_mov_b32 v239, 0
  v_mov_b32 v240, 0
  v_mov_b32 v241, 0
  v_mov_b32 v242, 0
  v_mov_b32 v243, 0
  v_mov_b32 v244, 0
  v_mov_b32 v245, 0
  v_mov_b32 v246, 0
  v_mov_b32 v247, 0
  v_mov_b32 v248, 0
  v_mov_b32 v249, 0
  v_mov_b32 v250, 0
  v_mov_b32 v251, 0
  v_mov_b32 v252, 0
  v_mov_b32 v253, 0
  v_mov_b32 v254, 0
  v_mov_b32 v255, 0
  s_mul_i32 s41, s3, 40
  v_mul_u32_u24 v225, 968, v2
  v_lshl_add_u32 v225, v3, 4, v225
  v_add_u32 v225, s41, v225
  v_bfe_u32 v15, v1, 2, 2
  v_lshl_add_u32 v15, v3, 2, v15
  v_mul_u32_u24 v226, 968, v15
  v_and_b32 v16, 3, v1
  v_lshl_add_u32 v226, v16, 3, v226
  v_add_u32 v226, s41, v226
  v_add_u32 v224, 46464, v225
  v_add_u32 v230, 46464, v226
  v_and_b32 v15, 1, v2
  v_lshlrev_b32 v227, 4, v15
  v_cmp_eq_u32 s[82:83], 1, v15
  v_lshl_add_u32 v15, v3, 2, v15
  v_cmp_le_u32 s[84:85], v15, v2
  v_add_u32 v15, 2, v15
  v_cmp_le_u32 s[86:87], v15, v2
  s_cmp_eq_u32 s52, 0
  s_cselect_b32 s42, 0, -1
  s_or_b32 s88, s84, s42
  s_or_b32 s89, s85, s42
  s_or_b32 s90, s86, s42
  s_or_b32 s91, s87, s42
  s_lshr_b32 s41, s33, 3
  s_mul_i32 s42, s3, 5
  s_add_u32 s41, s41, s42
  s_lshr_b32 s42, s52, 4
  s_mul_i32 s92, s42, 75776
  v_add_u32 v15, s41, v3
  v_lshrrev_b32 v16, 3, v15
  v_lshlrev_b32 v228, 10, v16
  v_and_b32 v16, 3, v15
  v_lshl_add_u32 v228, v16, 8, v228
  v_and_b32 v16, 4, v15
  v_lshl_add_u32 v228, v16, 1, v228
  v_lshl_add_u32 v228, v2, 4, v228
  v_mov_b32 v15, s41
  v_add_u32 v15, 4, v15
  v_lshrrev_b32 v16, 3, v15
  v_lshlrev_b32 v229, 10, v16
  v_and_b32 v16, 3, v15
  v_lshl_add_u32 v229, v16, 8, v229
  v_and_b32 v16, 4, v15
  v_lshl_add_u32 v229, v16, 1, v229
  v_lshl_add_u32 v229, v2, 4, v229
  s_lshl_b32 s41, s33, 4
  s_sub_u32 s42, 98304, s41
  v_add_u32 v228, s42, v228
  v_add_u32 v229, s42, v229
  s_add_u32 s92, s92, s41
  s_lshl_b32 s41, s3, 10
  v_lshlrev_b32 v231, 4, v1
  v_add_u32 v231, s41, v231
  v_add_u32 v232, 98304, v231
  s_add_u32 s41, s3, 0
  s_mul_i32 s41, s41, 52
  s_lshr_b32 s41, s41, 8
  s_mul_i32 s41, s41, 70656
  s_add_u32 s41, s41, 0
  s_add_u32 s96, s41, s92
  s_add_u32 s41, s3, 8
  s_mul_i32 s41, s41, 52
  s_lshr_b32 s41, s41, 8
  s_mul_i32 s41, s41, 70656
  s_add_u32 s41, s41, 8192
  s_add_u32 s97, s41, s92
  s_add_u32 s41, s3, 16
  s_mul_i32 s41, s41, 52
  s_lshr_b32 s41, s41, 8
  s_mul_i32 s41, s41, 70656
  s_add_u32 s41, s41, 16384
  s_add_u32 s98, s41, s92
  s_add_u32 s41, s3, 24
  s_mul_i32 s41, s41, 52
  s_lshr_b32 s41, s41, 8
  s_mul_i32 s41, s41, 70656
  s_add_u32 s41, s41, 24576
  s_add_u32 s99, s41, s92
  s_waitcnt vmcnt(6)
  s_barrier
  ds_read_b128 v[24:27], v13 offset:0
  ds_read_b128 v[28:31], v13 offset:2048
  ds_read_b128 v[32:35], v13 offset:4096
  ds_read_b64_tr_b16 v[48:49], v10 offset:0
  ds_read_b64_tr_b16 v[50:51], v10 offset:7936
  ds_read_b64_tr_b16 v[52:53], v10 offset:32
  ds_read_b64_tr_b16 v[54:55], v10 offset:7968
  ds_read_b64_tr_b16 v[56:57], v10 offset:64
  ds_read_b64_tr_b16 v[58:59], v10 offset:8000
  ds_read_b64_tr_b16 v[60:61], v10 offset:96
  ds_read_b64_tr_b16 v[62:63], v10 offset:8032
  ds_read_b64_tr_b16 v[64:65], v10 offset:128
  ds_read_b64_tr_b16 v[66:67], v10 offset:8064
  ds_read_b64_tr_b16 v[68:69], v10 offset:160
  ds_read_b64_tr_b16 v[70:71], v10 offset:8096
  ds_read_b64_tr_b16 v[72:73], v10 offset:192
  ds_read_b64_tr_b16 v[74:75], v10 offset:8128
  ds_read_b64_tr_b16 v[76:77], v10 offset:224
  ds_read_b64_tr_b16 v[78:79], v10 offset:8160
  s_add_u32 s54, s54, 31744
  s_cmp_ge_u32 s54, 126976
  s_cselect_b32 s42, 4294872064, s56
  s_cselect_b32 s54, 0, s54
  v_add_u32 v10, s42, v10
  s_waitcnt vmcnt(2) lgkmcnt(0)
  s_barrier
  s_mov_b64 exec, s[48:49]
  v_mov_b32 v24, v20
  v_mov_b32 v25, v20
  v_mov_b32 v26, v20
  v_mov_b32 v27, v20
  s_mov_b64 exec, -1
  s_cmp_eq_u32 s43, 0
  s_cbranch_scc0 LQ_v1_h0
  v_mfma_f32_16x16x32_bf16 v[192:195], v[48:51], v[32:35], v[192:195]
  s_add_u32 s42, s38, s40
  s_add_u32 m0, s42, 0
  s_nop 0
  buffer_load_dwordx4 v8, s[16:19], s35 offen lds
  s_add_u32 s42, s38, s40
  s_add_u32 m0, s42, 1024
  s_mov_b32 exec_hi, 0
  buffer_load_dwordx4 v9, s[16:19], s35 offen lds
  s_mov_b32 exec_hi, -1
  s_add_u32 s35, s35, 128
  s_cmp_ge_u32 s35, 1280
  s_cselect_b32 s35, 0, s35
  s_add_u32 s40, s40, 12288
  s_cmp_ge_u32 s40, 36864
  s_cselect_b32 s40, 0, s40
  v_mfma_f32_16x16x32_bf16 v[160:163], v[48:51], v[28:31], v[160:163]
  s_add_u32 s41, s37, s39
  s_add_u32 m0, s41, 0
  s_mov_b64 exec, s[46:47]
  buffer_load_dwordx4 v4, s[20:23], s34 offen lds
  s_mov_b64 exec, -1
  v_mfma_f32_16x16x32_bf16 v[128:131], v[48:51], v[24:27], v[128:131]
  s_add_u32 m0, s41, 992
  s_mov_b64 exec, s[46:47]
  buffer_load_dwordx4 v5, s[20:23], s34 offen lds
  s_mov_b64 exec, -1
  v_mfma_f32_16x16x32_bf16 v[196:199], v[52:55], v[32:35], v[196:199]
  s_add_u32 m0, s41, 1984
  s_mov_b64 exec, s[46:47]
  buffer_load_dwordx4 v6, s[20:23], s34 offen lds
  s_mov_b64 exec, -1
  s_add_u32 m0, s41, 2976
  s_mov_b64 exec, s[46:47]
  buffer_load_dwordx4 v7, s[20:23], s34 offen lds
  s_mov_b64 exec, -1
  s_add_u32 s34, s34, 122880
  s_cmp_ge_u32 s34, 2457600
  s_cselect_b32 s41, 2457600, 0
  s_sub_u32 s34, s34, s41
  s_add_u32 s39, s39, 31744
  s_cmp_ge_u32 s39, 126976
  s_cselect_b32 s39, 0, s39
  v_mfma_f32_16x16x32_bf16 v[164:167], v[52:55], v[28:31], v[164:167]
  s_add_u32 s41, s37, s39
  s_add_u32 m0, s41, 0
  s_mov_b64 exec, s[46:47]
  buffer_load_dwordx4 v4, s[20:23], s34 offen lds
  s_mov_b64 exec, -1
  v_mfma_f32_16x16x32_bf16 v[132:135], v[52:55], v[24:27], v[132:135]
  s_add_u32 m0, s41, 992
  s_mov_b64 exec, s[46:47]
  buffer_load_dwordx4 v5, s[20:23], s34 offen lds
  s_mov_b64 exec, -1
  v_mfma_f32_16x16x32_bf16 v[200:203], v[56:59], v[32:35], v[200:203]
  s_add_u32 m0, s41, 1984
  s_mov_b64 exec, s[46:47]
  buffer_load_dwordx4 v6, s[20:23], s34 offen lds
  s_mov_b64 exec, -1
  s_add_u32 m0, s41, 2976
  s_mov_b64 exec, s[46:47]
  buffer_load_dwordx4 v7, s[20:23], s34 offen lds
  s_mov_b64 exec, -1
  s_add_u32 s34, s34, 122880
  s_cmp_ge_u32 s34, 2457600
  s_cselect_b32 s41, 2457600, 0
  s_sub_u32 s34, s34, s41
  s_add_u32 s39, s39, 31744
  s_cmp_ge_u32 s39, 126976
  s_cselect_b32 s39, 0, s39
  v_mfma_f32_16x16x32_bf16 v[168:171], v[56:59], v[28:31], v[168:171]
  s_add_u32 s58, s58, s59
  buffer_load_dwordx4 v[112:115], v116, s[24:27], s58 offen
  v_mfma_f32_16x16x32_bf16 v[136:139], v[56:59], v[24:27], v[136:139]
  s_add_u32 s58, s58, s59
  buffer_load_dwordx4 v[112:115], v116, s[24:27], s58 offen
  v_mfma_f32_16x16x32_bf16 v[204:207], v[60:63], v[32:35], v[204:207]
  ds_read_b128 v[36:39], v14 offset:0
  ds_read_b128 v[40:43], v14 offset:2048
  ds_read_b128 v[44:47], v14 offset:4096
  v_mfma_f32_16x16x32_bf16 v[172:175], v[60:63], v[28:31], v[172:175]
  ds_read_b64_tr_b16 v[80:81], v10 offset:0
  ds_read_b64_tr_b16 v[82:83], v10 offset:7936
  v_mfma_f32_16x16x32_bf16 v[140:143], v[60:63], v[24:27], v[140:143]
  ds_read_b64_tr_b16 v[84:85], v10 offset:32
  ds_read_b64_tr_b16 v[86:87], v10 offset:7968
  ds_read_b64_tr_b16 v[88:89], v10 offset:64
  v_mfma_f32_16x16x32_bf16 v[208:211], v[64:67], v[32:35], v[208:211]
  ds_read_b64_tr_b16 v[90:91], v10 offset:8000
  ds_read_b64_tr_b16 v[92:93], v10 offset:96
  v_mfma_f32_16x16x32_bf16 v[176:179], v[64:67], v[28:31], v[176:179]
  ds_read_b64_tr_b16 v[94:95], v10 offset:8032
  ds_read_b64_tr_b16 v[96:97], v10 offset:128
  ds_read_b64_tr_b16 v[98:99], v10 offset:8064
  v_mfma_f32_16x16x32_bf16 v[144:147], v[64:67], v[24:27], v[144:147]
  ds_read_b64_tr_b16 v[100:101], v10 offset:160
  ds_read_b64_tr_b16 v[102:103], v10 offset:8096
  v_mfma_f32_16x16x32_bf16 v[212:215], v[68:71], v[32:35], v[212:215]
  ds_read_b64_tr_b16 v[104:105], v10 offset:192
  ds_read_b64_tr_b16 v[106:107], v10 offset:8128
  ds_read_b64_tr_b16 v[108:109], v10 offset:224
  v_mfma_f32_16x16x32_bf16 v[180:183], v[68:71], v[28:31], v[180:183]
  ds_read_b64_tr_b16 v[110:111], v10 offset:8160
  s_add_u32 s54, s54, 31744
  s_cmp_ge_u32 s54, 126976
  s_cselect_b32 s42, 4294872064, s56
  s_cselect_b32 s54, 0, s54
  v_add_u32 v10, s42, v10
  v_mfma_f32_16x16x32_bf16 v[148:151], v[68:71], v[24:27], v[148:151]
  s_branch LQ_vj_h0
LQ_v1_h0:
  v_mfma_f32_16x16x32_bf16 v[192:195], v[48:51], v[32:35], v[192:195]
  ds_read_b128 v[36:39], v14 offset:0
  ds_read_b128 v[40:43], v14 offset:2048
  ds_read_b128 v[44:47], v14 offset:4096
  v_mfma_f32_16x16x32_bf16 v[160:163], v[48:51], v[28:31], v[160:163]
  ds_read_b64_tr_b16 v[80:81], v10 offset:0
  ds_read_b64_tr_b16 v[82:83], v10 offset:7936
  v_mfma_f32_16x16x32_bf16 v[128:131], v[48:51], v[24:27], v[128:131]
  ds_read_b64_tr_b16 v[84:85], v10 offset:32
  ds_read_b64_tr_b16 v[86:87], v10 offset:7968
  ds_read_b64_tr_b16 v[88:89], v10 offset:64
  v_mfma_f32_16x16x32_bf16 v[196:199], v[52:55], v[32:35], v[196:199]
  ds_read_b64_tr_b16 v[90:91], v10 offset:8000
  ds_read_b64_tr_b16 v[92:93], v10 offset:96
  v_mfma_f32_16x16x32_bf16 v[164:167], v[52:55], v[28:31], v[164:167]
  ds_read_b64_tr_b16 v[94:95], v10 offset:8032
  ds_read_b64_tr_b16 v[96:97], v10 offset:128
  ds_read_b64_tr_b16 v[98:99], v10 offset:8064
  v_mfma_f32_16x16x32_bf16 v[132:135], v[52:55], v[24:27], v[132:135]
  ds_read_b64_tr_b16 v[100:101], v10 offset:160
  ds_read_b64_tr_b16 v[102:103], v10 offset:8096
  v_mfma_f32_16x16x32_bf16 v[200:203], v[56:59], v[32:35], v[200:203]
  ds_read_b64_tr_b16 v[104:105], v10 offset:192
  ds_read_b64_tr_b16 v[106:107], v10 offset:8128
  ds_read_b64_tr_b16 v[108:109], v10 offset:224
  v_mfma_f32_16x16x32_bf16 v[168:171], v[56:59], v[28:31], v[168:171]
  ds_read_b64_tr_b16 v[110:111], v10 offset:8160
  s_add_u32 s54, s54, 31744
  s_cmp_ge_u32 s54, 126976
  s_cselect_b32 s42, 4294872064, s56
  s_cselect_b32 s54, 0, s54
  v_add_u32 v10, s42, v10
  v_mfma_f32_16x16x32_bf16 v[136:139], v[56:59], v[24:27], v[136:139]
  v_mfma_f32_16x16x32_bf16 v[204:207], v[60:63], v[32:35], v[204:207]
  s_add_u32 s42, s38, s40
  s_add_u32 m0, s42, 0
  s_nop 0
  buffer_load_dwordx4 v8, s[16:19], s35 offen lds
  s_add_u32 s42, s38, s40
  s_add_u32 m0, s42, 1024
  s_mov_b32 exec_hi, 0
  buffer_load_dwordx4 v9, s[16:19], s35 offen lds
  s_mov_b32 exec_hi, -1
  s_add_u32 s35, s35, 128
  s_cmp_ge_u32 s35, 1280
  s_cselect_b32 s35, 0, s35
  s_add_u32 s40, s40, 12288
  s_cmp_ge_u32 s40, 36864
  s_cselect_b32 s40, 0, s40
  v_mfma_f32_16x16x32_bf16 v[172:175], v[60:63], v[28:31], v[172:175]
  s_add_u32 s41, s37, s39
  s_add_u32 m0, s41, 0
  s_mov_b64 exec, s[46:47]
  buffer_load_dwordx4 v4, s[20:23], s34 offen lds
  s_mov_b64 exec, -1
  v_mfma_f32_16x16x32_bf16 v[140:143], v[60:63], v[24:27], v[140:143]
  s_add_u32 m0, s41, 992
  s_mov_b64 exec, s[46:47]
  buffer_load_dwordx4 v5, s[20:23], s34 offen lds
  s_mov_b64 exec, -1
  v_mfma_f32_16x16x32_bf16 v[208:211], v[64:67], v[32:35], v[208:211]
  s_add_u32 m0, s41, 1984
  s_mov_b64 exec, s[46:47]
  buffer_load_dwordx4 v6, s[20:23], s34 offen lds
  s_mov_b64 exec, -1
  s_add_u32 m0, s41, 2976
  s_mov_b64 exec, s[46:47]
  buffer_load_dwordx4 v7, s[20:23], s34 offen lds
  s_mov_b64 exec, -1
  s_add_u32 s34, s34, 122880
  s_cmp_ge_u32 s34, 2457600
  s_cselect_b32 s41, 2457600, 0
  s_sub_u32 s34, s34, s41
  s_add_u32 s39, s39, 31744
  s_cmp_ge_u32 s39, 126976
  s_cselect_b32 s39, 0, s39
  v_mfma_f32_16x16x32_bf16 v[176:179], v[64:67], v[28:31], v[176:179]
  s_add_u32 s41, s37, s39
  s_add_u32 m0, s41, 0
  s_mov_b64 exec, s[46:47]
  buffer_load_dwordx4 v4, s[20:23], s34 offen lds
  s_mov_b64 exec, -1
  v_mfma_f32_16x16x32_bf16 v[144:147], v[64:67], v[24:27], v[144:147]
  s_add_u32 m0, s41, 992
  s_mov_b64 exec, s[46:47]
  buffer_load_dwordx4 v5, s[20:23], s34 offen lds
  s_mov_b64 exec, -1
  v_mfma_f32_16x16x32_bf16 v[212:215], v[68:71], v[32:35], v[212:215]
  s_add_u32 m0, s41, 1984
  s_mov_b64 exec, s[46:47]
  buffer_load_dwordx4 v6, s[20:23], s34 offen lds
  s_mov_b64 exec, -1
  s_add_u32 m0, s41, 2976
  s_mov_b64 exec, s[46:47]
  buffer_load_dwordx4 v7, s[20:23], s34 offen lds
  s_mov_b64 exec, -1
  s_add_u32 s34, s34, 122880
  s_cmp_ge_u32 s34, 2457600
  s_cselect_b32 s41, 2457600, 0
  s_sub_u32 s34, s34, s41
  s_add_u32 s39, s39, 31744
  s_cmp_ge_u32 s39, 126976
  s_cselect_b32 s39, 0, s39
  v_mfma_f32_16x16x32_bf16 v[180:183], v[68:71], v[28:31], v[180:183]
  s_add_u32 s58, s58, s59
  buffer_load_dwordx4 v[112:115], v116, s[24:27], s58 offen
  v_mfma_f32_16x16x32_bf16 v[148:151], v[68:71], v[24:27], v[148:151]
  s_add_u32 s58, s58, s59
  buffer_load_dwordx4 v[112:115], v116, s[24:27], s58 offen
LQ_vj_h0:
  s_cmp_eq_u32 s44, 3
  s_cbranch_scc1 LQ_n3_h0
  v_mfma_f32_16x16x32_bf16 v[152:155], v[72:75], v[24:27], v[152:155]
  v_mfma_f32_16x16x32_bf16 v[184:187], v[72:75], v[28:31], v[184:187]
  v_mfma_f32_16x16x32_bf16 v[216:219], v[72:75], v[32:35], v[216:219]
  v_mfma_f32_16x16x32_bf16 v[156:159], v[76:79], v[24:27], v[156:159]
  v_mfma_f32_16x16x32_bf16 v[188:191], v[76:79], v[28:31], v[188:191]
  v_mfma_f32_16x16x32_bf16 v[220:223], v[76:79], v[32:35], v[220:223]
  s_branch LQ_nj_h0
LQ_n3_h0:
  v_mfma_f32_16x16x32_bf16 v[152:155], v[20:23], v[24:27], v[152:155]
  v_mfma_f32_16x16x32_bf16 v[156:159], v[24:27], v[24:27], v[156:159]
  v_mfma_f32_16x16x32_bf16 v[184:187], v[20:23], v[28:31], v[184:187]
  v_mfma_f32_16x16x32_bf16 v[188:191], v[28:31], v[28:31], v[188:191]
  v_mfma_f32_16x16x32_bf16 v[216:219], v[20:23], v[32:35], v[216:219]
  v_mfma_f32_16x16x32_bf16 v[220:223], v[32:35], v[32:35], v[220:223]
LQ_nj_h0:
  s_waitcnt vmcnt(6) lgkmcnt(0)
  s_barrier
  s_mov_b64 exec, s[48:49]
  v_mov_b32 v36, v20
  v_mov_b32 v37, v20
  v_mov_b32 v38, v20
  v_mov_b32 v39, v20
  s_mov_b64 exec, -1
  s_cmp_eq_u32 s43, 0
  s_cbranch_scc0 LQ_v1_h1
  v_mfma_f32_16x16x32_bf16 v[192:195], v[80:83], v[44:47], v[192:195]
  s_add_u32 s42, s38, s40
  s_add_u32 m0, s42, 0
  s_nop 0
  buffer_load_dwordx4 v8, s[16:19], s35 offen lds
  s_add_u32 s41, s37, s39
  s_add_u32 m0, s41, 0
  s_mov_b64 exec, s[46:47]
  buffer_load_dwordx4 v4, s[20:23], s34 offen lds
  s_mov_b64 exec, -1
  v_mfma_f32_16x16x32_bf16 v[160:163], v[80:83], v[40:43], v[160:163]
  s_add_u32 m0, s41, 992
  s_mov_b64 exec, s[46:47]
  buffer_load_dwordx4 v5, s[20:23], s34 offen lds
  s_mov_b64 exec, -1
  v_mfma_f32_16x16x32_bf16 v[128:131], v[80:83], v[36:39], v[128:131]
  s_add_u32 m0, s41, 1984
  s_mov_b64 exec, s[46:47]
  buffer_load_dwordx4 v6, s[20:23], s34 offen lds
  s_mov_b64 exec, -1
  v_mfma_f32_16x16x32_bf16 v[196:199], v[84:87], v[44:47], v[196:199]
  s_add_u32 m0, s41, 2976
  s_mov_b64 exec, s[46:47]
  buffer_load_dwordx4 v7, s[20:23], s34 offen lds
  s_mov_b64 exec, -1
  s_add_u32 s34, s34, 122880
  s_cmp_ge_u32 s34, 2457600
  s_cselect_b32 s41, 2457600, 0
  s_sub_u32 s34, s34, s41
  s_add_u32 s39, s39, 31744
  s_cmp_ge_u32 s39, 126976
  s_cselect_b32 s39, 0, s39
  v_mfma_f32_16x16x32_bf16 v[164:167], v[84:87], v[40:43], v[164:167]
  s_add_u32 s42, s38, s40
  s_add_u32 m0, s42, 1024
  s_mov_b32 exec_hi, 0
  buffer_load_dwordx4 v9, s[16:19], s35 offen lds
  s_mov_b32 exec_hi, -1
  s_add_u32 s35, s35, 128
  s_cmp_ge_u32 s35, 1280
  s_cselect_b32 s35, 0, s35
  s_add_u32 s40, s40, 12288
  s_cmp_ge_u32 s40, 36864
  s_cselect_b32 s40, 0, s40
  s_add_u32 s41, s37, s39
  s_add_u32 m0, s41, 0
  s_mov_b64 exec, s[46:47]
  buffer_load_dwordx4 v4, s[20:23], s34 offen lds
  s_mov_b64 exec, -1
  v_mfma_f32_16x16x32_bf16 v[132:135], v[84:87], v[36:39], v[132:135]
  s_add_u32 m0, s41, 992
  s_mov_b64 exec, s[46:47]
  buffer_load_dwordx4 v5, s[20:23], s34 offen lds
  s_mov_b64 exec, -1
  v_mfma_f32_16x16x32_bf16 v[200:203], v[88:91], v[44:47], v[200:203]
  s_add_u32 m0, s41, 1984
  s_mov_b64 exec, s[46:47]
  buffer_load_dwordx4 v6, s[20:23], s34 offen lds
  s_mov_b64 exec, -1
  v_mfma_f32_16x16x32_bf16 v[168:171], v[88:91], v[40:43], v[168:171]
  s_add_u32 m0, s41, 2976
  s_mov_b64 exec, s[46:47]
  buffer_load_dwordx4 v7, s[20:23], s34 offen lds
  s_mov_b64 exec, -1
  s_add_u32 s34, s34, 122880
  s_cmp_ge_u32 s34, 2457600
  s_cselect_b32 s41, 2457600, 0
  s_sub_u32 s34, s34, s41
  s_add_u32 s39, s39, 31744
  s_cmp_ge_u32 s39, 126976
  s_cselect_b32 s39, 0, s39
  v_mfma_f32_16x16x32_bf16 v[136:139], v[88:91], v[36:39], v[136:139]
  s_add_u32 s42, s38, s40
  s_add_u32 m0, s42, 0
  s_nop 0
  buffer_load_dwordx4 v8, s[16:19], s35 offen lds
  v_mfma_f32_16x16x32_bf16 v[204:207], v[92:95], v[44:47], v[204:207]
  s_add_u32 s55, s55, 12288
  s_cmp_ge_u32 s55, 36864
  s_cselect_b32 s42, 4294942720, s57
  s_cselect_b32 s55, 0, s55
  v_add_u32 v13, s42, v13
  v_add_u32 v14, s42, v14
  ds_read_b128 v[24:27], v13 offset:0
  ds_read_b128 v[28:31], v13 offset:2048
  v_mfma_f32_16x16x32_bf16 v[172:175], v[92:95], v[40:43], v[172:175]
  ds_read_b128 v[32:35], v13 offset:4096
  ds_read_b64_tr_b16 v[48:49], v10 offset:0
  ds_read_b64_tr_b16 v[50:51], v10 offset:7936
  v_mfma_f32_16x16x32_bf16 v[140:143], v[92:95], v[36:39], v[140:143]
  ds_read_b64_tr_b16 v[52:53], v10 offset:32
  ds_read_b64_tr_b16 v[54:55], v10 offset:7968
  v_mfma_f32_16x16x32_bf16 v[208:211], v[96:99], v[44:47], v[208:211]
  ds_read_b64_tr_b16 v[56:57], v10 offset:64
  ds_read_b64_tr_b16 v[58:59], v10 offset:8000
  ds_read_b64_tr_b16 v[60:61], v10 offset:96
  v_mfma_f32_16x16x32_bf16 v[176:179], v[96:99], v[40:43], v[176:179]
  ds_read_b64_tr_b16 v[62:63], v10 offset:8032
  ds_read_b64_tr_b16 v[64:65], v10 offset:128
  ds_read_b64_tr_b16 v[66:67], v10 offset:8064
  v_mfma_f32_16x16x32_bf16 v[144:147], v[96:99], v[36:39], v[144:147]
  ds_read_b64_tr_b16 v[68:69], v10 offset:160
  ds_read_b64_tr_b16 v[70:71], v10 offset:8096
  v_mfma_f32_16x16x32_bf16 v[212:215], v[100:103], v[44:47], v[212:215]
  ds_read_b64_tr_b16 v[72:73], v10 offset:192
  ds_read_b64_tr_b16 v[74:75], v10 offset:8128
  ds_read_b64_tr_b16 v[76:77], v10 offset:224
  v_mfma_f32_16x16x32_bf16 v[180:183], v[100:103], v[40:43], v[180:183]
  ds_read_b64_tr_b16 v[78:79], v10 offset:8160
  s_add_u32 s54, s54, 31744
  s_cmp_ge_u32 s54, 126976
  s_cselect_b32 s42, 4294872064, s56
  s_cselect_b32 s54, 0, s54
  v_add_u32 v10, s42, v10
  v_mfma_f32_16x16x32_bf16 v[148:151], v[100:103], v[36:39], v[148:151]
  s_branch LQ_vj_h1
LQ_v1_h1:
  v_mfma_f32_16x16x32_bf16 v[192:195], v[80:83], v[44:47], v[192:195]
  s_add_u32 s55, s55, 12288
  s_cmp_ge_u32 s55, 36864
  s_cselect_b32 s42, 4294942720, s57
  s_cselect_b32 s55, 0, s55
  v_add_u32 v13, s42, v13
  v_add_u32 v14, s42, v14
  ds_read_b128 v[24:27], v13 offset:0
  ds_read_b128 v[28:31], v13 offset:2048
  v_mfma_f32_16x16x32_bf16 v[160:163], v[80:83], v[40:43], v[160:163]
  ds_read_b128 v[32:35], v13 offset:4096
  ds_read_b64_tr_b16 v[48:49], v10 offset:0
  ds_read_b64_tr_b16 v[50:51], v10 offset:7936
  v_mfma_f32_16x16x32_bf16 v[128:131], v[80:83], v[36:39], v[128:131]
  ds_read_b64_tr_b16 v[52:53], v10 offset:32
  ds_read_b64_tr_b16 v[54:55], v10 offset:7968
  v_mfma_f32_16x16x32_bf16 v[196:199], v[84:87], v[44:47], v[196:199]
  ds_read_b64_tr_b16 v[56:57], v10 offset:64
  ds_read_b64_tr_b16 v[58:59], v10 offset:8000
  ds_read_b64_tr_b16 v[60:61], v10 offset:96
  v_mfma_f32_16x16x32_bf16 v[164:167], v[84:87], v[40:43], v[164:167]
  ds_read_b64_tr_b16 v[62:63], v10 offset:8032
  ds_read_b64_tr_b16 v[64:65], v10 offset:128
  ds_read_b64_tr_b16 v[66:67], v10 offset:8064
  v_mfma_f32_16x16x32_bf16 v[132:135], v[84:87], v[36:39], v[132:135]
  ds_read_b64_tr_b16 v[68:69], v10 offset:160
  ds_read_b64_tr_b16 v[70:71], v10 offset:8096
  v_mfma_f32_16x16x32_bf16 v[200:203], v[88:91], v[44:47], v[200:203]
  ds_read_b64_tr_b16 v[72:73], v10 offset:192
  ds_read_b64_tr_b16 v[74:75], v10 offset:8128
  ds_read_b64_tr_b16 v[76:77], v10 offset:224
  v_mfma_f32_16x16x32_bf16 v[168:171], v[88:91], v[40:43], v[168:171]
  ds_read_b64_tr_b16 v[78:79], v10 offset:8160
  s_add_u32 s54, s54, 31744
  s_cmp_ge_u32 s54, 126976
  s_cselect_b32 s42, 4294872064, s56
  s_cselect_b32 s54, 0, s54
  v_add_u32 v10, s42, v10
  v_mfma_f32_16x16x32_bf16 v[136:139], v[88:91], v[36:39], v[136:139]
  v_mfma_f32_16x16x32_bf16 v[204:207], v[92:95], v[44:47], v[204:207]
  s_add_u32 s42, s38, s40
  s_add_u32 m0, s42, 0
  s_nop 0
  buffer_load_dwordx4 v8, s[16:19], s35 offen lds
  s_add_u32 s41, s37, s39
  s_add_u32 m0, s41, 0
  s_mov_b64 exec, s[46:47]
  buffer_load_dwordx4 v4, s[20:23], s34 offen lds
  s_mov_b64 exec, -1
  v_mfma_f32_16x16x32_bf16 v[172:175], v[92:95], v[40:43], v[172:175]
  s_add_u32 m0, s41, 992
  s_mov_b64 exec, s[46:47]
  buffer_load_dwordx4 v5, s[20:23], s34 offen lds
  s_mov_b64 exec, -1
  v_mfma_f32_16x16x32_bf16 v[140:143], v[92:95], v[36:39], v[140:143]
  s_add_u32 m0, s41, 1984
  s_mov_b64 exec, s[46:47]
  buffer_load_dwordx4 v6, s[20:23], s34 offen lds
  s_mov_b64 exec, -1
  v_mfma_f32_16x16x32_bf16 v[208:211], v[96:99], v[44:47], v[208:211]
  s_add_u32 m0, s41, 2976
  s_mov_b64 exec, s[46:47]
  buffer_load_dwordx4 v7, s[20:23], s34 offen lds
  s_mov_b64 exec, -1
  s_add_u32 s34, s34, 122880
  s_cmp_ge_u32 s34, 2457600
  s_cselect_b32 s41, 2457600, 0
  s_sub_u32 s34, s34, s41
  s_add_u32 s39, s39, 31744
  s_cmp_ge_u32 s39, 126976
  s_cselect_b32 s39, 0, s39
  v_mfma_f32_16x16x32_bf16 v[176:179], v[96:99], v[40:43], v[176:179]
  s_add_u32 s42, s38, s40
  s_add_u32 m0, s42, 1024
  s_mov_b32 exec_hi, 0
  buffer_load_dwordx4 v9, s[16:19], s35 offen lds
  s_mov_b32 exec_hi, -1
  s_add_u32 s35, s35, 128
  s_cmp_ge_u32 s35, 1280
  s_cselect_b32 s35, 0, s35
  s_add_u32 s40, s40, 12288
  s_cmp_ge_u32 s40, 36864
  s_cselect_b32 s40, 0, s40
  s_add_u32 s41, s37, s39
  s_add_u32 m0, s41, 0
  s_mov_b64 exec, s[46:47]
  buffer_load_dwordx4 v4, s[20:23], s34 offen lds
  s_mov_b64 exec, -1
  v_mfma_f32_16x16x32_bf16 v[144:147], v[96:99], v[36:39], v[144:147]
  s_add_u32 m0, s41, 992
  s_mov_b64 exec, s[46:47]
  buffer_load_dwordx4 v5, s[20:23], s34 offen lds
  s_mov_b64 exec, -1
  v_mfma_f32_16x16x32_bf16 v[212:215], v[100:103], v[44:47], v[212:215]
  s_add_u32 m0, s41, 1984
  s_mov_b64 exec, s[46:47]
  buffer_load_dwordx4 v6, s[20:23], s34 offen lds
  s_mov_b64 exec, -1
  v_mfma_f32_16x16x32_bf16 v[180:183], v[100:103], v[40:43], v[180:183]
  s_add_u32 m0, s41, 2976
  s_mov_b64 exec, s[46:47]
  buffer_load_dwordx4 v7, s[20:23], s34 offen lds
  s_mov_b64 exec, -1
  s_add_u32 s34, s34, 122880
  s_cmp_ge_u32 s34, 2457600
  s_cselect_b32 s41, 2457600, 0
  s_sub_u32 s34, s34, s41
  s_add_u32 s39, s39, 31744
  s_cmp_ge_u32 s39, 126976
  s_cselect_b32 s39, 0, s39
  v_mfma_f32_16x16x32_bf16 v[148:151], v[100:103], v[36:39], v[148:151]
  s_add_u32 s42, s38, s40
  s_add_u32 m0, s42, 0
  s_nop 0
  buffer_load_dwordx4 v8, s[16:19], s35 offen lds
LQ_vj_h1:
  s_cmp_eq_u32 s44, 3
  s_cbranch_scc1 LQ_n3_h1
  v_mfma_f32_16x16x32_bf16 v[152:155], v[104:107], v[36:39], v[152:155]
  v_mfma_f32_16x16x32_bf16 v[184:187], v[104:107], v[40:43], v[184:187]
  v_mfma_f32_16x16x32_bf16 v[216:219], v[104:107], v[44:47], v[216:219]
  v_mfma_f32_16x16x32_bf16 v[156:159], v[108:111], v[36:39], v[156:159]
  v_mfma_f32_16x16x32_bf16 v[188:191], v[108:111], v[40:43], v[188:191]
  v_mfma_f32_16x16x32_bf16 v[220:223], v[108:111], v[44:47], v[220:223]
  s_branch LQ_nj_h1
LQ_n3_h1:
  v_mfma_f32_16x16x32_bf16 v[152:155], v[20:23], v[36:39], v[152:155]
  v_mfma_f32_16x16x32_bf16 v[156:159], v[36:39], v[36:39], v[156:159]
  v_mfma_f32_16x16x32_bf16 v[184:187], v[20:23], v[40:43], v[184:187]
  v_mfma_f32_16x16x32_bf16 v[188:191], v[40:43], v[40:43], v[188:191]
  v_mfma_f32_16x16x32_bf16 v[216:219], v[20:23], v[44:47], v[216:219]
  v_mfma_f32_16x16x32_bf16 v[220:223], v[44:47], v[44:47], v[220:223]
LQ_nj_h1:
  s_mov_b32 s36, 6
LQ_loop:
  s_waitcnt vmcnt(11) lgkmcnt(0)
  s_barrier
  s_mov_b64 exec, s[48:49]
  v_mov_b32 v24, v20
  v_mov_b32 v25, v20
  v_mov_b32 v26, v20
  v_mov_b32 v27, v20
  s_mov_b64 exec, -1
  s_cmp_eq_u32 s43, 0
  s_cbranch_scc0 LQ_v1_a
  v_mfma_f32_16x16x32_bf16 v[192:195], v[48:51], v[32:35], v[192:195]
  s_add_u32 s41, s37, s39
  s_add_u32 m0, s41, 0
  s_mov_b64 exec, s[46:47]
  buffer_load_dwordx4 v4, s[20:23], s34 offen lds
  s_mov_b64 exec, -1
  v_mfma_f32_16x16x32_bf16 v[160:163], v[48:51], v[28:31], v[160:163]
  s_add_u32 m0, s41, 992
  s_mov_b64 exec, s[46:47]
  buffer_load_dwordx4 v5, s[20:23], s34 offen lds
  s_mov_b64 exec, -1
  v_mfma_f32_16x16x32_bf16 v[128:131], v[48:51], v[24:27], v[128:131]
  v_mfma_f32_16x16x32_bf16 v[196:199], v[52:55], v[32:35], v[196:199]
  s_add_u32 m0, s41, 1984
  s_mov_b64 exec, s[46:47]
  buffer_load_dwordx4 v6, s[20:23], s34 offen lds
  s_mov_b64 exec, -1
  v_mfma_f32_16x16x32_bf16 v[164:167], v[52:55], v[28:31], v[164:167]
  v_mfma_f32_16x16x32_bf16 v[132:135], v[52:55], v[24:27], v[132:135]
  s_add_u32 m0, s41, 2976
  s_mov_b64 exec, s[46:47]
  buffer_load_dwordx4 v7, s[20:23], s34 offen lds
  s_mov_b64 exec, -1
  s_add_u32 s34, s34, 122880
  s_cmp_ge_u32 s34, 2457600
  s_cselect_b32 s41, 2457600, 0
  s_sub_u32 s34, s34, s41
  s_add_u32 s39, s39, 31744
  s_cmp_ge_u32 s39, 126976
  s_cselect_b32 s39, 0, s39
  v_mfma_f32_16x16x32_bf16 v[200:203], v[56:59], v[32:35], v[200:203]
  v_mfma_f32_16x16x32_bf16 v[168:171], v[56:59], v[28:31], v[168:171]
  s_add_u32 s42, s38, s40
  s_add_u32 m0, s42, 1024
  s_mov_b32 exec_hi, 0
  buffer_load_dwordx4 v9, s[16:19], s35 offen lds
  s_mov_b32 exec_hi, -1
  s_add_u32 s35, s35, 128
  s_cmp_ge_u32 s35, 1280
  s_cselect_b32 s35, 0, s35
  s_add_u32 s40, s40, 12288
  s_cmp_ge_u32 s40, 36864
  s_cselect_b32 s40, 0, s40
  v_mfma_f32_16x16x32_bf16 v[136:139], v[56:59], v[24:27], v[136:139]
  v_mfma_f32_16x16x32_bf16 v[204:207], v[60:63], v[32:35], v[204:207]
  ds_read_b128 v[36:39], v14 offset:0
  ds_read_b128 v[40:43], v14 offset:2048
  ds_read_b128 v[44:47], v14 offset:4096
  v_mfma_f32_16x16x32_bf16 v[172:175], v[60:63], v[28:31], v[172:175]
  ds_read_b64_tr_b16 v[80:81], v10 offset:0
  ds_read_b64_tr_b16 v[82:83], v10 offset:7936
  v_mfma_f32_16x16x32_bf16 v[140:143], v[60:63], v[24:27], v[140:143]
  ds_read_b64_tr_b16 v[84:85], v10 offset:32
  ds_read_b64_tr_b16 v[86:87], v10 offset:7968
  ds_read_b64_tr_b16 v[88:89], v10 offset:64
  v_mfma_f32_16x16x32_bf16 v[208:211], v[64:67], v[32:35], v[208:211]
  ds_read_b64_tr_b16 v[90:91], v10 offset:8000
  ds_read_b64_tr_b16 v[92:93], v10 offset:96
  v_mfma_f32_16x16x32_bf16 v[176:179], v[64:67], v[28:31], v[176:179]
  ds_read_b64_tr_b16 v[94:95], v10 offset:8032
  ds_read_b64_tr_b16 v[96:97], v10 offset:128
  ds_read_b64_tr_b16 v[98:99], v10 offset:8064
  v_mfma_f32_16x16x32_bf16 v[144:147], v[64:67], v[24:27], v[144:147]
  ds_read_b64_tr_b16 v[100:101], v10 offset:160
  ds_read_b64_tr_b16 v[102:103], v10 offset:8096
  v_mfma_f32_16x16x32_bf16 v[212:215], v[68:71], v[32:35], v[212:215]
  ds_read_b64_tr_b16 v[104:105], v10 offset:192
  ds_read_b64_tr_b16 v[106:107], v10 offset:8128
  ds_read_b64_tr_b16 v[108:109], v10 offset:224
  v_mfma_f32_16x16x32_bf16 v[180:183], v[68:71], v[28:31], v[180:183]
  ds_read_b64_tr_b16 v[110:111], v10 offset:8160
  s_add_u32 s54, s54, 31744
  s_cmp_ge_u32 s54, 126976
  s_cselect_b32 s42, 4294872064, s56
  s_cselect_b32 s54, 0, s54
  v_add_u32 v10, s42, v10
  v_mfma_f32_16x16x32_bf16 v[148:151], v[68:71], v[24:27], v[148:151]
  s_branch LQ_vj_a
LQ_v1_a:
  v_mfma_f32_16x16x32_bf16 v[192:195], v[48:51], v[32:35], v[192:195]
  ds_read_b128 v[36:39], v14 offset:0
  ds_read_b128 v[40:43], v14 offset:2048
  ds_read_b128 v[44:47], v14 offset:4096
  v_mfma_f32_16x16x32_bf16 v[160:163], v[48:51], v[28:31], v[160:163]
  ds_read_b64_tr_b16 v[80:81], v10 offset:0
  ds_read_b64_tr_b16 v[82:83], v10 offset:7936
  v_mfma_f32_16x16x32_bf16 v[128:131], v[48:51], v[24:27], v[128:131]
  ds_read_b64_tr_b16 v[84:85], v10 offset:32
  ds_read_b64_tr_b16 v[86:87], v10 offset:7968
  ds_read_b64_tr_b16 v[88:89], v10 offset:64
  v_mfma_f32_16x16x32_bf16 v[196:199], v[52:55], v[32:35], v[196:199]
  ds_read_b64_tr_b16 v[90:91], v10 offset:8000
  ds_read_b64_tr_b16 v[92:93], v10 offset:96
  v_mfma_f32_16x16x32_bf16 v[164:167], v[52:55], v[28:31], v[164:167]
  ds_read_b64_tr_b16 v[94:95], v10 offset:8032
  ds_read_b64_tr_b16 v[96:97], v10 offset:128
  ds_read_b64_tr_b16 v[98:99], v10 offset:8064
  v_mfma_f32_16x16x32_bf16 v[132:135], v[52:55], v[24:27], v[132:135]
  ds_read_b64_tr_b16 v[100:101], v10 offset:160
  ds_read_b64_tr_b16 v[102:103], v10 offset:8096
  v_mfma_f32_16x16x32_bf16 v[200:203], v[56:59], v[32:35], v[200:203]
  ds_read_b64_tr_b16 v[104:105], v10 offset:192
  ds_read_b64_tr_b16 v[106:107], v10 offset:8128
  ds_read_b64_tr_b16 v[108:109], v10 offset:224
  v_mfma_f32_16x16x32_bf16 v[168:171], v[56:59], v[28:31], v[168:171]
  ds_read_b64_tr_b16 v[110:111], v10 offset:8160
  s_add_u32 s54, s54, 31744
  s_cmp_ge_u32 s54, 126976
  s_cselect_b32 s42, 4294872064, s56
  s_cselect_b32 s54, 0, s54
  v_add_u32 v10, s42, v10
  v_mfma_f32_16x16x32_bf16 v[136:139], v[56:59], v[24:27], v[136:139]
  v_mfma_f32_16x16x32_bf16 v[204:207], v[60:63], v[32:35], v[204:207]
  s_add_u32 s41, s37, s39
  s_add_u32 m0, s41, 0
  s_mov_b64 exec, s[46:47]
  buffer_load_dwordx4 v4, s[20:23], s34 offen lds
  s_mov_b64 exec, -1
  v_mfma_f32_16x16x32_bf16 v[172:175], v[60:63], v[28:31], v[172:175]
  s_add_u32 m0, s41, 992
  s_mov_b64 exec, s[46:47]
  buffer_load_dwordx4 v5, s[20:23], s34 offen lds
  s_mov_b64 exec, -1
  v_mfma_f32_16x16x32_bf16 v[140:143], v[60:63], v[24:27], v[140:143]
  v_mfma_f32_16x16x32_bf16 v[208:211], v[64:67], v[32:35], v[208:211]
  s_add_u32 m0, s41, 1984
  s_mov_b64 exec, s[46:47]
  buffer_load_dwordx4 v6, s[20:23], s34 offen lds
  s_mov_b64 exec, -1
  v_mfma_f32_16x16x32_bf16 v[176:179], v[64:67], v[28:31], v[176:179]
  v_mfma_f32_16x16x32_bf16 v[144:147], v[64:67], v[24:27], v[144:147]
  s_add_u32 m0, s41, 2976
  s_mov_b64 exec, s[46:47]
  buffer_load_dwordx4 v7, s[20:23], s34 offen lds
  s_mov_b64 exec, -1
  s_add_u32 s34, s34, 122880
  s_cmp_ge_u32 s34, 2457600
  s_cselect_b32 s41, 2457600, 0
  s_sub_u32 s34, s34, s41
  s_add_u32 s39, s39, 31744
  s_cmp_ge_u32 s39, 126976
  s_cselect_b32 s39, 0, s39
  v_mfma_f32_16x16x32_bf16 v[212:215], v[68:71], v[32:35], v[212:215]
  v_mfma_f32_16x16x32_bf16 v[180:183], v[68:71], v[28:31], v[180:183]
  s_add_u32 s42, s38, s40
  s_add_u32 m0, s42, 1024
  s_mov_b32 exec_hi, 0
  buffer_load_dwordx4 v9, s[16:19], s35 offen lds
  s_mov_b32 exec_hi, -1
  s_add_u32 s35, s35, 128
  s_cmp_ge_u32 s35, 1280
  s_cselect_b32 s35, 0, s35
  s_add_u32 s40, s40, 12288
  s_cmp_ge_u32 s40, 36864
  s_cselect_b32 s40, 0, s40
  v_mfma_f32_16x16x32_bf16 v[148:151], v[68:71], v[24:27], v[148:151]
LQ_vj_a:
  s_cmp_eq_u32 s44, 3
  s_cbranch_scc1 LQ_n3_a
  v_mfma_f32_16x16x32_bf16 v[152:155], v[72:75], v[24:27], v[152:155]
  v_mfma_f32_16x16x32_bf16 v[184:187], v[72:75], v[28:31], v[184:187]
  v_mfma_f32_16x16x32_bf16 v[216:219], v[72:75], v[32:35], v[216:219]
  v_mfma_f32_16x16x32_bf16 v[156:159], v[76:79], v[24:27], v[156:159]
  v_mfma_f32_16x16x32_bf16 v[188:191], v[76:79], v[28:31], v[188:191]
  v_mfma_f32_16x16x32_bf16 v[220:223], v[76:79], v[32:35], v[220:223]
  s_branch LQ_nj_a
LQ_n3_a:
  v_mfma_f32_16x16x32_bf16 v[152:155], v[20:23], v[24:27], v[152:155]
  v_mfma_f32_16x16x32_bf16 v[156:159], v[24:27], v[24:27], v[156:159]
  v_mfma_f32_16x16x32_bf16 v[184:187], v[20:23], v[28:31], v[184:187]
  v_mfma_f32_16x16x32_bf16 v[188:191], v[28:31], v[28:31], v[188:191]
  v_mfma_f32_16x16x32_bf16 v[216:219], v[20:23], v[32:35], v[216:219]
  v_mfma_f32_16x16x32_bf16 v[220:223], v[32:35], v[32:35], v[220:223]
LQ_nj_a:
  s_waitcnt vmcnt(10) lgkmcnt(0)
  s_barrier
  s_mov_b64 exec, s[48:49]
  v_mov_b32 v36, v20
  v_mov_b32 v37, v20
  v_mov_b32 v38, v20
  v_mov_b32 v39, v20
  s_mov_b64 exec, -1
  s_cmp_eq_u32 s43, 0
  s_cbranch_scc0 LQ_v1_b
  v_mfma_f32_16x16x32_bf16 v[192:195], v[80:83], v[44:47], v[192:195]
  s_add_u32 s41, s37, s39
  s_add_u32 m0, s41, 0
  s_mov_b64 exec, s[46:47]
  buffer_load_dwordx4 v4, s[20:23], s34 offen lds
  s_mov_b64 exec, -1
  v_mfma_f32_16x16x32_bf16 v[160:163], v[80:83], v[40:43], v[160:163]
  s_add_u32 m0, s41, 992
  s_mov_b64 exec, s[46:47]
  buffer_load_dwordx4 v5, s[20:23], s34 offen lds
  s_mov_b64 exec, -1
  v_mfma_f32_16x16x32_bf16 v[128:131], v[80:83], v[36:39], v[128:131]
  v_mfma_f32_16x16x32_bf16 v[196:199], v[84:87], v[44:47], v[196:199]
  s_add_u32 m0, s41, 1984
  s_mov_b64 exec, s[46:47]
  buffer_load_dwordx4 v6, s[20:23], s34 offen lds
  s_mov_b64 exec, -1
  v_mfma_f32_16x16x32_bf16 v[164:167], v[84:87], v[40:43], v[164:167]
  v_mfma_f32_16x16x32_bf16 v[132:135], v[84:87], v[36:39], v[132:135]
  s_add_u32 m0, s41, 2976
  s_mov_b64 exec, s[46:47]
  buffer_load_dwordx4 v7, s[20:23], s34 offen lds
  s_mov_b64 exec, -1
  s_add_u32 s34, s34, 122880
  s_cmp_ge_u32 s34, 2457600
  s_cselect_b32 s41, 2457600, 0
  s_sub_u32 s34, s34, s41
  s_add_u32 s39, s39, 31744
  s_cmp_ge_u32 s39, 126976
  s_cselect_b32 s39, 0, s39
  v_mfma_f32_16x16x32_bf16 v[200:203], v[88:91], v[44:47], v[200:203]
  v_mfma_f32_16x16x32_bf16 v[168:171], v[88:91], v[40:43], v[168:171]
  s_add_u32 s42, s38, s40
  s_add_u32 m0, s42, 0
  s_nop 0
  buffer_load_dwordx4 v8, s[16:19], s35 offen lds
  v_mfma_f32_16x16x32_bf16 v[136:139], v[88:91], v[36:39], v[136:139]
  v_mfma_f32_16x16x32_bf16 v[204:207], v[92:95], v[44:47], v[204:207]
  s_add_u32 s55, s55, 12288
  s_cmp_ge_u32 s55, 36864
  s_cselect_b32 s42, 4294942720, s57
  s_cselect_b32 s55, 0, s55
  v_add_u32 v13, s42, v13
  v_add_u32 v14, s42, v14
  ds_read_b128 v[24:27], v13 offset:0
  ds_read_b128 v[28:31], v13 offset:2048
  v_mfma_f32_16x16x32_bf16 v[172:175], v[92:95], v[40:43], v[172:175]
  ds_read_b128 v[32:35], v13 offset:4096
  ds_read_b64_tr_b16 v[48:49], v10 offset:0
  ds_read_b64_tr_b16 v[50:51], v10 offset:7936
  v_mfma_f32_16x16x32_bf16 v[140:143], v[92:95], v[36:39], v[140:143]
  ds_read_b64_tr_b16 v[52:53], v10 offset:32
  ds_read_b64_tr_b16 v[54:55], v10 offset:7968
  v_mfma_f32_16x16x32_bf16 v[208:211], v[96:99], v[44:47], v[208:211]
  ds_read_b64_tr_b16 v[56:57], v10 offset:64
  ds_read_b64_tr_b16 v[58:59], v10 offset:8000
  ds_read_b64_tr_b16 v[60:61], v10 offset:96
  v_mfma_f32_16x16x32_bf16 v[176:179], v[96:99], v[40:43], v[176:179]
  ds_read_b64_tr_b16 v[62:63], v10 offset:8032
  ds_read_b64_tr_b16 v[64:65], v10 offset:128
  ds_read_b64_tr_b16 v[66:67], v10 offset:8064
  v_mfma_f32_16x16x32_bf16 v[144:147], v[96:99], v[36:39], v[144:147]
  ds_read_b64_tr_b16 v[68:69], v10 offset:160
  ds_read_b64_tr_b16 v[70:71], v10 offset:8096
  v_mfma_f32_16x16x32_bf16 v[212:215], v[100:103], v[44:47], v[212:215]
  ds_read_b64_tr_b16 v[72:73], v10 offset:192
  ds_read_b64_tr_b16 v[74:75], v10 offset:8128
  ds_read_b64_tr_b16 v[76:77], v10 offset:224
  v_mfma_f32_16x16x32_bf16 v[180:183], v[100:103], v[40:43], v[180:183]
  ds_read_b64_tr_b16 v[78:79], v10 offset:8160
  s_add_u32 s54, s54, 31744
  s_cmp_ge_u32 s54, 126976
  s_cselect_b32 s42, 4294872064, s56
  s_cselect_b32 s54, 0, s54
  v_add_u32 v10, s42, v10
  v_mfma_f32_16x16x32_bf16 v[148:151], v[100:103], v[36:39], v[148:151]
  s_branch LQ_vj_b
LQ_v1_b:
  v_mfma_f32_16x16x32_bf16 v[192:195], v[80:83], v[44:47], v[192:195]
  s_add_u32 s55, s55, 12288
  s_cmp_ge_u32 s55, 36864
  s_cselect_b32 s42, 4294942720, s57
  s_cselect_b32 s55, 0, s55
  v_add_u32 v13, s42, v13
  v_add_u32 v14, s42, v14
  ds_read_b128 v[24:27], v13 offset:0
  ds_read_b128 v[28:31], v13 offset:2048
  v_mfma_f32_16x16x32_bf16 v[160:163], v[80:83], v[40:43], v[160:163]
  ds_read_b128 v[32:35], v13 offset:4096
  ds_read_b64_tr_b16 v[48:49], v10 offset:0
  ds_read_b64_tr_b16 v[50:51], v10 offset:7936
  v_mfma_f32_16x16x32_bf16 v[128:131], v[80:83], v[36:39], v[128:131]
  ds_read_b64_tr_b16 v[52:53], v10 offset:32
  ds_read_b64_tr_b16 v[54:55], v10 offset:7968
  v_mfma_f32_16x16x32_bf16 v[196:199], v[84:87], v[44:47], v[196:199]
  ds_read_b64_tr_b16 v[56:57], v10 offset:64
  ds_read_b64_tr_b16 v[58:59], v10 offset:8000
  ds_read_b64_tr_b16 v[60:61], v10 offset:96
  v_mfma_f32_16x16x32_bf16 v[164:167], v[84:87], v[40:43], v[164:167]
  ds_read_b64_tr_b16 v[62:63], v10 offset:8032
  ds_read_b64_tr_b16 v[64:65], v10 offset:128
  ds_read_b64_tr_b16 v[66:67], v10 offset:8064
  v_mfma_f32_16x16x32_bf16 v[132:135], v[84:87], v[36:39], v[132:135]
  ds_read_b64_tr_b16 v[68:69], v10 offset:160
  ds_read_b64_tr_b16 v[70:71], v10 offset:8096
  v_mfma_f32_16x16x32_bf16 v[200:203], v[88:91], v[44:47], v[200:203]
  ds_read_b64_tr_b16 v[72:73], v10 offset:192
  ds_read_b64_tr_b16 v[74:75], v10 offset:8128
  ds_read_b64_tr_b16 v[76:77], v10 offset:224
  v_mfma_f32_16x16x32_bf16 v[168:171], v[88:91], v[40:43], v[168:171]
  ds_read_b64_tr_b16 v[78:79], v10 offset:8160
  s_add_u32 s54, s54, 31744
  s_cmp_ge_u32 s54, 126976
  s_cselect_b32 s42, 4294872064, s56
  s_cselect_b32 s54, 0, s54
  v_add_u32 v10, s42, v10
  v_mfma_f32_16x16x32_bf16 v[136:139], v[88:91], v[36:39], v[136:139]
  v_mfma_f32_16x16x32_bf16 v[204:207], v[92:95], v[44:47], v[204:207]
  s_add_u32 s41, s37, s39
  s_add_u32 m0, s41, 0
  s_mov_b64 exec, s[46:47]
  buffer_load_dwordx4 v4, s[20:23], s34 offen lds
  s_mov_b64 exec, -1
  v_mfma_f32_16x16x32_bf16 v[172:175], v[92:95], v[40:43], v[172:175]
  s_add_u32 m0, s41, 992
  s_mov_b64 exec, s[46:47]
  buffer_load_dwordx4 v5, s[20:23], s34 offen lds
  s_mov_b64 exec, -1
  v_mfma_f32_16x16x32_bf16 v[140:143], v[92:95], v[36:39], v[140:143]
  v_mfma_f32_16x16x32_bf16 v[208:211], v[96:99], v[44:47], v[208:211]
  s_add_u32 m0, s41, 1984
  s_mov_b64 exec, s[46:47]
  buffer_load_dwordx4 v6, s[20:23], s34 offen lds
  s_mov_b64 exec, -1
  v_mfma_f32_16x16x32_bf16 v[176:179], v[96:99], v[40:43], v[176:179]
  v_mfma_f32_16x16x32_bf16 v[144:147], v[96:99], v[36:39], v[144:147]
  s_add_u32 m0, s41, 2976
  s_mov_b64 exec, s[46:47]
  buffer_load_dwordx4 v7, s[20:23], s34 offen lds
  s_mov_b64 exec, -1
  s_add_u32 s34, s34, 122880
  s_cmp_ge_u32 s34, 2457600
  s_cselect_b32 s41, 2457600, 0
  s_sub_u32 s34, s34, s41
  s_add_u32 s39, s39, 31744
  s_cmp_ge_u32 s39, 126976
  s_cselect_b32 s39, 0, s39
  v_mfma_f32_16x16x32_bf16 v[212:215], v[100:103], v[44:47], v[212:215]
  v_mfma_f32_16x16x32_bf16 v[180:183], v[100:103], v[40:43], v[180:183]
  s_add_u32 s42, s38, s40
  s_add_u32 m0, s42, 0
  s_nop 0
  buffer_load_dwordx4 v8, s[16:19], s35 offen lds
  v_mfma_f32_16x16x32_bf16 v[148:151], v[100:103], v[36:39], v[148:151]
LQ_vj_b:
  s_cmp_eq_u32 s44, 3
  s_cbranch_scc1 LQ_n3_b
  v_mfma_f32_16x16x32_bf16 v[152:155], v[104:107], v[36:39], v[152:155]
  v_mfma_f32_16x16x32_bf16 v[184:187], v[104:107], v[40:43], v[184:187]
  v_mfma_f32_16x16x32_bf16 v[216:219], v[104:107], v[44:47], v[216:219]
  v_mfma_f32_16x16x32_bf16 v[156:159], v[108:111], v[36:39], v[156:159]
  v_mfma_f32_16x16x32_bf16 v[188:191], v[108:111], v[40:43], v[188:191]
  v_mfma_f32_16x16x32_bf16 v[220:223], v[108:111], v[44:47], v[220:223]
  s_branch LQ_nj_b
LQ_n3_b:
  v_mfma_f32_16x16x32_bf16 v[152:155], v[20:23], v[36:39], v[152:155]
  v_mfma_f32_16x16x32_bf16 v[156:159], v[36:39], v[36:39], v[156:159]
  v_mfma_f32_16x16x32_bf16 v[184:187], v[20:23], v[40:43], v[184:187]
  v_mfma_f32_16x16x32_bf16 v[188:191], v[40:43], v[40:43], v[188:191]
  v_mfma_f32_16x16x32_bf16 v[216:219], v[20:23], v[44:47], v[216:219]
  v_mfma_f32_16x16x32_bf16 v[220:223], v[44:47], v[44:47], v[220:223]
LQ_nj_b:
  s_sub_u32 s36, s36, 1
  s_cmp_lg_u32 s36, 0
  s_cbranch_scc1 LQ_loop
  s_waitcnt vmcnt(11) lgkmcnt(0)
  s_barrier
  s_mov_b64 exec, s[48:49]
  v_mov_b32 v24, v20
  v_mov_b32 v25, v20
  v_mov_b32 v26, v20
  v_mov_b32 v27, v20
  s_mov_b64 exec, -1
  s_cmp_eq_u32 s43, 0
  s_cbranch_scc0 LQ_v1_t14
  v_mfma_f32_16x16x32_bf16 v[192:195], v[48:51], v[32:35], v[192:195]
  s_add_u32 s41, s37, s39
  s_add_u32 m0, s41, 0
  s_mov_b64 exec, s[46:47]
  buffer_load_dwordx4 v4, s[20:23], s34 offen lds
  s_mov_b64 exec, -1
  v_mfma_f32_16x16x32_bf16 v[160:163], v[48:51], v[28:31], v[160:163]
  s_add_u32 m0, s41, 992
  s_mov_b64 exec, s[46:47]
  buffer_load_dwordx4 v5, s[20:23], s34 offen lds
  s_mov_b64 exec, -1
  v_mfma_f32_16x16x32_bf16 v[128:131], v[48:51], v[24:27], v[128:131]
  v_mfma_f32_16x16x32_bf16 v[196:199], v[52:55], v[32:35], v[196:199]
  s_add_u32 m0, s41, 1984
  s_mov_b64 exec, s[46:47]
  buffer_load_dwordx4 v6, s[20:23], s34 offen lds
  s_mov_b64 exec, -1
  v_mfma_f32_16x16x32_bf16 v[164:167], v[52:55], v[28:31], v[164:167]
  v_mfma_f32_16x16x32_bf16 v[132:135], v[52:55], v[24:27], v[132:135]
  s_add_u32 m0, s41, 2976
  s_mov_b64 exec, s[46:47]
  buffer_load_dwordx4 v7, s[20:23], s34 offen lds
  s_mov_b64 exec, -1
  s_add_u32 s34, s34, 122880
  s_cmp_ge_u32 s34, 2457600
  s_cselect_b32 s41, 2457600, 0
  s_sub_u32 s34, s34, s41
  s_add_u32 s39, s39, 31744
  s_cmp_ge_u32 s39, 126976
  s_cselect_b32 s39, 0, s39
  v_mfma_f32_16x16x32_bf16 v[200:203], v[56:59], v[32:35], v[200:203]
  v_mfma_f32_16x16x32_bf16 v[168:171], v[56:59], v[28:31], v[168:171]
  s_add_u32 s42, s38, s40
  s_add_u32 m0, s42, 1024
  s_mov_b32 exec_hi, 0
  buffer_load_dwordx4 v9, s[16:19], s35 offen lds
  s_mov_b32 exec_hi, -1
  s_add_u32 s35, s35, 128
  s_cmp_ge_u32 s35, 1280
  s_cselect_b32 s35, 0, s35
  s_add_u32 s40, s40, 12288
  s_cmp_ge_u32 s40, 36864
  s_cselect_b32 s40, 0, s40
  v_mfma_f32_16x16x32_bf16 v[136:139], v[56:59], v[24:27], v[136:139]
  v_mfma_f32_16x16x32_bf16 v[204:207], v[60:63], v[32:35], v[204:207]
  ds_read_b128 v[36:39], v14 offset:0
  ds_read_b128 v[40:43], v14 offset:2048
  ds_read_b128 v[44:47], v14 offset:4096
  v_mfma_f32_16x16x32_bf16 v[172:175], v[60:63], v[28:31], v[172:175]
  ds_read_b64_tr_b16 v[80:81], v10 offset:0
  ds_read_b64_tr_b16 v[82:83], v10 offset:7936
  v_mfma_f32_16x16x32_bf16 v[140:143], v[60:63], v[24:27], v[140:143]
  ds_read_b64_tr_b16 v[84:85], v10 offset:32
  ds_read_b64_tr_b16 v[86:87], v10 offset:7968
  ds_read_b64_tr_b16 v[88:89], v10 offset:64
  v_mfma_f32_16x16x32_bf16 v[208:211], v[64:67], v[32:35], v[208:211]
  ds_read_b64_tr_b16 v[90:91], v10 offset:8000
  ds_read_b64_tr_b16 v[92:93], v10 offset:96
  v_mfma_f32_16x16x32_bf16 v[176:179], v[64:67], v[28:31], v[176:179]
  ds_read_b64_tr_b16 v[94:95], v10 offset:8032
  ds_read_b64_tr_b16 v[96:97], v10 offset:128
  ds_read_b64_tr_b16 v[98:99], v10 offset:8064
  v_mfma_f32_16x16x32_bf16 v[144:147], v[64:67], v[24:27], v[144:147]
  ds_read_b64_tr_b16 v[100:101], v10 offset:160
  ds_read_b64_tr_b16 v[102:103], v10 offset:8096
  v_mfma_f32_16x16x32_bf16 v[212:215], v[68:71], v[32:35], v[212:215]
  ds_read_b64_tr_b16 v[104:105], v10 offset:192
  ds_read_b64_tr_b16 v[106:107], v10 offset:8128
  ds_read_b64_tr_b16 v[108:109], v10 offset:224
  v_mfma_f32_16x16x32_bf16 v[180:183], v[68:71], v[28:31], v[180:183]
  ds_read_b64_tr_b16 v[110:111], v10 offset:8160
  s_add_u32 s54, s54, 31744
  s_cmp_ge_u32 s54, 126976
  s_cselect_b32 s42, 4294872064, s56
  s_cselect_b32 s54, 0, s54
  v_add_u32 v10, s42, v10
  v_mfma_f32_16x16x32_bf16 v[148:151], v[68:71], v[24:27], v[148:151]
  s_branch LQ_vj_t14
LQ_v1_t14:
  v_mfma_f32_16x16x32_bf16 v[192:195], v[48:51], v[32:35], v[192:195]
  ds_read_b128 v[36:39], v14 offset:0
  ds_read_b128 v[40:43], v14 offset:2048
  ds_read_b128 v[44:47], v14 offset:4096
  v_mfma_f32_16x16x32_bf16 v[160:163], v[48:51], v[28:31], v[160:163]
  ds_read_b64_tr_b16 v[80:81], v10 offset:0
  ds_read_b64_tr_b16 v[82:83], v10 offset:7936
  v_mfma_f32_16x16x32_bf16 v[128:131], v[48:51], v[24:27], v[128:131]
  ds_read_b64_tr_b16 v[84:85], v10 offset:32
  ds_read_b64_tr_b16 v[86:87], v10 offset:7968
  ds_read_b64_tr_b16 v[88:89], v10 offset:64
  v_mfma_f32_16x16x32_bf16 v[196:199], v[52:55], v[32:35], v[196:199]
  ds_read_b64_tr_b16 v[90:91], v10 offset:8000
  ds_read_b64_tr_b16 v[92:93], v10 offset:96
  v_mfma_f32_16x16x32_bf16 v[164:167], v[52:55], v[28:31], v[164:167]
  ds_read_b64_tr_b16 v[94:95], v10 offset:8032
  ds_read_b64_tr_b16 v[96:97], v10 offset:128
  ds_read_b64_tr_b16 v[98:99], v10 offset:8064
  v_mfma_f32_16x16x32_bf16 v[132:135], v[52:55], v[24:27], v[132:135]
  ds_read_b64_tr_b16 v[100:101], v10 offset:160
  ds_read_b64_tr_b16 v[102:103], v10 offset:8096
  v_mfma_f32_16x16x32_bf16 v[200:203], v[56:59], v[32:35], v[200:203]
  ds_read_b64_tr_b16 v[104:105], v10 offset:192
  ds_read_b64_tr_b16 v[106:107], v10 offset:8128
  ds_read_b64_tr_b16 v[108:109], v10 offset:224
  v_mfma_f32_16x16x32_bf16 v[168:171], v[56:59], v[28:31], v[168:171]
  ds_read_b64_tr_b16 v[110:111], v10 offset:8160
  s_add_u32 s54, s54, 31744
  s_cmp_ge_u32 s54, 126976
  s_cselect_b32 s42, 4294872064, s56
  s_cselect_b32 s54, 0, s54
  v_add_u32 v10, s42, v10
  v_mfma_f32_16x16x32_bf16 v[136:139], v[56:59], v[24:27], v[136:139]
  v_mfma_f32_16x16x32_bf16 v[204:207], v[60:63], v[32:35], v[204:207]
  s_add_u32 s41, s37, s39
  s_add_u32 m0, s41, 0
  s_mov_b64 exec, s[46:47]
  buffer_load_dwordx4 v4, s[20:23], s34 offen lds
  s_mov_b64 exec, -1
  v_mfma_f32_16x16x32_bf16 v[172:175], v[60:63], v[28:31], v[172:175]
  s_add_u32 m0, s41, 992
  s_mov_b64 exec, s[46:47]
  buffer_load_dwordx4 v5, s[20:23], s34 offen lds
  s_mov_b64 exec, -1
  v_mfma_f32_16x16x32_bf16 v[140:143], v[60:63], v[24:27], v[140:143]
  v_mfma_f32_16x16x32_bf16 v[208:211], v[64:67], v[32:35], v[208:211]
  s_add_u32 m0, s41, 1984
  s_mov_b64 exec, s[46:47]
  buffer_load_dwordx4 v6, s[20:23], s34 offen lds
  s_mov_b64 exec, -1
  v_mfma_f32_16x16x32_bf16 v[176:179], v[64:67], v[28:31], v[176:179]
  v_mfma_f32_16x16x32_bf16 v[144:147], v[64:67], v[24:27], v[144:147]
  s_add_u32 m0, s41, 2976
  s_mov_b64 exec, s[46:47]
  buffer_load_dwordx4 v7, s[20:23], s34 offen lds
  s_mov_b64 exec, -1
  s_add_u32 s34, s34, 122880
  s_cmp_ge_u32 s34, 2457600
  s_cselect_b32 s41, 2457600, 0
  s_sub_u32 s34, s34, s41
  s_add_u32 s39, s39, 31744
  s_cmp_ge_u32 s39, 126976
  s_cselect_b32 s39, 0, s39
  v_mfma_f32_16x16x32_bf16 v[212:215], v[68:71], v[32:35], v[212:215]
  v_mfma_f32_16x16x32_bf16 v[180:183], v[68:71], v[28:31], v[180:183]
  s_add_u32 s42, s38, s40
  s_add_u32 m0, s42, 1024
  s_mov_b32 exec_hi, 0
  buffer_load_dwordx4 v9, s[16:19], s35 offen lds
  s_mov_b32 exec_hi, -1
  s_add_u32 s35, s35, 128
  s_cmp_ge_u32 s35, 1280
  s_cselect_b32 s35, 0, s35
  s_add_u32 s40, s40, 12288
  s_cmp_ge_u32 s40, 36864
  s_cselect_b32 s40, 0, s40
  v_mfma_f32_16x16x32_bf16 v[148:151], v[68:71], v[24:27], v[148:151]
LQ_vj_t14:
  s_cmp_eq_u32 s44, 3
  s_cbranch_scc1 LQ_n3_t14
  v_mfma_f32_16x16x32_bf16 v[152:155], v[72:75], v[24:27], v[152:155]
  v_mfma_f32_16x16x32_bf16 v[184:187], v[72:75], v[28:31], v[184:187]
  v_mfma_f32_16x16x32_bf16 v[216:219], v[72:75], v[32:35], v[216:219]
  v_mfma_f32_16x16x32_bf16 v[156:159], v[76:79], v[24:27], v[156:159]
  v_mfma_f32_16x16x32_bf16 v[188:191], v[76:79], v[28:31], v[188:191]
  v_mfma_f32_16x16x32_bf16 v[220:223], v[76:79], v[32:35], v[220:223]
  s_branch LQ_nj_t14
LQ_n3_t14:
  v_mfma_f32_16x16x32_bf16 v[152:155], v[20:23], v[24:27], v[152:155]
  v_mfma_f32_16x16x32_bf16 v[156:159], v[24:27], v[24:27], v[156:159]
  v_mfma_f32_16x16x32_bf16 v[184:187], v[20:23], v[28:31], v[184:187]
  v_mfma_f32_16x16x32_bf16 v[188:191], v[28:31], v[28:31], v[188:191]
  v_mfma_f32_16x16x32_bf16 v[216:219], v[20:23], v[32:35], v[216:219]
  v_mfma_f32_16x16x32_bf16 v[220:223], v[32:35], v[32:35], v[220:223]
LQ_nj_t14:
  s_waitcnt vmcnt(10) lgkmcnt(0)
  s_barrier
  s_mov_b64 exec, s[48:49]
  v_mov_b32 v36, v20
  v_mov_b32 v37, v20
  v_mov_b32 v38, v20
  v_mov_b32 v39, v20
  s_mov_b64 exec, -1
  s_cmp_eq_u32 s43, 0
  s_cbranch_scc0 LQ_v1_t15
  v_mfma_f32_16x16x32_bf16 v[192:195], v[80:83], v[44:47], v[192:195]
  s_add_u32 s41, s37, s39
  s_add_u32 m0, s41, 0
  s_mov_b64 exec, s[46:47]
  buffer_load_dwordx4 v4, s[20:23], s34 offen lds
  s_mov_b64 exec, -1
  v_mfma_f32_16x16x32_bf16 v[160:163], v[80:83], v[40:43], v[160:163]
  v_mfma_f32_16x16x32_bf16 v[128:131], v[80:83], v[36:39], v[128:131]
  s_add_u32 m0, s41, 992
  s_mov_b64 exec, s[46:47]
  buffer_load_dwordx4 v5, s[20:23], s34 offen lds
  s_mov_b64 exec, -1
  v_mfma_f32_16x16x32_bf16 v[196:199], v[84:87], v[44:47], v[196:199]
  v_mfma_f32_16x16x32_bf16 v[164:167], v[84:87], v[40:43], v[164:167]
  s_add_u32 m0, s41, 1984
  s_mov_b64 exec, s[46:47]
  buffer_load_dwordx4 v6, s[20:23], s34 offen lds
  s_mov_b64 exec, -1
  v_mfma_f32_16x16x32_bf16 v[132:135], v[84:87], v[36:39], v[132:135]
  v_mfma_f32_16x16x32_bf16 v[200:203], v[88:91], v[44:47], v[200:203]
  s_add_u32 m0, s41, 2976
  s_mov_b64 exec, s[46:47]
  buffer_load_dwordx4 v7, s[20:23], s34 offen lds
  s_mov_b64 exec, -1
  s_add_u32 s34, s34, 122880
  s_cmp_ge_u32 s34, 2457600
  s_cselect_b32 s41, 2457600, 0
  s_sub_u32 s34, s34, s41
  s_add_u32 s39, s39, 31744
  s_cmp_ge_u32 s39, 126976
  s_cselect_b32 s39, 0, s39
  v_mfma_f32_16x16x32_bf16 v[168:171], v[88:91], v[40:43], v[168:171]
  v_mfma_f32_16x16x32_bf16 v[136:139], v[88:91], v[36:39], v[136:139]
  v_mfma_f32_16x16x32_bf16 v[204:207], v[92:95], v[44:47], v[204:207]
  s_add_u32 s55, s55, 12288
  s_cmp_ge_u32 s55, 36864
  s_cselect_b32 s42, 4294942720, s57
  s_cselect_b32 s55, 0, s55
  v_add_u32 v13, s42, v13
  v_add_u32 v14, s42, v14
  ds_read_b128 v[24:27], v13 offset:0
  ds_read_b128 v[28:31], v13 offset:2048
  v_mfma_f32_16x16x32_bf16 v[172:175], v[92:95], v[40:43], v[172:175]
  ds_read_b128 v[32:35], v13 offset:4096
  ds_read_b64_tr_b16 v[48:49], v10 offset:0
  ds_read_b64_tr_b16 v[50:51], v10 offset:7936
  v_mfma_f32_16x16x32_bf16 v[140:143], v[92:95], v[36:39], v[140:143]
  ds_read_b64_tr_b16 v[52:53], v10 offset:32
  ds_read_b64_tr_b16 v[54:55], v10 offset:7968
  v_mfma_f32_16x16x32_bf16 v[208:211], v[96:99], v[44:47], v[208:211]
  ds_read_b64_tr_b16 v[56:57], v10 offset:64
  ds_read_b64_tr_b16 v[58:59], v10 offset:8000
  ds_read_b64_tr_b16 v[60:61], v10 offset:96
  v_mfma_f32_16x16x32_bf16 v[176:179], v[96:99], v[40:43], v[176:179]
  ds_read_b64_tr_b16 v[62:63], v10 offset:8032
  ds_read_b64_tr_b16 v[64:65], v10 offset:128
  ds_read_b64_tr_b16 v[66:67], v10 offset:8064
  v_mfma_f32_16x16x32_bf16 v[144:147], v[96:99], v[36:39], v[144:147]
  ds_read_b64_tr_b16 v[68:69], v10 offset:160
  ds_read_b64_tr_b16 v[70:71], v10 offset:8096
  v_mfma_f32_16x16x32_bf16 v[212:215], v[100:103], v[44:47], v[212:215]
  ds_read_b64_tr_b16 v[72:73], v10 offset:192
  ds_read_b64_tr_b16 v[74:75], v10 offset:8128
  ds_read_b64_tr_b16 v[76:77], v10 offset:224
  v_mfma_f32_16x16x32_bf16 v[180:183], v[100:103], v[40:43], v[180:183]
  ds_read_b64_tr_b16 v[78:79], v10 offset:8160
  s_add_u32 s54, s54, 31744
  s_cmp_ge_u32 s54, 126976
  s_cselect_b32 s42, 4294872064, s56
  s_cselect_b32 s54, 0, s54
  v_add_u32 v10, s42, v10
  v_mfma_f32_16x16x32_bf16 v[148:151], v[100:103], v[36:39], v[148:151]
  s_branch LQ_vj_t15
LQ_v1_t15:
  v_mfma_f32_16x16x32_bf16 v[192:195], v[80:83], v[44:47], v[192:195]
  s_add_u32 s55, s55, 12288
  s_cmp_ge_u32 s55, 36864
  s_cselect_b32 s42, 4294942720, s57
  s_cselect_b32 s55, 0, s55
  v_add_u32 v13, s42, v13
  v_add_u32 v14, s42, v14
  ds_read_b128 v[24:27], v13 offset:0
  ds_read_b128 v[28:31], v13 offset:2048
  v_mfma_f32_16x16x32_bf16 v[160:163], v[80:83], v[40:43], v[160:163]
  ds_read_b128 v[32:35], v13 offset:4096
  ds_read_b64_tr_b16 v[48:49], v10 offset:0
  ds_read_b64_tr_b16 v[50:51], v10 offset:7936
  v_mfma_f32_16x16x32_bf16 v[128:131], v[80:83], v[36:39], v[128:131]
  ds_read_b64_tr_b16 v[52:53], v10 offset:32
  ds_read_b64_tr_b16 v[54:55], v10 offset:7968
  v_mfma_f32_16x16x32_bf16 v[196:199], v[84:87], v[44:47], v[196:199]
  ds_read_b64_tr_b16 v[56:57], v10 offset:64
  ds_read_b64_tr_b16 v[58:59], v10 offset:8000
  ds_read_b64_tr_b16 v[60:61], v10 offset:96
  v_mfma_f32_16x16x32_bf16 v[164:167], v[84:87], v[40:43], v[164:167]
  ds_read_b64_tr_b16 v[62:63], v10 offset:8032
  ds_read_b64_tr_b16 v[64:65], v10 offset:128
  ds_read_b64_tr_b16 v[66:67], v10 offset:8064
  v_mfma_f32_16x16x32_bf16 v[132:135], v[84:87], v[36:39], v[132:135]
  ds_read_b64_tr_b16 v[68:69], v10 offset:160
  ds_read_b64_tr_b16 v[70:71], v10 offset:8096
  v_mfma_f32_16x16x32_bf16 v[200:203], v[88:91], v[44:47], v[200:203]
  ds_read_b64_tr_b16 v[72:73], v10 offset:192
  ds_read_b64_tr_b16 v[74:75], v10 offset:8128
  ds_read_b64_tr_b16 v[76:77], v10 offset:224
  v_mfma_f32_16x16x32_bf16 v[168:171], v[88:91], v[40:43], v[168:171]
  ds_read_b64_tr_b16 v[78:79], v10 offset:8160
  s_add_u32 s54, s54, 31744
  s_cmp_ge_u32 s54, 126976
  s_cselect_b32 s42, 4294872064, s56
  s_cselect_b32 s54, 0, s54
  v_add_u32 v10, s42, v10
  v_mfma_f32_16x16x32_bf16 v[136:139], v[88:91], v[36:39], v[136:139]
  v_mfma_f32_16x16x32_bf16 v[204:207], v[92:95], v[44:47], v[204:207]
  s_add_u32 s41, s37, s39
  s_add_u32 m0, s41, 0
  s_mov_b64 exec, s[46:47]
  buffer_load_dwordx4 v4, s[20:23], s34 offen lds
  s_mov_b64 exec, -1
  v_mfma_f32_16x16x32_bf16 v[172:175], v[92:95], v[40:43], v[172:175]
  v_mfma_f32_16x16x32_bf16 v[140:143], v[92:95], v[36:39], v[140:143]
  s_add_u32 m0, s41, 992
  s_mov_b64 exec, s[46:47]
  buffer_load_dwordx4 v5, s[20:23], s34 offen lds
  s_mov_b64 exec, -1
  v_mfma_f32_16x16x32_bf16 v[208:211], v[96:99], v[44:47], v[208:211]
  v_mfma_f32_16x16x32_bf16 v[176:179], v[96:99], v[40:43], v[176:179]
  s_add_u32 m0, s41, 1984
  s_mov_b64 exec, s[46:47]
  buffer_load_dwordx4 v6, s[20:23], s34 offen lds
  s_mov_b64 exec, -1
  v_mfma_f32_16x16x32_bf16 v[144:147], v[96:99], v[36:39], v[144:147]
  v_mfma_f32_16x16x32_bf16 v[212:215], v[100:103], v[44:47], v[212:215]
  s_add_u32 m0, s41, 2976
  s_mov_b64 exec, s[46:47]
  buffer_load_dwordx4 v7, s[20:23], s34 offen lds
  s_mov_b64 exec, -1
  s_add_u32 s34, s34, 122880
  s_cmp_ge_u32 s34, 2457600
  s_cselect_b32 s41, 2457600, 0
  s_sub_u32 s34, s34, s41
  s_add_u32 s39, s39, 31744
  s_cmp_ge_u32 s39, 126976
  s_cselect_b32 s39, 0, s39
  v_mfma_f32_16x16x32_bf16 v[180:183], v[100:103], v[40:43], v[180:183]
  v_mfma_f32_16x16x32_bf16 v[148:151], v[100:103], v[36:39], v[148:151]
LQ_vj_t15:
  s_cmp_eq_u32 s44, 3
  s_cbranch_scc1 LQ_n3_t15
  v_mfma_f32_16x16x32_bf16 v[152:155], v[104:107], v[36:39], v[152:155]
  v_mfma_f32_16x16x32_bf16 v[184:187], v[104:107], v[40:43], v[184:187]
  v_mfma_f32_16x16x32_bf16 v[216:219], v[104:107], v[44:47], v[216:219]
  v_mfma_f32_16x16x32_bf16 v[156:159], v[108:111], v[36:39], v[156:159]
  v_mfma_f32_16x16x32_bf16 v[188:191], v[108:111], v[40:43], v[188:191]
  v_mfma_f32_16x16x32_bf16 v[220:223], v[108:111], v[44:47], v[220:223]
  s_branch LQ_nj_t15
LQ_n3_t15:
  v_mfma_f32_16x16x32_bf16 v[152:155], v[20:23], v[36:39], v[152:155]
  v_mfma_f32_16x16x32_bf16 v[156:159], v[36:39], v[36:39], v[156:159]
  v_mfma_f32_16x16x32_bf16 v[184:187], v[20:23], v[40:43], v[184:187]
  v_mfma_f32_16x16x32_bf16 v[188:191], v[40:43], v[40:43], v[188:191]
  v_mfma_f32_16x16x32_bf16 v[216:219], v[20:23], v[44:47], v[216:219]
  v_mfma_f32_16x16x32_bf16 v[220:223], v[44:47], v[44:47], v[220:223]
LQ_nj_t15:
  s_waitcnt vmcnt(10) lgkmcnt(0)
  s_barrier
  s_mov_b64 exec, s[48:49]
  v_mov_b32 v24, v20
  v_mov_b32 v25, v20
  v_mov_b32 v26, v20
  v_mov_b32 v27, v20
  s_mov_b64 exec, -1
  v_mfma_f32_16x16x32_bf16 v[192:195], v[48:51], v[32:35], v[192:195]
  ds_read_b128 v[36:39], v14 offset:0
  ds_read_b128 v[40:43], v14 offset:2048
  v_mfma_f32_16x16x32_bf16 v[160:163], v[48:51], v[28:31], v[160:163]
  ds_read_b128 v[44:47], v14 offset:4096
  ds_read_b64_tr_b16 v[80:81], v10 offset:0
  v_mfma_f32_16x16x32_bf16 v[128:131], v[48:51], v[24:27], v[128:131]
  ds_read_b64_tr_b16 v[82:83], v10 offset:7936
  ds_read_b64_tr_b16 v[84:85], v10 offset:32
  v_mfma_f32_16x16x32_bf16 v[196:199], v[52:55], v[32:35], v[196:199]
  ds_read_b64_tr_b16 v[86:87], v10 offset:7968
  ds_read_b64_tr_b16 v[88:89], v10 offset:64
  v_mfma_f32_16x16x32_bf16 v[164:167], v[52:55], v[28:31], v[164:167]
  ds_read_b64_tr_b16 v[90:91], v10 offset:8000
  ds_read_b64_tr_b16 v[92:93], v10 offset:96
  v_mfma_f32_16x16x32_bf16 v[132:135], v[52:55], v[24:27], v[132:135]
  ds_read_b64_tr_b16 v[94:95], v10 offset:8032
  ds_read_b64_tr_b16 v[96:97], v10 offset:128
  v_mfma_f32_16x16x32_bf16 v[200:203], v[56:59], v[32:35], v[200:203]
  ds_read_b64_tr_b16 v[98:99], v10 offset:8064
  ds_read_b64_tr_b16 v[100:101], v10 offset:160
  v_mfma_f32_16x16x32_bf16 v[168:171], v[56:59], v[28:31], v[168:171]
  ds_read_b64_tr_b16 v[102:103], v10 offset:8096
  ds_read_b64_tr_b16 v[104:105], v10 offset:192
  v_mfma_f32_16x16x32_bf16 v[136:139], v[56:59], v[24:27], v[136:139]
  ds_read_b64_tr_b16 v[106:107], v10 offset:8128
  ds_read_b64_tr_b16 v[108:109], v10 offset:224
  v_mfma_f32_16x16x32_bf16 v[204:207], v[60:63], v[32:35], v[204:207]
  ds_read_b64_tr_b16 v[110:111], v10 offset:8160
  s_add_u32 s54, s54, 31744
  s_cmp_ge_u32 s54, 126976
  s_cselect_b32 s42, 4294872064, s56
  s_cselect_b32 s54, 0, s54
  v_add_u32 v10, s42, v10
  v_mfma_f32_16x16x32_bf16 v[172:175], v[60:63], v[28:31], v[172:175]
  v_mfma_f32_16x16x32_bf16 v[140:143], v[60:63], v[24:27], v[140:143]
  v_mfma_f32_16x16x32_bf16 v[208:211], v[64:67], v[32:35], v[208:211]
  v_mfma_f32_16x16x32_bf16 v[176:179], v[64:67], v[28:31], v[176:179]
  v_mfma_f32_16x16x32_bf16 v[144:147], v[64:67], v[24:27], v[144:147]
  v_mfma_f32_16x16x32_bf16 v[212:215], v[68:71], v[32:35], v[212:215]
  v_mfma_f32_16x16x32_bf16 v[180:183], v[68:71], v[28:31], v[180:183]
  v_mfma_f32_16x16x32_bf16 v[148:151], v[68:71], v[24:27], v[148:151]
  s_cmp_eq_u32 s44, 3
  s_cbranch_scc1 LQ_n3_t16
  v_mfma_f32_16x16x32_bf16 v[152:155], v[72:75], v[24:27], v[152:155]
  v_mfma_f32_16x16x32_bf16 v[184:187], v[72:75], v[28:31], v[184:187]
  v_mfma_f32_16x16x32_bf16 v[216:219], v[72:75], v[32:35], v[216:219]
  v_mfma_f32_16x16x32_bf16 v[156:159], v[76:79], v[24:27], v[156:159]
  v_mfma_f32_16x16x32_bf16 v[188:191], v[76:79], v[28:31], v[188:191]
  v_mfma_f32_16x16x32_bf16 v[220:223], v[76:79], v[32:35], v[220:223]
  s_branch LQ_nj_t16
LQ_n3_t16:
  v_mfma_f32_16x16x32_bf16 v[152:155], v[20:23], v[24:27], v[152:155]
  v_mfma_f32_16x16x32_bf16 v[156:159], v[24:27], v[24:27], v[156:159]
  v_mfma_f32_16x16x32_bf16 v[184:187], v[20:23], v[28:31], v[184:187]
  v_mfma_f32_16x16x32_bf16 v[188:191], v[28:31], v[28:31], v[188:191]
  v_mfma_f32_16x16x32_bf16 v[216:219], v[20:23], v[32:35], v[216:219]
  v_mfma_f32_16x16x32_bf16 v[220:223], v[32:35], v[32:35], v[220:223]
LQ_nj_t16:
  s_waitcnt vmcnt(4) lgkmcnt(0)
  s_barrier
  s_mov_b64 exec, s[48:49]
  v_mov_b32 v36, v20
  v_mov_b32 v37, v20
  v_mov_b32 v38, v20
  v_mov_b32 v39, v20
  s_mov_b64 exec, -1
  v_mfma_f32_16x16x32_bf16 v[192:195], v[80:83], v[44:47], v[192:195]
  s_add_u32 s55, s55, 12288
  s_cmp_ge_u32 s55, 36864
  s_cselect_b32 s42, 4294942720, s57
  s_cselect_b32 s55, 0, s55
  v_add_u32 v13, s42, v13
  v_add_u32 v14, s42, v14
  ds_read_b128 v[24:27], v13 offset:0
  v_mfma_f32_16x16x32_bf16 v[160:163], v[80:83], v[40:43], v[160:163]
  ds_read_b128 v[28:31], v13 offset:2048
  ds_read_b128 v[32:35], v13 offset:4096
  v_mfma_f32_16x16x32_bf16 v[128:131], v[80:83], v[36:39], v[128:131]
  ds_read_b64_tr_b16 v[48:49], v10 offset:0
  ds_read_b64_tr_b16 v[50:51], v10 offset:7936
  v_mfma_f32_16x16x32_bf16 v[196:199], v[84:87], v[44:47], v[196:199]
  ds_read_b64_tr_b16 v[52:53], v10 offset:32
  ds_read_b64_tr_b16 v[54:55], v10 offset:7968
  v_mfma_f32_16x16x32_bf16 v[164:167], v[84:87], v[40:43], v[164:167]
  ds_read_b64_tr_b16 v[56:57], v10 offset:64
  ds_read_b64_tr_b16 v[58:59], v10 offset:8000
  v_mfma_f32_16x16x32_bf16 v[132:135], v[84:87], v[36:39], v[132:135]
  ds_read_b64_tr_b16 v[60:61], v10 offset:96
  ds_read_b64_tr_b16 v[62:63], v10 offset:8032
  v_mfma_f32_16x16x32_bf16 v[200:203], v[88:91], v[44:47], v[200:203]
  ds_read_b64_tr_b16 v[64:65], v10 offset:128
  ds_read_b64_tr_b16 v[66:67], v10 offset:8064
  v_mfma_f32_16x16x32_bf16 v[168:171], v[88:91], v[40:43], v[168:171]
  ds_read_b64_tr_b16 v[68:69], v10 offset:160
  ds_read_b64_tr_b16 v[70:71], v10 offset:8096
  v_mfma_f32_16x16x32_bf16 v[136:139], v[88:91], v[36:39], v[136:139]
  ds_read_b64_tr_b16 v[72:73], v10 offset:192
  ds_read_b64_tr_b16 v[74:75], v10 offset:8128
  v_mfma_f32_16x16x32_bf16 v[204:207], v[92:95], v[44:47], v[204:207]
  ds_read_b64_tr_b16 v[76:77], v10 offset:224
  ds_read_b64_tr_b16 v[78:79], v10 offset:8160
  v_mfma_f32_16x16x32_bf16 v[172:175], v[92:95], v[40:43], v[172:175]
  s_add_u32 s54, s54, 31744
  s_cmp_ge_u32 s54, 126976
  s_cselect_b32 s42, 4294872064, s56
  s_cselect_b32 s54, 0, s54
  v_add_u32 v10, s42, v10
  v_mfma_f32_16x16x32_bf16 v[140:143], v[92:95], v[36:39], v[140:143]
  v_mfma_f32_16x16x32_bf16 v[208:211], v[96:99], v[44:47], v[208:211]
  v_mfma_f32_16x16x32_bf16 v[176:179], v[96:99], v[40:43], v[176:179]
  v_mfma_f32_16x16x32_bf16 v[144:147], v[96:99], v[36:39], v[144:147]
  v_mfma_f32_16x16x32_bf16 v[212:215], v[100:103], v[44:47], v[212:215]
  v_mfma_f32_16x16x32_bf16 v[180:183], v[100:103], v[40:43], v[180:183]
  v_mfma_f32_16x16x32_bf16 v[148:151], v[100:103], v[36:39], v[148:151]
  s_cmp_eq_u32 s44, 3
  s_cbranch_scc1 LQ_n3_t17
  v_mfma_f32_16x16x32_bf16 v[152:155], v[104:107], v[36:39], v[152:155]
  v_mfma_f32_16x16x32_bf16 v[184:187], v[104:107], v[40:43], v[184:187]
  v_mfma_f32_16x16x32_bf16 v[216:219], v[104:107], v[44:47], v[216:219]
  v_mfma_f32_16x16x32_bf16 v[156:159], v[108:111], v[36:39], v[156:159]
  v_mfma_f32_16x16x32_bf16 v[188:191], v[108:111], v[40:43], v[188:191]
  v_mfma_f32_16x16x32_bf16 v[220:223], v[108:111], v[44:47], v[220:223]
  s_branch LQ_nj_t17
LQ_n3_t17:
  v_mfma_f32_16x16x32_bf16 v[152:155], v[20:23], v[36:39], v[152:155]
  v_mfma_f32_16x16x32_bf16 v[156:159], v[36:39], v[36:39], v[156:159]
  v_mfma_f32_16x16x32_bf16 v[184:187], v[20:23], v[40:43], v[184:187]
  v_mfma_f32_16x16x32_bf16 v[188:191], v[40:43], v[40:43], v[188:191]
  v_mfma_f32_16x16x32_bf16 v[216:219], v[20:23], v[44:47], v[216:219]
  v_mfma_f32_16x16x32_bf16 v[220:223], v[44:47], v[44:47], v[220:223]
LQ_nj_t17:
  s_waitcnt vmcnt(0) lgkmcnt(0)
  s_barrier
  s_mov_b64 exec, s[48:49]
  v_mov_b32 v24, v20
  v_mov_b32 v25, v20
  v_mov_b32 v26, v20
  v_mov_b32 v27, v20
  s_mov_b64 exec, -1
  v_mfma_f32_16x16x32_bf16 v[192:195], v[48:51], v[32:35], v[192:195]
  ds_read_b128 v[36:39], v14 offset:0
  ds_read_b128 v[40:43], v14 offset:2048
  v_mfma_f32_16x16x32_bf16 v[160:163], v[48:51], v[28:31], v[160:163]
  ds_read_b128 v[44:47], v14 offset:4096
  ds_read_b64_tr_b16 v[80:81], v10 offset:0
  v_mfma_f32_16x16x32_bf16 v[128:131], v[48:51], v[24:27], v[128:131]
  ds_read_b64_tr_b16 v[82:83], v10 offset:7936
  ds_read_b64_tr_b16 v[84:85], v10 offset:32
  v_mfma_f32_16x16x32_bf16 v[196:199], v[52:55], v[32:35], v[196:199]
  ds_read_b64_tr_b16 v[86:87], v10 offset:7968
  ds_read_b64_tr_b16 v[88:89], v10 offset:64
  v_mfma_f32_16x16x32_bf16 v[164:167], v[52:55], v[28:31], v[164:167]
  ds_read_b64_tr_b16 v[90:91], v10 offset:8000
  ds_read_b64_tr_b16 v[92:93], v10 offset:96
  v_mfma_f32_16x16x32_bf16 v[132:135], v[52:55], v[24:27], v[132:135]
  ds_read_b64_tr_b16 v[94:95], v10 offset:8032
  ds_read_b64_tr_b16 v[96:97], v10 offset:128
  v_mfma_f32_16x16x32_bf16 v[200:203], v[56:59], v[32:35], v[200:203]
  ds_read_b64_tr_b16 v[98:99], v10 offset:8064
  ds_read_b64_tr_b16 v[100:101], v10 offset:160
  v_mfma_f32_16x16x32_bf16 v[168:171], v[56:59], v[28:31], v[168:171]
  ds_read_b64_tr_b16 v[102:103], v10 offset:8096
  ds_read_b64_tr_b16 v[104:105], v10 offset:192
  v_mfma_f32_16x16x32_bf16 v[136:139], v[56:59], v[24:27], v[136:139]
  ds_read_b64_tr_b16 v[106:107], v10 offset:8128
  ds_read_b64_tr_b16 v[108:109], v10 offset:224
  v_mfma_f32_16x16x32_bf16 v[204:207], v[60:63], v[32:35], v[204:207]
  ds_read_b64_tr_b16 v[110:111], v10 offset:8160
  s_add_u32 s54, s54, 31744
  s_cmp_ge_u32 s54, 126976
  s_cselect_b32 s42, 4294872064, s56
  s_cselect_b32 s54, 0, s54
  v_add_u32 v10, s42, v10
  v_mfma_f32_16x16x32_bf16 v[172:175], v[60:63], v[28:31], v[172:175]
  v_mfma_f32_16x16x32_bf16 v[140:143], v[60:63], v[24:27], v[140:143]
  v_mfma_f32_16x16x32_bf16 v[208:211], v[64:67], v[32:35], v[208:211]
  v_mfma_f32_16x16x32_bf16 v[176:179], v[64:67], v[28:31], v[176:179]
  v_mfma_f32_16x16x32_bf16 v[144:147], v[64:67], v[24:27], v[144:147]
  v_mfma_f32_16x16x32_bf16 v[212:215], v[68:71], v[32:35], v[212:215]
  v_mfma_f32_16x16x32_bf16 v[180:183], v[68:71], v[28:31], v[180:183]
  v_mfma_f32_16x16x32_bf16 v[148:151], v[68:71], v[24:27], v[148:151]
  s_cmp_eq_u32 s44, 3
  s_cbranch_scc1 LQ_n3_t18
  v_mfma_f32_16x16x32_bf16 v[152:155], v[72:75], v[24:27], v[152:155]
  v_mfma_f32_16x16x32_bf16 v[184:187], v[72:75], v[28:31], v[184:187]
  v_mfma_f32_16x16x32_bf16 v[216:219], v[72:75], v[32:35], v[216:219]
  v_mfma_f32_16x16x32_bf16 v[156:159], v[76:79], v[24:27], v[156:159]
  v_mfma_f32_16x16x32_bf16 v[188:191], v[76:79], v[28:31], v[188:191]
  v_mfma_f32_16x16x32_bf16 v[220:223], v[76:79], v[32:35], v[220:223]
  s_branch LQ_nj_t18
LQ_n3_t18:
  v_mfma_f32_16x16x32_bf16 v[152:155], v[20:23], v[24:27], v[152:155]
  v_mfma_f32_16x16x32_bf16 v[156:159], v[24:27], v[24:27], v[156:159]
  v_mfma_f32_16x16x32_bf16 v[184:187], v[20:23], v[28:31], v[184:187]
  v_mfma_f32_16x16x32_bf16 v[188:191], v[28:31], v[28:31], v[188:191]
  v_mfma_f32_16x16x32_bf16 v[216:219], v[20:23], v[32:35], v[216:219]
  v_mfma_f32_16x16x32_bf16 v[220:223], v[32:35], v[32:35], v[220:223]
LQ_nj_t18:
  s_waitcnt lgkmcnt(0)
  s_mov_b64 exec, s[48:49]
  v_mov_b32 v36, v20
  v_mov_b32 v37, v20
  v_mov_b32 v38, v20
  v_mov_b32 v39, v20
  s_mov_b64 exec, -1
  s_cmp_eq_u32 s44, 3
  s_cbranch_scc1 LQ_n3_t19
  v_mfma_f32_16x16x32_bf16 v[152:155], v[104:107], v[36:39], v[152:155]
  v_mfma_f32_16x16x32_bf16 v[184:187], v[104:107], v[40:43], v[184:187]
  v_mfma_f32_16x16x32_bf16 v[216:219], v[104:107], v[44:47], v[216:219]
  v_mfma_f32_16x16x32_bf16 v[156:159], v[108:111], v[36:39], v[156:159]
  v_mfma_f32_16x16x32_bf16 v[188:191], v[108:111], v[40:43], v[188:191]
  v_mfma_f32_16x16x32_bf16 v[220:223], v[108:111], v[44:47], v[220:223]
  s_branch LQ_nj_t19
LQ_n3_t19:
  v_mfma_f32_16x16x32_bf16 v[152:155], v[20:23], v[36:39], v[152:155]
  v_mfma_f32_16x16x32_bf16 v[156:159], v[36:39], v[36:39], v[156:159]
  v_mfma_f32_16x16x32_bf16 v[184:187], v[20:23], v[40:43], v[184:187]
  v_mfma_f32_16x16x32_bf16 v[188:191], v[40:43], v[40:43], v[188:191]
  v_mfma_f32_16x16x32_bf16 v[216:219], v[20:23], v[44:47], v[216:219]
  v_mfma_f32_16x16x32_bf16 v[220:223], v[44:47], v[44:47], v[220:223]
LQ_nj_t19:
  v_mfma_f32_16x16x32_bf16 v[128:131], v[80:83], v[36:39], v[128:131]
  v_mfma_f32_16x16x32_bf16 v[132:135], v[84:87], v[36:39], v[132:135]
  v_mfma_f32_16x16x32_bf16 v[136:139], v[88:91], v[36:39], v[136:139]
  v_mfma_f32_16x16x32_bf16 v[140:143], v[92:95], v[36:39], v[140:143]
  v_mfma_f32_16x16x32_bf16 v[144:147], v[96:99], v[36:39], v[144:147]
  v_mfma_f32_16x16x32_bf16 v[148:151], v[100:103], v[36:39], v[148:151]
  v_mfma_f32_16x16x32_bf16 v[192:195], v[80:83], v[44:47], v[192:195]
  v_mfma_f32_16x16x32_bf16 v[160:163], v[80:83], v[40:43], v[160:163]
  v_lshlrev_b32 v15, 6, v2
  v_lshl_add_u32 v15, v3, 4, v15
  v_lshlrev_b32 v16, 2, v2
  v_lshlrev_b32 v17, 4, v3
  s_nop 7
  s_cmp_eq_u32 s44, 3
  s_cbranch_scc0 LQ_nostat
  s_mul_i32 s41, s43, 3
  s_lshl_b32 s42, s41, 10
  s_add_u32 s42, s42, 139264
  v_add_u32 v15, s42, v15
  s_lshl_b32 s42, s41, 6
  s_add_u32 s42, s42, 147456
  v_add_u32 v16, s42, v16
  ds_write_b128 v15, v[156:159] offset:0
  ds_write_b32 v16, v152 offset:0
  ds_write_b128 v15, v[188:191] offset:1024
  ds_write_b32 v16, v184 offset:64
  ds_write_b128 v15, v[220:223] offset:2048
  ds_write_b32 v16, v216 offset:128
LQ_nostat:
  s_lshl_b32 s41, s44, 3
  s_cmp_eq_u32 s43, 0
  s_cbranch_scc0 LQ_nocol
  s_lshl_b32 s42, s41, 6
  s_add_u32 s42, s42, 147968
  v_add_u32 v18, s42, v17
  s_mov_b64 exec, s[48:49]
  ds_write_b128 v18, v[128:131] offset:0
  ds_write_b128 v18, v[132:135] offset:64
  ds_write_b128 v18, v[136:139] offset:128
  ds_write_b128 v18, v[140:143] offset:192
  ds_write_b128 v18, v[144:147] offset:256
  ds_write_b128 v18, v[148:151] offset:320
  ds_write_b128 v18, v[152:155] offset:384
  ds_write_b128 v18, v[156:159] offset:448
  s_mov_b64 exec, -1
LQ_nocol:
  v_mfma_f32_16x16x32_bf16 v[196:199], v[84:87], v[44:47], v[196:199]
  v_mfma_f32_16x16x32_bf16 v[164:167], v[84:87], v[40:43], v[164:167]
  s_waitcnt lgkmcnt(0)
  s_barrier
  s_lshl_b32 s41, s41, 6
  s_add_u32 s41, s41, 147968
  v_add_u32 v18, s41, v17
  s_mul_i32 s41, s43, 3
  s_lshl_b32 s42, s41, 10
  s_add_u32 s42, s42, 139264
  v_mul_u32_u24 v15, 68, v2
  v_add_u32 v15, s42, v15
  s_lshl_b32 s42, s41, 6
  s_add_u32 s42, s42, 147456
  v_lshlrev_b32 v16, 2, v2
  v_add_u32 v16, s42, v16
  ds_read_b32 v112, v15 offset:0
  ds_read_b32 v118, v16 offset:0
  ds_read_b32 v114, v15 offset:1024
  ds_read_b32 v120, v16 offset:64
  ds_read_b32 v116, v15 offset:2048
  ds_read_b32 v122, v16 offset:128
  ds_read_b128 v[48:51], v18 offset:0
  ds_read_b128 v[52:55], v18 offset:64
  ds_read_b128 v[56:59], v18 offset:128
  ds_read_b128 v[60:63], v18 offset:192
  ds_read_b128 v[64:67], v18 offset:256
  ds_read_b128 v[68:71], v18 offset:320
  ds_read_b128 v[72:75], v18 offset:384
  ds_read_b128 v[76:79], v18 offset:448
  s_mov_b32 s41, 0x3acccccd
  v_mfma_f32_16x16x32_bf16 v[200:203], v[88:91], v[44:47], v[200:203]
  v_mfma_f32_16x16x32_bf16 v[168:171], v[88:91], v[40:43], v[168:171]
  s_waitcnt lgkmcnt(8)
  v_mul_f32 v118, s41, v118
  v_mul_f32 v120, s41, v120
  v_mul_f32 v122, s41, v122
  v_mul_f32 v112, s41, v112
  v_mul_f32 v114, s41, v114
  v_mul_f32 v116, s41, v116
  v_fma_f32 v112, -v118, v118, v112
  v_fma_f32 v114, -v120, v120, v114
  v_fma_f32 v116, -v122, v122, v116
  v_mfma_f32_16x16x32_bf16 v[204:207], v[92:95], v[44:47], v[204:207]
  v_max_f32 v112, 0, v112
  v_max_f32 v114, 0, v114
  v_max_f32 v116, 0, v116
  v_cvt_pk_bf16_f32 v24, v112, v118
  v_cvt_pk_bf16_f32 v26, v114, v120
  v_cvt_pk_bf16_f32 v28, v116, v122
  v_lshlrev_b32 v112, 16, v24
  v_and_b32 v118, 0xffff0000, v24
  v_lshlrev_b32 v114, 16, v26
  v_and_b32 v120, 0xffff0000, v26
  v_mfma_f32_16x16x32_bf16 v[172:175], v[92:95], v[40:43], v[172:175]
  v_lshlrev_b32 v116, 16, v28
  v_and_b32 v122, 0xffff0000, v28
  v_add_f32 v112, 0x3727c5ac, v112
  v_add_f32 v114, 0x3727c5ac, v114
  v_add_f32 v116, 0x3727c5ac, v116
  v_cvt_pk_bf16_f32 v24, v112, v112
  v_cvt_pk_bf16_f32 v26, v114, v114
  v_cvt_pk_bf16_f32 v28, v116, v116
  v_lshlrev_b32 v112, 16, v24
  v_lshlrev_b32 v114, 16, v26
  v_mfma_f32_16x16x32_bf16 v[208:211], v[96:99], v[44:47], v[208:211]
  v_lshlrev_b32 v116, 16, v28
  v_sqrt_f32 v112, v112
  v_sqrt_f32 v114, v114
  v_sqrt_f32 v116, v116
  s_nop 0
  v_cvt_pk_bf16_f32 v24, v112, v112
  v_cvt_pk_bf16_f32 v26, v114, v114
  v_cvt_pk_bf16_f32 v28, v116, v116
  v_lshlrev_b32 v24, 16, v24
  v_lshlrev_b32 v26, 16, v26
  v_mfma_f32_16x16x32_bf16 v[176:179], v[96:99], v[40:43], v[176:179]
  v_lshlrev_b32 v28, 16, v28
  v_rcp_f32 v112, v24
  v_rcp_f32 v114, v26
  v_rcp_f32 v116, v28
  v_sub_f32 v118, 0, v118
  v_mov_b32 v25, v24
  v_sub_f32 v120, 0, v120
  v_mov_b32 v27, v26
  v_sub_f32 v122, 0, v122
  v_mov_b32 v29, v28
  v_mfma_f32_16x16x32_bf16 v[212:215], v[100:103], v[44:47], v[212:215]
  v_mov_b32 v113, v112
  v_mov_b32 v119, v118
  v_mov_b32 v115, v114
  v_mov_b32 v121, v120
  v_mov_b32 v117, v116
  v_mov_b32 v123, v122
  v_mfma_f32_16x16x32_bf16 v[180:183], v[100:103], v[40:43], v[180:183]
  s_nop 7
  s_waitcnt lgkmcnt(0)
  s_mul_i32 s41, s43, 48
  v_add_u32 v30, s41, v2
  v_mul_u32_u24 v30, 968, v30
  s_lshl_b32 s41, s44, 8
  v_lshl_add_u32 v30, v3, 3, v30
  v_add_u32 v30, s41, v30
  v_pk_fma_f32 v[128:129], v[48:49], v[118:119], v[128:129]
  v_pk_fma_f32 v[130:131], v[50:51], v[118:119], v[130:131]
  v_pk_fma_f32 v[160:161], v[48:49], v[120:121], v[160:161]
  v_pk_fma_f32 v[162:163], v[50:51], v[120:121], v[162:163]
  v_pk_fma_f32 v[192:193], v[48:49], v[122:123], v[192:193]
  v_pk_fma_f32 v[194:195], v[50:51], v[122:123], v[194:195]
  v_pk_mul_f32 v[128:129], v[128:129], v[112:113]
  v_pk_mul_f32 v[130:131], v[130:131], v[112:113]
  v_pk_mul_f32 v[160:161], v[160:161], v[114:115]
  v_pk_mul_f32 v[162:163], v[162:163], v[114:115]
  v_pk_mul_f32 v[192:193], v[192:193], v[116:117]
  v_pk_mul_f32 v[194:195], v[194:195], v[116:117]
  v_cvt_pk_bf16_f32 v128, v128, v129
  v_cvt_pk_bf16_f32 v129, v130, v131
  v_cvt_pk_bf16_f32 v160, v160, v161
  v_cvt_pk_bf16_f32 v161, v162, v163
  v_cvt_pk_bf16_f32 v192, v192, v193
  v_cvt_pk_bf16_f32 v193, v194, v195
  ds_write_b64 v30, v[128:129] offset:0
  ds_write_b64 v30, v[160:161] offset:15488
  ds_write_b64 v30, v[192:193] offset:30976
  v_pk_fma_f32 v[132:133], v[52:53], v[118:119], v[132:133]
  v_pk_fma_f32 v[134:135], v[54:55], v[118:119], v[134:135]
  v_pk_fma_f32 v[164:165], v[52:53], v[120:121], v[164:165]
  v_pk_fma_f32 v[166:167], v[54:55], v[120:121], v[166:167]
  v_pk_fma_f32 v[196:197], v[52:53], v[122:123], v[196:197]
  v_pk_fma_f32 v[198:199], v[54:55], v[122:123], v[198:199]
  v_pk_mul_f32 v[132:133], v[132:133], v[112:113]
  v_pk_mul_f32 v[134:135], v[134:135], v[112:113]
  v_pk_mul_f32 v[164:165], v[164:165], v[114:115]
  v_pk_mul_f32 v[166:167], v[166:167], v[114:115]
  v_pk_mul_f32 v[196:197], v[196:197], v[116:117]
  v_pk_mul_f32 v[198:199], v[198:199], v[116:117]
  v_cvt_pk_bf16_f32 v132, v132, v133
  v_cvt_pk_bf16_f32 v133, v134, v135
  v_cvt_pk_bf16_f32 v164, v164, v165
  v_cvt_pk_bf16_f32 v165, v166, v167
  v_cvt_pk_bf16_f32 v196, v196, v197
  v_cvt_pk_bf16_f32 v197, v198, v199
  ds_write_b64 v30, v[132:133] offset:32
  ds_write_b64 v30, v[164:165] offset:15520
  ds_write_b64 v30, v[196:197] offset:31008
  v_pk_fma_f32 v[136:137], v[56:57], v[118:119], v[136:137]
  v_pk_fma_f32 v[138:139], v[58:59], v[118:119], v[138:139]
  v_pk_fma_f32 v[168:169], v[56:57], v[120:121], v[168:169]
  v_pk_fma_f32 v[170:171], v[58:59], v[120:121], v[170:171]
  v_pk_fma_f32 v[200:201], v[56:57], v[122:123], v[200:201]
  v_pk_fma_f32 v[202:203], v[58:59], v[122:123], v[202:203]
  v_pk_mul_f32 v[136:137], v[136:137], v[112:113]
  v_pk_mul_f32 v[138:139], v[138:139], v[112:113]
  v_pk_mul_f32 v[168:169], v[168:169], v[114:115]
  v_pk_mul_f32 v[170:171], v[170:171], v[114:115]
  v_pk_mul_f32 v[200:201], v[200:201], v[116:117]
  v_pk_mul_f32 v[202:203], v[202:203], v[116:117]
  v_cvt_pk_bf16_f32 v136, v136, v137
  v_cvt_pk_bf16_f32 v137, v138, v139
  v_cvt_pk_bf16_f32 v168, v168, v169
  v_cvt_pk_bf16_f32 v169, v170, v171
  v_cvt_pk_bf16_f32 v200, v200, v201
  v_cvt_pk_bf16_f32 v201, v202, v203
  ds_write_b64 v30, v[136:137] offset:64
  ds_write_b64 v30, v[168:169] offset:15552
  ds_write_b64 v30, v[200:201] offset:31040
  v_pk_fma_f32 v[140:141], v[60:61], v[118:119], v[140:141]
  v_pk_fma_f32 v[142:143], v[62:63], v[118:119], v[142:143]
  v_pk_fma_f32 v[172:173], v[60:61], v[120:121], v[172:173]
  v_pk_fma_f32 v[174:175], v[62:63], v[120:121], v[174:175]
  v_pk_fma_f32 v[204:205], v[60:61], v[122:123], v[204:205]
  v_pk_fma_f32 v[206:207], v[62:63], v[122:123], v[206:207]
  v_pk_mul_f32 v[140:141], v[140:141], v[112:113]
  v_pk_mul_f32 v[142:143], v[142:143], v[112:113]
  v_pk_mul_f32 v[172:173], v[172:173], v[114:115]
  v_pk_mul_f32 v[174:175], v[174:175], v[114:115]
  v_pk_mul_f32 v[204:205], v[204:205], v[116:117]
  v_pk_mul_f32 v[206:207], v[206:207], v[116:117]
  v_cvt_pk_bf16_f32 v140, v140, v141
  v_cvt_pk_bf16_f32 v141, v142, v143
  v_cvt_pk_bf16_f32 v172, v172, v173
  v_cvt_pk_bf16_f32 v173, v174, v175
  v_cvt_pk_bf16_f32 v204, v204, v205
  v_cvt_pk_bf16_f32 v205, v206, v207
  ds_write_b64 v30, v[140:141] offset:96
  ds_write_b64 v30, v[172:173] offset:15584
  ds_write_b64 v30, v[204:205] offset:31072
  v_pk_fma_f32 v[144:145], v[64:65], v[118:119], v[144:145]
  v_pk_fma_f32 v[146:147], v[66:67], v[118:119], v[146:147]
  v_pk_fma_f32 v[176:177], v[64:65], v[120:121], v[176:177]
  v_pk_fma_f32 v[178:179], v[66:67], v[120:121], v[178:179]
  v_pk_fma_f32 v[208:209], v[64:65], v[122:123], v[208:209]
  v_pk_fma_f32 v[210:211], v[66:67], v[122:123], v[210:211]
  v_pk_mul_f32 v[144:145], v[144:145], v[112:113]
  v_pk_mul_f32 v[146:147], v[146:147], v[112:113]
  v_pk_mul_f32 v[176:177], v[176:177], v[114:115]
  v_pk_mul_f32 v[178:179], v[178:179], v[114:115]
  v_pk_mul_f32 v[208:209], v[208:209], v[116:117]
  v_pk_mul_f32 v[210:211], v[210:211], v[116:117]
  v_cvt_pk_bf16_f32 v144, v144, v145
  v_cvt_pk_bf16_f32 v145, v146, v147
  v_cvt_pk_bf16_f32 v176, v176, v177
  v_cvt_pk_bf16_f32 v177, v178, v179
  v_cvt_pk_bf16_f32 v208, v208, v209
  v_cvt_pk_bf16_f32 v209, v210, v211
  ds_write_b64 v30, v[144:145] offset:128
  ds_write_b64 v30, v[176:177] offset:15616
  ds_write_b64 v30, v[208:209] offset:31104
  v_pk_fma_f32 v[148:149], v[68:69], v[118:119], v[148:149]
  v_pk_fma_f32 v[150:151], v[70:71], v[118:119], v[150:151]
  v_pk_fma_f32 v[180:181], v[68:69], v[120:121], v[180:181]
  v_pk_fma_f32 v[182:183], v[70:71], v[120:121], v[182:183]
  v_pk_fma_f32 v[212:213], v[68:69], v[122:123], v[212:213]
  v_pk_fma_f32 v[214:215], v[70:71], v[122:123], v[214:215]
  v_pk_mul_f32 v[148:149], v[148:149], v[112:113]
  v_pk_mul_f32 v[150:151], v[150:151], v[112:113]
  v_pk_mul_f32 v[180:181], v[180:181], v[114:115]
  v_pk_mul_f32 v[182:183], v[182:183], v[114:115]
  v_pk_mul_f32 v[212:213], v[212:213], v[116:117]
  v_pk_mul_f32 v[214:215], v[214:215], v[116:117]
  v_cvt_pk_bf16_f32 v148, v148, v149
  v_cvt_pk_bf16_f32 v149, v150, v151
  v_cvt_pk_bf16_f32 v180, v180, v181
  v_cvt_pk_bf16_f32 v181, v182, v183
  v_cvt_pk_bf16_f32 v212, v212, v213
  v_cvt_pk_bf16_f32 v213, v214, v215
  ds_write_b64 v30, v[148:149] offset:160
  ds_write_b64 v30, v[180:181] offset:15648
  ds_write_b64 v30, v[212:213] offset:31136
  s_cmp_eq_u32 s44, 3
  s_cbranch_scc1 LQ_skipw
  v_pk_fma_f32 v[152:153], v[72:73], v[118:119], v[152:153]
  v_pk_fma_f32 v[154:155], v[74:75], v[118:119], v[154:155]
  v_pk_fma_f32 v[184:185], v[72:73], v[120:121], v[184:185]
  v_pk_fma_f32 v[186:187], v[74:75], v[120:121], v[186:187]
  v_pk_fma_f32 v[216:217], v[72:73], v[122:123], v[216:217]
  v_pk_fma_f32 v[218:219], v[74:75], v[122:123], v[218:219]
  v_pk_mul_f32 v[152:153], v[152:153], v[112:113]
  v_pk_mul_f32 v[154:155], v[154:155], v[112:113]
  v_pk_mul_f32 v[184:185], v[184:185], v[114:115]
  v_pk_mul_f32 v[186:187], v[186:187], v[114:115]
  v_pk_mul_f32 v[216:217], v[216:217], v[116:117]
  v_pk_mul_f32 v[218:219], v[218:219], v[116:117]
  v_cvt_pk_bf16_f32 v152, v152, v153
  v_cvt_pk_bf16_f32 v153, v154, v155
  v_cvt_pk_bf16_f32 v184, v184, v185
  v_cvt_pk_bf16_f32 v185, v186, v187
  v_cvt_pk_bf16_f32 v216, v216, v217
  v_cvt_pk_bf16_f32 v217, v218, v219
  ds_write_b64 v30, v[152:153] offset:192
  ds_write_b64 v30, v[184:185] offset:15680
  ds_write_b64 v30, v[216:217] offset:31168
  v_pk_fma_f32 v[156:157], v[76:77], v[118:119], v[156:157]
  v_pk_fma_f32 v[158:159], v[78:79], v[118:119], v[158:159]
  v_pk_fma_f32 v[188:189], v[76:77], v[120:121], v[188:189]
  v_pk_fma_f32 v[190:191], v[78:79], v[120:121], v[190:191]
  v_pk_fma_f32 v[220:221], v[76:77], v[122:123], v[220:221]
  v_pk_fma_f32 v[222:223], v[78:79], v[122:123], v[222:223]
  v_pk_mul_f32 v[156:157], v[156:157], v[112:113]
  v_pk_mul_f32 v[158:159], v[158:159], v[112:113]
  v_pk_mul_f32 v[188:189], v[188:189], v[114:115]
  v_pk_mul_f32 v[190:191], v[190:191], v[114:115]
  v_pk_mul_f32 v[220:221], v[220:221], v[116:117]
  v_pk_mul_f32 v[222:223], v[222:223], v[116:117]
  v_cvt_pk_bf16_f32 v156, v156, v157
  v_cvt_pk_bf16_f32 v157, v158, v159
  v_cvt_pk_bf16_f32 v188, v188, v189
  v_cvt_pk_bf16_f32 v189, v190, v191
  v_cvt_pk_bf16_f32 v220, v220, v221
  v_cvt_pk_bf16_f32 v221, v222, v223
  ds_write_b64 v30, v[156:157] offset:224
  ds_write_b64 v30, v[188:189] offset:15712
  ds_write_b64 v30, v[220:221] offset:31200
LQ_skipw:
  s_waitcnt lgkmcnt(0)
  s_barrier
  s_mov_b32 exec_hi, 0xffff
  ds_read_b64 v[236:237], v225 offset:15488
  ds_read_b64 v[240:241], v225 offset:30976
  ds_read_b64 v[244:245], v224 offset:0
  ds_read_b64 v[248:249], v224 offset:15488
  ds_read_b64 v[252:253], v224 offset:30976
  s_mov_b32 exec_hi, 0
  ds_read_b64 v[238:239], v225 offset:15496
  ds_read_b64 v[242:243], v225 offset:30984
  ds_read_b64 v[246:247], v224 offset:8
  ds_read_b64 v[250:251], v224 offset:15496
  ds_read_b64 v[254:255], v224 offset:30984
  s_mov_b32 exec_hi, -1
  ds_read_b64 v[44:45], v225 offset:320
  ds_read_b64 v[46:47], v225 offset:328
  ds_read_b64 v[48:49], v225 offset:15808
  ds_read_b64 v[50:51], v225 offset:15816
  ds_read_b64 v[52:53], v225 offset:31296
  ds_read_b64 v[54:55], v225 offset:31304
  ds_read_b64 v[56:57], v224 offset:320
  ds_read_b64 v[58:59], v224 offset:328
  ds_read_b64 v[60:61], v224 offset:15808
  ds_read_b64 v[62:63], v224 offset:15816
  ds_read_b64 v[64:65], v224 offset:31296
  ds_read_b64 v[66:67], v224 offset:31304
  s_waitcnt lgkmcnt(0)
  ds_read_b64_tr_b16 v[68:69], v226 offset:640
  ds_read_b64_tr_b16 v[70:71], v226 offset:16128
  ds_read_b64_tr_b16 v[72:73], v226 offset:31616
  ds_read_b64_tr_b16 v[74:75], v230 offset:640
  ds_read_b64_tr_b16 v[76:77], v230 offset:16128
  ds_read_b64_tr_b16 v[78:79], v230 offset:31616
  ds_read_b64_tr_b16 v[80:81], v226 offset:672
  ds_read_b64_tr_b16 v[82:83], v226 offset:16160
  ds_read_b64_tr_b16 v[84:85], v226 offset:31648
  ds_read_b64_tr_b16 v[86:87], v230 offset:672
  ds_read_b64_tr_b16 v[88:89], v230 offset:16160
  ds_read_b64_tr_b16 v[90:91], v230 offset:31648
  v_mfma_f32_16x16x32_bf16 v[92:95], v[44:47], v[236:239], 0
  v_mfma_f32_16x16x32_bf16 v[96:99], v[48:51], v[236:239], 0
  v_mfma_f32_16x16x32_bf16 v[100:103], v[48:51], v[240:243], 0
  v_mfma_f32_16x16x32_bf16 v[104:107], v[52:55], v[240:243], 0
  v_mfma_f32_16x16x32_bf16 v[108:111], v[52:55], v[244:247], 0
  v_mfma_f32_16x16x32_bf16 v[112:115], v[56:59], v[244:247], 0
  v_mfma_f32_16x16x32_bf16 v[116:119], v[56:59], v[248:251], 0
  v_mfma_f32_16x16x32_bf16 v[120:123], v[60:63], v[248:251], 0
  v_mfma_f32_16x16x32_bf16 v[124:127], v[60:63], v[252:255], 0
  v_mfma_f32_16x16x32_bf16 v[128:131], v[64:67], v[252:255], 0
  s_mov_b32 s41, 0x3e64f92e
  s_mov_b32 s42, 0x3fb8aa3b
  v_mov_b32 v15, 0xce6e6b28
  s_nop 4
  v_cndmask_b32 v92, v92, v93, s[82:83]
  v_cndmask_b32 v94, v94, v95, s[82:83]
  v_cndmask_b32 v96, v96, v97, s[82:83]
  v_cndmask_b32 v98, v98, v99, s[82:83]
  v_cndmask_b32 v100, v100, v101, s[82:83]
  v_cndmask_b32 v102, v102, v103, s[82:83]
  v_cndmask_b32 v104, v104, v105, s[82:83]
  v_cndmask_b32 v106, v106, v107, s[82:83]
  v_cndmask_b32 v108, v108, v109, s[82:83]
  v_cndmask_b32 v110, v110, v111, s[82:83]
  v_cndmask_b32 v112, v112, v113, s[82:83]
  v_cndmask_b32 v114, v114, v115, s[82:83]
  v_cndmask_b32 v116, v116, v117, s[82:83]
  v_cndmask_b32 v118, v118, v119, s[82:83]
  v_cndmask_b32 v120, v120, v121, s[82:83]
  v_cndmask_b32 v122, v122, v123, s[82:83]
  v_cndmask_b32 v124, v124, v125, s[82:83]
  v_cndmask_b32 v126, v126, v127, s[82:83]
  v_cndmask_b32 v128, v128, v129, s[82:83]
  v_cndmask_b32 v130, v130, v131, s[82:83]
  v_cndmask_b32 v132, v92, v96, s[84:85]
  v_cndmask_b32 v133, v94, v98, s[86:87]
  v_cndmask_b32 v134, v100, v104, s[84:85]
  v_cndmask_b32 v135, v102, v106, s[86:87]
  v_cndmask_b32 v136, v108, v112, s[84:85]
  v_cndmask_b32 v137, v110, v114, s[86:87]
  v_cndmask_b32 v138, v116, v120, s[84:85]
  v_cndmask_b32 v139, v118, v122, s[86:87]
  v_cndmask_b32 v140, v124, v128, s[84:85]
  v_cndmask_b32 v141, v126, v130, s[86:87]
  v_cvt_pk_bf16_f32 v142, v132, v133
  v_cvt_pk_bf16_f32 v143, v134, v135
  v_cvt_pk_bf16_f32 v144, v136, v137
  v_cvt_pk_bf16_f32 v145, v138, v139
  v_cvt_pk_bf16_f32 v146, v140, v141
  v_lshlrev_b32 v132, 16, v142
  v_and_b32 v133, 0xffff0000, v142
  v_lshlrev_b32 v134, 16, v143
  v_and_b32 v135, 0xffff0000, v143
  v_lshlrev_b32 v136, 16, v144
  v_and_b32 v137, 0xffff0000, v144
  v_lshlrev_b32 v138, 16, v145
  v_and_b32 v139, 0xffff0000, v145
  v_lshlrev_b32 v140, 16, v146
  v_and_b32 v141, 0xffff0000, v146
  v_mul_f32 v132, s41, v132
  v_mul_f32 v133, s41, v133
  v_mul_f32 v134, s41, v134
  v_mul_f32 v135, s41, v135
  v_mul_f32 v136, s41, v136
  v_mul_f32 v137, s41, v137
  v_mul_f32 v138, s41, v138
  v_mul_f32 v139, s41, v139
  v_mul_f32 v140, s41, v140
  v_mul_f32 v141, s41, v141
  v_cvt_pk_bf16_f32 v142, v132, v133
  v_cvt_pk_bf16_f32 v143, v134, v135
  v_cvt_pk_bf16_f32 v144, v136, v137
  v_cvt_pk_bf16_f32 v145, v138, v139
  v_cvt_pk_bf16_f32 v146, v140, v141
  v_lshlrev_b32 v132, 16, v142
  v_and_b32 v133, 0xffff0000, v142
  v_lshlrev_b32 v134, 16, v143
  v_and_b32 v135, 0xffff0000, v143
  v_lshlrev_b32 v136, 16, v144
  v_and_b32 v137, 0xffff0000, v144
  v_lshlrev_b32 v138, 16, v145
  v_and_b32 v139, 0xffff0000, v145
  v_lshlrev_b32 v140, 16, v146
  v_and_b32 v141, 0xffff0000, v146
  v_cndmask_b32 v132, v15, v132, s[88:89]
  v_cndmask_b32 v133, v15, v133, s[90:91]
  v_max_f32 v142, v132, v133
  v_max_f32 v143, v134, v135
  v_max_f32 v144, v136, v137
  v_max_f32 v145, v138, v139
  v_max_f32 v146, v140, v141
  v_mov_b32 v147, v142
  v_mov_b32 v148, v143
  v_mov_b32 v149, v144
  v_mov_b32 v150, v145
  v_mov_b32 v151, v146
  s_nop 0
  v_permlane32_swap_b32 v142, v147
  v_permlane32_swap_b32 v143, v148
  v_permlane32_swap_b32 v144, v149
  v_permlane32_swap_b32 v145, v150
  v_permlane32_swap_b32 v146, v151
  s_nop 0
  v_max_f32 v142, v142, v147
  v_max_f32 v143, v143, v148
  v_max_f32 v144, v144, v149
  v_max_f32 v145, v145, v150
  v_max_f32 v146, v146, v151
  v_mov_b32 v147, v142
  v_mov_b32 v148, v143
  v_mov_b32 v149, v144
  v_mov_b32 v150, v145
  v_mov_b32 v151, v146
  s_nop 0
  v_permlane16_swap_b32 v142, v147
  v_permlane16_swap_b32 v143, v148
  v_permlane16_swap_b32 v144, v149
  v_permlane16_swap_b32 v145, v150
  v_permlane16_swap_b32 v146, v151
  s_nop 0
  v_max_f32 v142, v142, v147
  v_max_f32 v143, v143, v148
  v_max_f32 v144, v144, v149
  v_max_f32 v145, v145, v150
  v_max_f32 v146, v146, v151
  v_sub_f32 v132, v132, v142
  v_sub_f32 v133, v133, v142
  v_sub_f32 v134, v134, v143
  v_sub_f32 v135, v135, v143
  v_sub_f32 v136, v136, v144
  v_sub_f32 v137, v137, v144
  v_sub_f32 v138, v138, v145
  v_sub_f32 v139, v139, v145
  v_sub_f32 v140, v140, v146
  v_sub_f32 v141, v141, v146
  v_mul_f32 v132, s42, v132
  v_mul_f32 v133, s42, v133
  v_mul_f32 v134, s42, v134
  v_mul_f32 v135, s42, v135
  v_mul_f32 v136, s42, v136
  v_mul_f32 v137, s42, v137
  v_mul_f32 v138, s42, v138
  v_mul_f32 v139, s42, v139
  v_mul_f32 v140, s42, v140
  v_mul_f32 v141, s42, v141
  v_exp_f32 v132, v132
  v_exp_f32 v133, v133
  v_exp_f32 v134, v134
  v_exp_f32 v135, v135
  v_exp_f32 v136, v136
  v_exp_f32 v137, v137
  v_exp_f32 v138, v138
  v_exp_f32 v139, v139
  v_exp_f32 v140, v140
  v_exp_f32 v141, v141
  s_nop 0
  v_add_f32 v142, v132, v133
  v_add_f32 v143, v134, v135
  v_add_f32 v144, v136, v137
  v_add_f32 v145, v138, v139
  v_add_f32 v146, v140, v141
  v_mov_b32 v147, v142
  v_mov_b32 v148, v143
  v_mov_b32 v149, v144
  v_mov_b32 v150, v145
  v_mov_b32 v151, v146
  s_nop 0
  v_permlane32_swap_b32 v142, v147
  v_permlane32_swap_b32 v143, v148
  v_permlane32_swap_b32 v144, v149
  v_permlane32_swap_b32 v145, v150
  v_permlane32_swap_b32 v146, v151
  s_nop 0
  v_add_f32 v142, v142, v147
  v_add_f32 v143, v143, v148
  v_add_f32 v144, v144, v149
  v_add_f32 v145, v145, v150
  v_add_f32 v146, v146, v151
  v_mov_b32 v147, v142
  v_mov_b32 v148, v143
  v_mov_b32 v149, v144
  v_mov_b32 v150, v145
  v_mov_b32 v151, v146
  s_nop 0
  v_permlane16_swap_b32 v142, v147
  v_permlane16_swap_b32 v143, v148
  v_permlane16_swap_b32 v144, v149
  v_permlane16_swap_b32 v145, v150
  v_permlane16_swap_b32 v146, v151
  s_nop 0
  v_add_f32 v142, v142, v147
  v_add_f32 v143, v143, v148
  v_add_f32 v144, v144, v149
  v_add_f32 v145, v145, v150
  v_add_f32 v146, v146, v151
  v_rcp_f32 v142, v142
  v_rcp_f32 v143, v143
  v_rcp_f32 v144, v144
  v_rcp_f32 v145, v145
  v_rcp_f32 v146, v146
  s_nop 0
  v_mul_f32 v132, v132, v142
  v_mul_f32 v133, v133, v142
  v_mul_f32 v134, v134, v143
  v_mul_f32 v135, v135, v143
  v_mul_f32 v136, v136, v144
  v_mul_f32 v137, v137, v144
  v_mul_f32 v138, v138, v145
  v_mul_f32 v139, v139, v145
  v_mul_f32 v140, v140, v146
  v_mul_f32 v141, v141, v146
  v_cvt_pk_bf16_f32 v142, v132, v133
  v_cvt_pk_bf16_f32 v143, v134, v135
  v_cvt_pk_bf16_f32 v144, v136, v137
  v_cvt_pk_bf16_f32 v145, v138, v139
  v_cvt_pk_bf16_f32 v146, v140, v141
  v_and_b32 v132, 0xffff, v142
  v_lshrrev_b32 v133, 16, v142
  v_and_b32 v134, 0xffff, v143
  v_lshrrev_b32 v135, 16, v143
  v_and_b32 v136, 0xffff, v144
  v_lshrrev_b32 v137, 16, v144
  v_and_b32 v138, 0xffff, v145
  v_lshrrev_b32 v139, 16, v145
  v_and_b32 v140, 0xffff, v146
  v_lshrrev_b32 v141, 16, v146
  v_lshlrev_b32 v132, v227, v132
  v_lshlrev_b32 v133, v227, v133
  v_lshlrev_b32 v134, v227, v134
  v_lshlrev_b32 v135, v227, v135
  v_lshlrev_b32 v136, v227, v136
  v_lshlrev_b32 v137, v227, v137
  v_lshlrev_b32 v138, v227, v138
  v_lshlrev_b32 v139, v227, v139
  v_lshlrev_b32 v140, v227, v140
  v_lshlrev_b32 v141, v227, v141
  v_mov_b32 v15, 0
  v_cndmask_b32 v152, v132, v15, s[84:85]
  v_cndmask_b32 v153, v133, v15, s[86:87]
  v_cndmask_b32 v154, v15, v132, s[84:85]
  v_cndmask_b32 v155, v15, v133, s[86:87]
  v_cndmask_b32 v156, v134, v15, s[84:85]
  v_cndmask_b32 v157, v135, v15, s[86:87]
  v_cndmask_b32 v158, v15, v134, s[84:85]
  v_cndmask_b32 v159, v15, v135, s[86:87]
  v_cndmask_b32 v160, v136, v15, s[84:85]
  v_cndmask_b32 v161, v137, v15, s[86:87]
  v_cndmask_b32 v162, v15, v136, s[84:85]
  v_cndmask_b32 v163, v15, v137, s[86:87]
  v_cndmask_b32 v164, v138, v15, s[84:85]
  v_cndmask_b32 v165, v139, v15, s[86:87]
  v_cndmask_b32 v166, v15, v138, s[84:85]
  v_cndmask_b32 v167, v15, v139, s[86:87]
  v_cndmask_b32 v168, v140, v15, s[84:85]
  v_cndmask_b32 v169, v141, v15, s[86:87]
  v_cndmask_b32 v170, v15, v140, s[84:85]
  v_cndmask_b32 v171, v15, v141, s[86:87]
  s_waitcnt lgkmcnt(0)
  s_nop 1
  v_mfma_f32_16x16x32_bf16 v[92:95], v[68:71], v[152:155], 0
  v_mfma_f32_16x16x32_bf16 v[96:99], v[80:83], v[152:155], 0
  v_mfma_f32_16x16x32_bf16 v[100:103], v[70:73], v[156:159], 0
  v_mfma_f32_16x16x32_bf16 v[104:107], v[82:85], v[156:159], 0
  v_mfma_f32_16x16x32_bf16 v[108:111], v[72:75], v[160:163], 0
  v_mfma_f32_16x16x32_bf16 v[112:115], v[84:87], v[160:163], 0
  v_mfma_f32_16x16x32_bf16 v[116:119], v[74:77], v[164:167], 0
  v_mfma_f32_16x16x32_bf16 v[120:123], v[86:89], v[164:167], 0
  v_mfma_f32_16x16x32_bf16 v[124:127], v[76:79], v[168:171], 0
  v_mfma_f32_16x16x32_bf16 v[128:131], v[88:91], v[168:171], 0
  s_nop 4
  v_cvt_pk_bf16_f32 v152, v92, v93
  v_cvt_pk_bf16_f32 v153, v94, v95
  v_cvt_pk_bf16_f32 v154, v96, v97
  v_cvt_pk_bf16_f32 v155, v98, v99
  ds_write_b64 v228, v[152:153] offset:0
  v_cvt_pk_bf16_f32 v156, v100, v101
  v_cvt_pk_bf16_f32 v157, v102, v103
  v_cvt_pk_bf16_f32 v158, v104, v105
  v_cvt_pk_bf16_f32 v159, v106, v107
  ds_write_b64 v228, v[156:157] offset:5120
  v_cvt_pk_bf16_f32 v160, v108, v109
  v_cvt_pk_bf16_f32 v161, v110, v111
  v_cvt_pk_bf16_f32 v162, v112, v113
  v_cvt_pk_bf16_f32 v163, v114, v115
  ds_write_b64 v228, v[160:161] offset:10240
  v_cvt_pk_bf16_f32 v164, v116, v117
  v_cvt_pk_bf16_f32 v165, v118, v119
  v_cvt_pk_bf16_f32 v166, v120, v121
  v_cvt_pk_bf16_f32 v167, v122, v123
  ds_write_b64 v228, v[164:165] offset:15360
  v_cvt_pk_bf16_f32 v168, v124, v125
  v_cvt_pk_bf16_f32 v169, v126, v127
  v_cvt_pk_bf16_f32 v170, v128, v129
  v_cvt_pk_bf16_f32 v171, v130, v131
  ds_write_b64 v228, v[168:169] offset:20480
  s_mov_b64 exec, 0xffff
  ds_write_b64 v229, v[154:155] offset:0
  ds_write_b64 v229, v[158:159] offset:5120
  ds_write_b64 v229, v[162:163] offset:10240
  ds_write_b64 v229, v[166:167] offset:15360
  ds_write_b64 v229, v[170:171] offset:20480
  s_mov_b64 exec, -1
  s_waitcnt lgkmcnt(0)
  s_barrier
  ds_read_b128 v[92:95], v232 offset:0
  ds_read_b128 v[96:99], v232 offset:8192
  ds_read_b128 v[100:103], v232 offset:16384
  ds_read_b128 v[104:107], v232 offset:24576
  s_waitcnt lgkmcnt(3)
  buffer_store_dwordx4 v[92:95], v231, s[28:31], s96 offen sc0 sc1
  s_waitcnt lgkmcnt(2)
  buffer_store_dwordx4 v[96:99], v231, s[28:31], s97 offen sc0 sc1
  s_waitcnt lgkmcnt(1)
  buffer_store_dwordx4 v[100:103], v231, s[28:31], s98 offen sc0 sc1
  s_cmp_eq_u32 s3, 0
  s_cbranch_scc0 LQ_oend
  s_waitcnt lgkmcnt(0)
  buffer_store_dwordx4 v[104:107], v231, s[28:31], s99 offen sc0 sc1
LQ_oend:
  s_endpgm
LP_start:
  s_mov_b32 s94, s2
  s_load_dwordx2 s[14:15], s[0:1], 16
  s_load_dwordx2 s[32:33], s[0:1], 48
  v_add_u32 v10, 0, v1
  v_mul_u32_u24 v11, 1639, v10
  v_lshrrev_b32 v11, 16, v11
  v_mul_u32_u24 v12, 40, v11
  v_sub_u32 v10, v10, v12
  v_mul_u32_u24 v11, 1280, v11
  v_lshl_add_u32 v4, v10, 4, v11
  v_add_u32 v10, 64, v1
  v_mul_u32_u24 v11, 1639, v10
  v_lshrrev_b32 v11, 16, v11
  v_mul_u32_u24 v12, 40, v11
  v_sub_u32 v10, v10, v12
  v_mul_u32_u24 v11, 1280, v11
  v_lshl_add_u32 v5, v10, 4, v11
  v_add_u32 v10, 128, v1
  v_mul_u32_u24 v11, 1639, v10
  v_lshrrev_b32 v11, 16, v11
  v_mul_u32_u24 v12, 40, v11
  v_sub_u32 v10, v10, v12
  v_mul_u32_u24 v11, 1280, v11
  v_lshl_add_u32 v6, v10, 4, v11
  v_add_u32 v10, 192, v1
  v_mul_u32_u24 v11, 1639, v10
  v_lshrrev_b32 v11, 16, v11
  v_mul_u32_u24 v12, 40, v11
  v_sub_u32 v10, v10, v12
  v_mul_u32_u24 v11, 1280, v11
  v_lshl_add_u32 v7, v10, 4, v11
  v_add_u32 v10, 256, v1
  v_mul_u32_u24 v11, 1639, v10
  v_lshrrev_b32 v11, 16, v11
  v_mul_u32_u24 v12, 40, v11
  v_sub_u32 v10, v10, v12
  v_mul_u32_u24 v11, 1280, v11
  v_lshl_add_u32 v8, v10, 4, v11
  s_mul_i32 s36, s3, 20480
  v_bfe_u32 v10, v1, 2, 2
  v_lshl_add_u32 v10, v3, 2, v10
  v_mul_u32_u24 v10, 640, v10
  v_and_b32 v11, 3, v1
  v_lshl_add_u32 v10, v11, 3, v10
  v_add_u32 v9, s36, v10
  v_lshlrev_b32 v13, 4, v1
  s_and_b32 s34, s2, 7
  s_lshl_b32 s35, s3, 3
  s_add_u32 s34, s34, s35
  s_waitcnt lgkmcnt(0)
  s_mov_b32 s28, s12
  s_and_b32 s29, s13, 0xffff
  s_mov_b32 s30, 13516800
  s_mov_b32 s31, 0x20000
  s_mov_b32 s23, 0x20000
LP_job:
  s_lshr_b32 s37, s34, 1
  s_and_b32 s38, s34, 1
  s_sub_u32 s39, s37, 20
  s_cmp_lt_u32 s37, 20
  s_cselect_b32 s20, s14, s32
  s_cselect_b32 s21, s15, s33
  s_cselect_b32 s39, s37, s39
  s_mov_b32 s22, 2211840
  s_cselect_b32 s22, 819200, s22
  s_and_b32 s21, s21, 0xffff
  s_mul_i32 s39, s39, 40960
  s_mul_i32 s40, s38, 640
  s_add_u32 s39, s39, s40
  s_add_u32 m0, s36, 0
  s_add_u32 s40, s39, 0
  buffer_load_dwordx4 v4, s[20:23], s40 offen lds
  s_add_u32 m0, s36, 1024
  s_add_u32 s40, s39, 0
  buffer_load_dwordx4 v5, s[20:23], s40 offen lds
  s_add_u32 m0, s36, 2048
  s_add_u32 s40, s39, 0
  buffer_load_dwordx4 v6, s[20:23], s40 offen lds
  s_add_u32 m0, s36, 3072
  s_add_u32 s40, s39, 0
  buffer_load_dwordx4 v7, s[20:23], s40 offen lds
  s_add_u32 m0, s36, 4096
  s_add_u32 s40, s39, 0
  buffer_load_dwordx4 v8, s[20:23], s40 offen lds
  s_add_u32 m0, s36, 5120
  s_add_u32 s40, s39, 10240
  buffer_load_dwordx4 v4, s[20:23], s40 offen lds
  s_add_u32 m0, s36, 6144
  s_add_u32 s40, s39, 10240
  buffer_load_dwordx4 v5, s[20:23], s40 offen lds
  s_add_u32 m0, s36, 7168
  s_add_u32 s40, s39, 10240
  buffer_load_dwordx4 v6, s[20:23], s40 offen lds
  s_add_u32 m0, s36, 8192
  s_add_u32 s40, s39, 10240
  buffer_load_dwordx4 v7, s[20:23], s40 offen lds
  s_add_u32 m0, s36, 9216
  s_add_u32 s40, s39, 10240
  buffer_load_dwordx4 v8, s[20:23], s40 offen lds
  s_add_u32 m0, s36, 10240
  s_add_u32 s40, s39, 20480
  buffer_load_dwordx4 v4, s[20:23], s40 offen lds
  s_add_u32 m0, s36, 11264
  s_add_u32 s40, s39, 20480
  buffer_load_dwordx4 v5, s[20:23], s40 offen lds
  s_add_u32 m0, s36, 12288
  s_add_u32 s40, s39, 20480
  buffer_load_dwordx4 v6, s[20:23], s40 offen lds
  s_add_u32 m0, s36, 13312
  s_add_u32 s40, s39, 20480
  buffer_load_dwordx4 v7, s[20:23], s40 offen lds
  s_add_u32 m0, s36, 14336
  s_add_u32 s40, s39, 20480
  buffer_load_dwordx4 v8, s[20:23], s40 offen lds
  s_add_u32 m0, s36, 15360
  s_add_u32 s40, s39, 30720
  buffer_load_dwordx4 v4, s[20:23], s40 offen lds
  s_add_u32 m0, s36, 16384
  s_add_u32 s40, s39, 30720
  buffer_load_dwordx4 v5, s[20:23], s40 offen lds
  s_add_u32 m0, s36, 17408
  s_add_u32 s40, s39, 30720
  buffer_load_dwordx4 v6, s[20:23], s40 offen lds
  s_add_u32 m0, s36, 18432
  s_add_u32 s40, s39, 30720
  buffer_load_dwordx4 v7, s[20:23], s40 offen lds
  s_add_u32 m0, s36, 19456
  s_add_u32 s40, s39, 30720
  buffer_load_dwordx4 v8, s[20:23], s40 offen lds
  s_mul_i32 s40, s38, 1480
  s_add_u32 s40, s40, s37
  s_lshl_b32 s40, s40, 10
  s_add_u32 s40, s40, 10485760
  s_waitcnt vmcnt(0)
  ds_read_b64_tr_b16 v[16:17], v9 offset:0
  ds_read_b64_tr_b16 v[18:19], v9 offset:10240
  ds_read_b64_tr_b16 v[20:21], v9 offset:32
  ds_read_b64_tr_b16 v[22:23], v9 offset:10272
  ds_read_b64_tr_b16 v[24:25], v9 offset:64
  ds_read_b64_tr_b16 v[26:27], v9 offset:10304
  ds_read_b64_tr_b16 v[28:29], v9 offset:96
  ds_read_b64_tr_b16 v[30:31], v9 offset:10336
  ds_read_b64_tr_b16 v[32:33], v9 offset:128
  ds_read_b64_tr_b16 v[34:35], v9 offset:10368
  ds_read_b64_tr_b16 v[36:37], v9 offset:160
  ds_read_b64_tr_b16 v[38:39], v9 offset:10400
  ds_read_b64_tr_b16 v[40:41], v9 offset:192
  ds_read_b64_tr_b16 v[42:43], v9 offset:10432
  ds_read_b64_tr_b16 v[44:45], v9 offset:224
  ds_read_b64_tr_b16 v[46:47], v9 offset:10464
  ds_read_b64_tr_b16 v[48:49], v9 offset:256
  ds_read_b64_tr_b16 v[50:51], v9 offset:10496
  ds_read_b64_tr_b16 v[52:53], v9 offset:288
  ds_read_b64_tr_b16 v[54:55], v9 offset:10528
  ds_read_b64_tr_b16 v[56:57], v9 offset:320
  ds_read_b64_tr_b16 v[58:59], v9 offset:10560
  ds_read_b64_tr_b16 v[60:61], v9 offset:352
  ds_read_b64_tr_b16 v[62:63], v9 offset:10592
  ds_read_b64_tr_b16 v[64:65], v9 offset:384
  ds_read_b64_tr_b16 v[66:67], v9 offset:10624
  ds_read_b64_tr_b16 v[68:69], v9 offset:416
  ds_read_b64_tr_b16 v[70:71], v9 offset:10656
  ds_read_b64_tr_b16 v[72:73], v9 offset:448
  ds_read_b64_tr_b16 v[74:75], v9 offset:10688
  ds_read_b64_tr_b16 v[76:77], v9 offset:480
  ds_read_b64_tr_b16 v[78:79], v9 offset:10720
  ds_read_b64_tr_b16 v[80:81], v9 offset:512
  ds_read_b64_tr_b16 v[82:83], v9 offset:10752
  ds_read_b64_tr_b16 v[84:85], v9 offset:544
  ds_read_b64_tr_b16 v[86:87], v9 offset:10784
  ds_read_b64_tr_b16 v[88:89], v9 offset:576
  ds_read_b64_tr_b16 v[90:91], v9 offset:10816
  ds_read_b64_tr_b16 v[92:93], v9 offset:608
  ds_read_b64_tr_b16 v[94:95], v9 offset:10848
  s_waitcnt lgkmcnt(15)
  buffer_store_dwordx4 v[16:19], v13, s[28:31], s40 offen sc0 sc1
  s_add_u32 s40, s40, 75776
  s_waitcnt lgkmcnt(15)
  buffer_store_dwordx4 v[20:23], v13, s[28:31], s40 offen sc0 sc1
  s_add_u32 s40, s40, 75776
  s_waitcnt lgkmcnt(15)
  buffer_store_dwordx4 v[24:27], v13, s[28:31], s40 offen sc0 sc1
  s_add_u32 s40, s40, 75776
  s_waitcnt lgkmcnt(15)
  buffer_store_dwordx4 v[28:31], v13, s[28:31], s40 offen sc0 sc1
  s_add_u32 s40, s40, 75776
  s_waitcnt lgkmcnt(15)
  buffer_store_dwordx4 v[32:35], v13, s[28:31], s40 offen sc0 sc1
  s_add_u32 s40, s40, 75776
  s_waitcnt lgkmcnt(15)
  buffer_store_dwordx4 v[36:39], v13, s[28:31], s40 offen sc0 sc1
  s_add_u32 s40, s40, 75776
  s_waitcnt lgkmcnt(15)
  buffer_store_dwordx4 v[40:43], v13, s[28:31], s40 offen sc0 sc1
  s_add_u32 s40, s40, 75776
  s_waitcnt lgkmcnt(15)
  buffer_store_dwordx4 v[44:47], v13, s[28:31], s40 offen sc0 sc1
  s_add_u32 s40, s40, 75776
  s_waitcnt lgkmcnt(15)
  buffer_store_dwordx4 v[48:51], v13, s[28:31], s40 offen sc0 sc1
  s_add_u32 s40, s40, 75776
  s_waitcnt lgkmcnt(15)
  buffer_store_dwordx4 v[52:55], v13, s[28:31], s40 offen sc0 sc1
  s_add_u32 s40, s40, 75776
  s_waitcnt lgkmcnt(15)
  buffer_store_dwordx4 v[56:59], v13, s[28:31], s40 offen sc0 sc1
  s_add_u32 s40, s40, 75776
  s_waitcnt lgkmcnt(15)
  buffer_store_dwordx4 v[60:63], v13, s[28:31], s40 offen sc0 sc1
  s_add_u32 s40, s40, 75776
  s_waitcnt lgkmcnt(14)
  buffer_store_dwordx4 v[64:67], v13, s[28:31], s40 offen sc0 sc1
  s_add_u32 s40, s40, 75776
  s_waitcnt lgkmcnt(12)
  buffer_store_dwordx4 v[68:71], v13, s[28:31], s40 offen sc0 sc1
  s_add_u32 s40, s40, 75776
  s_waitcnt lgkmcnt(10)
  buffer_store_dwordx4 v[72:75], v13, s[28:31], s40 offen sc0 sc1
  s_add_u32 s40, s40, 75776
  s_waitcnt lgkmcnt(8)
  buffer_store_dwordx4 v[76:79], v13, s[28:31], s40 offen sc0 sc1
  s_add_u32 s40, s40, 75776
  s_waitcnt lgkmcnt(6)
  buffer_store_dwordx4 v[80:83], v13, s[28:31], s40 offen sc0 sc1
  s_add_u32 s40, s40, 75776
  s_waitcnt lgkmcnt(4)
  buffer_store_dwordx4 v[84:87], v13, s[28:31], s40 offen sc0 sc1
  s_add_u32 s40, s40, 75776
  s_waitcnt lgkmcnt(2)
  buffer_store_dwordx4 v[88:91], v13, s[28:31], s40 offen sc0 sc1
  s_add_u32 s40, s40, 75776
  s_waitcnt lgkmcnt(0)
  buffer_store_dwordx4 v[92:95], v13, s[28:31], s40 offen sc0 sc1
  s_add_u32 s40, s40, 75776
  s_add_u32 s34, s34, 64
  s_cmp_lt_u32 s34, 148
  s_cbranch_scc1 LP_job
L1_exit:
  s_endpgm
.globl k2_kernel
.p2align 8
.type k2_kernel,@function
k2_kernel:
  s_cmp_ge_u32 s2, 256
  s_cbranch_scc1 L2_exit
  s_load_dwordx2 s[4:5], s[0:1], 0
  s_load_dwordx2 s[10:11], s[0:1], 56
  s_load_dwordx2 s[12:13], s[0:1], 72
  v_and_b32 v1, 63, v0
  v_lshrrev_b32 v2, 6, v0
  s_nop 0
  v_readfirstlane_b32 s3, v2
  v_and_b32 v2, 15, v1
  v_lshrrev_b32 v3, 4, v1
  s_and_b32 s32, s2, 7
  s_lshr_b32 s33, s2, 3
  s_and_b32 s34, s32, 1
  s_lshl_b32 s34, s34, 2
  s_and_b32 s35, s33, 3
  s_add_u32 s37, s34, s35
  s_lshr_b32 s34, s32, 1
  s_lshl_b32 s34, s34, 3
  s_lshr_b32 s35, s33, 2
  s_add_u32 s34, s34, s35
  s_lshl_b32 s36, s34, 6
  s_mul_i32 s38, s3, 9
  s_add_u32 s38, s38, 1
  s_cmp_eq_u32 s3, 0
  s_cselect_b32 s38, 0, s38
  s_lshl_b32 s38, s38, 11
  s_mul_i32 s39, s34, 303104
  v_lshlrev_b32 v13, 4, v1
  v_add_u32 v4, s39, v13
  v_add_u32 v5, 75776, v4
  v_add_u32 v6, 151552, v4
  v_add_u32 v7, 227328, v4
  s_mul_i32 s39, s37, 378880
  s_add_u32 s39, s39, 10485760
  v_add_u32 v8, s39, v13
  v_add_u32 v9, 75776, v8
  v_add_u32 v10, 151552, v8
  v_add_u32 v11, 227328, v8
  v_add_u32 v12, 303104, v8
  s_waitcnt lgkmcnt(0)
  s_mov_b32 s16, s12
  s_and_b32 s17, s13, 0xffff
  s_mov_b32 s18, 13516800
  s_mov_b32 s19, 0x20000
  s_cmp_eq_u32 s3, 0
  s_cbranch_scc0 L2_p1
  buffer_load_dwordx4 v[28:31], v4, s[16:19], s38 offen offset:0
  buffer_load_dwordx4 v[32:35], v5, s[16:19], s38 offen offset:0
  buffer_load_dwordx4 v[36:39], v6, s[16:19], s38 offen offset:0
  buffer_load_dwordx4 v[40:43], v7, s[16:19], s38 offen offset:0
  buffer_load_dwordx4 v[44:47], v8, s[16:19], s38 offen offset:0
  buffer_load_dwordx4 v[48:51], v9, s[16:19], s38 offen offset:0
  buffer_load_dwordx4 v[52:55], v10, s[16:19], s38 offen offset:0
  buffer_load_dwordx4 v[56:59], v11, s[16:19], s38 offen offset:0
  buffer_load_dwordx4 v[60:63], v12, s[16:19], s38 offen offset:0
  buffer_load_dwordx4 v[64:67], v4, s[16:19], s38 offen offset:1024
  buffer_load_dwordx4 v[68:71], v5, s[16:19], s38 offen offset:1024
  buffer_load_dwordx4 v[72:75], v6, s[16:19], s38 offen offset:1024
  buffer_load_dwordx4 v[76:79], v7, s[16:19], s38 offen offset:1024
  buffer_load_dwordx4 v[80:83], v8, s[16:19], s38 offen offset:1024
  buffer_load_dwordx4 v[84:87], v9, s[16:19], s38 offen offset:1024
  buffer_load_dwordx4 v[88:91], v10, s[16:19], s38 offen offset:1024
  buffer_load_dwordx4 v[92:95], v11, s[16:19], s38 offen offset:1024
  buffer_load_dwordx4 v[96:99], v12, s[16:19], s38 offen offset:1024
  s_add_u32 s38, s38, 2048
L2_p1:
  buffer_load_dwordx4 v[100:103], v4, s[16:19], s38 offen offset:0
  buffer_load_dwordx4 v[104:107], v5, s[16:19], s38 offen offset:0
  buffer_load_dwordx4 v[108:111], v6, s[16:19], s38 offen offset:0
  buffer_load_dwordx4 v[112:115], v7, s[16:19], s38 offen offset:0
  buffer_load_dwordx4 v[116:119], v8, s[16:19], s38 offen offset:0
  buffer_load_dwordx4 v[120:123], v9, s[16:19], s38 offen offset:0
  buffer_load_dwordx4 v[124:127], v10, s[16:19], s38 offen offset:0
  buffer_load_dwordx4 v[128:131], v11, s[16:19], s38 offen offset:0
  buffer_load_dwordx4 v[132:135], v12, s[16:19], s38 offen offset:0
  buffer_load_dwordx4 v[136:139], v4, s[16:19], s38 offen offset:1024
  buffer_load_dwordx4 v[140:143], v5, s[16:19], s38 offen offset:1024
  buffer_load_dwordx4 v[144:147], v6, s[16:19], s38 offen offset:1024
  buffer_load_dwordx4 v[148:151], v7, s[16:19], s38 offen offset:1024
  buffer_load_dwordx4 v[152:155], v8, s[16:19], s38 offen offset:1024
  buffer_load_dwordx4 v[156:159], v9, s[16:19], s38 offen offset:1024
  buffer_load_dwordx4 v[160:163], v10, s[16:19], s38 offen offset:1024
  buffer_load_dwordx4 v[164:167], v11, s[16:19], s38 offen offset:1024
  buffer_load_dwordx4 v[168:171], v12, s[16:19], s38 offen offset:1024
  s_add_u32 s38, s38, 2048
  s_cmp_eq_u32 s3, 0
  s_cbranch_scc1 L2_p2
  buffer_load_dwordx4 v[172:175], v4, s[16:19], s38 offen offset:0
  buffer_load_dwordx4 v[176:179], v5, s[16:19], s38 offen offset:0
  buffer_load_dwordx4 v[180:183], v6, s[16:19], s38 offen offset:0
  buffer_load_dwordx4 v[184:187], v7, s[16:19], s38 offen offset:0
  buffer_load_dwordx4 v[188:191], v8, s[16:19], s38 offen offset:0
  buffer_load_dwordx4 v[192:195], v9, s[16:19], s38 offen offset:0
  buffer_load_dwordx4 v[196:199], v10, s[16:19], s38 offen offset:0
  buffer_load_dwordx4 v[200:203], v11, s[16:19], s38 offen offset:0
  buffer_load_dwordx4 v[204:207], v12, s[16:19], s38 offen offset:0
  buffer_load_dwordx4 v[208:211], v4, s[16:19], s38 offen offset:1024
  buffer_load_dwordx4 v[212:215], v5, s[16:19], s38 offen offset:1024
  buffer_load_dwordx4 v[216:219], v6, s[16:19], s38 offen offset:1024
  buffer_load_dwordx4 v[220:223], v7, s[16:19], s38 offen offset:1024
  buffer_load_dwordx4 v[224:227], v8, s[16:19], s38 offen offset:1024
  buffer_load_dwordx4 v[228:231], v9, s[16:19], s38 offen offset:1024
  buffer_load_dwordx4 v[232:235], v10, s[16:19], s38 offen offset:1024
  buffer_load_dwordx4 v[236:239], v11, s[16:19], s38 offen offset:1024
  buffer_load_dwordx4 v[240:243], v12, s[16:19], s38 offen offset:1024
  s_add_u32 s38, s38, 2048
L2_p2:
  v_accvgpr_write_b32 a0, 0
  v_accvgpr_write_b32 a1, 0
  v_accvgpr_write_b32 a2, 0
  v_accvgpr_write_b32 a3, 0
  v_accvgpr_write_b32 a4, 0
  v_accvgpr_write_b32 a5, 0
  v_accvgpr_write_b32 a6, 0
  v_accvgpr_write_b32 a7, 0
  v_accvgpr_write_b32 a8, 0
  v_accvgpr_write_b32 a9, 0
  v_accvgpr_write_b32 a10, 0
  v_accvgpr_write_b32 a11, 0
  v_accvgpr_write_b32 a12, 0
  v_accvgpr_write_b32 a13, 0
  v_accvgpr_write_b32 a14, 0
  v_accvgpr_write_b32 a15, 0
  v_accvgpr_write_b32 a16, 0
  v_accvgpr_write_b32 a17, 0
  v_accvgpr_write_b32 a18, 0
  v_accvgpr_write_b32 a19, 0
  v_accvgpr_write_b32 a20, 0
  v_accvgpr_write_b32 a21, 0
  v_accvgpr_write_b32 a22, 0
  v_accvgpr_write_b32 a23, 0
  v_accvgpr_write_b32 a24, 0
  v_accvgpr_write_b32 a25, 0
  v_accvgpr_write_b32 a26, 0
  v_accvgpr_write_b32 a27, 0
  v_accvgpr_write_b32 a28, 0
  v_accvgpr_write_b32 a29, 0
  v_accvgpr_write_b32 a30, 0
  v_accvgpr_write_b32 a31, 0
  v_accvgpr_write_b32 a32, 0
  v_accvgpr_write_b32 a33, 0
  v_accvgpr_write_b32 a34, 0
  v_accvgpr_write_b32 a35, 0
  v_accvgpr_write_b32 a36, 0
  v_accvgpr_write_b32 a37, 0
  v_accvgpr_write_b32 a38, 0
  v_accvgpr_write_b32 a39, 0
  v_accvgpr_write_b32 a40, 0
  v_accvgpr_write_b32 a41, 0
  v_accvgpr_write_b32 a42, 0
  v_accvgpr_write_b32 a43, 0
  v_accvgpr_write_b32 a44, 0
  v_accvgpr_write_b32 a45, 0
  v_accvgpr_write_b32 a46, 0
  v_accvgpr_write_b32 a47, 0
  v_accvgpr_write_b32 a48, 0
  v_accvgpr_write_b32 a49, 0
  v_accvgpr_write_b32 a50, 0
  v_accvgpr_write_b32 a51, 0
  v_accvgpr_write_b32 a52, 0
  v_accvgpr_write_b32 a53, 0
  v_accvgpr_write_b32 a54, 0
  v_accvgpr_write_b32 a55, 0
  v_accvgpr_write_b32 a56, 0
  v_accvgpr_write_b32 a57, 0
  v_accvgpr_write_b32 a58, 0
  v_accvgpr_write_b32 a59, 0
  v_accvgpr_write_b32 a60, 0
  v_accvgpr_write_b32 a61, 0
  v_accvgpr_write_b32 a62, 0
  v_accvgpr_write_b32 a63, 0
  v_accvgpr_write_b32 a64, 0
  v_accvgpr_write_b32 a65, 0
  v_accvgpr_write_b32 a66, 0
  v_accvgpr_write_b32 a67, 0
  v_accvgpr_write_b32 a68, 0
  v_accvgpr_write_b32 a69, 0
  v_accvgpr_write_b32 a70, 0
  v_accvgpr_write_b32 a71, 0
  v_accvgpr_write_b32 a72, 0
  v_accvgpr_write_b32 a73, 0
  v_accvgpr_write_b32 a74, 0
  v_accvgpr_write_b32 a75, 0
  v_accvgpr_write_b32 a76, 0
  v_accvgpr_write_b32 a77, 0
  v_accvgpr_write_b32 a78, 0
  v_accvgpr_write_b32 a79, 0
  s_mov_b32 s24, s4
  s_and_b32 s25, s5, 0xffff
  s_mov_b32 s26, 2621440
  s_mov_b32 s27, 0x20000
  s_mov_b32 s28, s10
  s_and_b32 s29, s11, 0xffff
  s_mov_b32 s30, 2621440
  s_mov_b32 s31, 0x20000
  v_add_u32 v13, 0, v0
  v_mul_u32_u24 v14, 6554, v13
  v_lshrrev_b32 v14, 16, v14
  v_mul_u32_u24 v15, 10, v14
  v_sub_u32 v15, v13, v15
  v_add_u32 v16, s36, v14
  v_mul_u32_u24 v17, 1280, v16
  v_lshl_add_u32 v17, v15, 4, v17
  s_mul_i32 s39, s37, 160
  v_add_u32 v17, s39, v17
  v_cmp_gt_u32 vcc, 640, v13
  v_mov_b32 v18, 2146435072
  v_cndmask_b32 v20, v18, v17, vcc
  v_min_u32 v14, 63, v14
  v_mul_u32_u24 v14, 336, v14
  v_lshl_add_u32 v23, v15, 5, v14
  v_add_u32 v13, 256, v0
  v_mul_u32_u24 v14, 6554, v13
  v_lshrrev_b32 v14, 16, v14
  v_mul_u32_u24 v15, 10, v14
  v_sub_u32 v15, v13, v15
  v_add_u32 v16, s36, v14
  v_mul_u32_u24 v17, 1280, v16
  v_lshl_add_u32 v17, v15, 4, v17
  s_mul_i32 s39, s37, 160
  v_add_u32 v17, s39, v17
  v_cmp_gt_u32 vcc, 640, v13
  v_mov_b32 v18, 2146435072
  v_cndmask_b32 v21, v18, v17, vcc
  v_min_u32 v14, 63, v14
  v_mul_u32_u24 v14, 336, v14
  v_lshl_add_u32 v24, v15, 5, v14
  v_add_u32 v13, 512, v0
  v_mul_u32_u24 v14, 6554, v13
  v_lshrrev_b32 v14, 16, v14
  v_mul_u32_u24 v15, 10, v14
  v_sub_u32 v15, v13, v15
  v_add_u32 v16, s36, v14
  v_mul_u32_u24 v17, 1280, v16
  v_lshl_add_u32 v17, v15, 4, v17
  s_mul_i32 s39, s37, 160
  v_add_u32 v17, s39, v17
  v_cmp_gt_u32 vcc, 640, v13
  v_mov_b32 v18, 2146435072
  v_cndmask_b32 v22, v18, v17, vcc
  v_min_u32 v14, 63, v14
  v_mul_u32_u24 v14, 336, v14
  v_lshl_add_u32 v25, v15, 5, v14
  s_cmp_eq_u32 s3, 0
  s_cbranch_scc0 L2_p3
  s_waitcnt vmcnt(27)
  v_mfma_f32_16x16x32_bf16 a[0:3], v[44:47], v[28:31], a[0:3]
  buffer_load_dwordx4 v[172:175], v4, s[16:19], s38 offen offset:0
  v_mfma_f32_16x16x32_bf16 a[20:23], v[44:47], v[32:35], a[20:23]
  v_mfma_f32_16x16x32_bf16 a[40:43], v[44:47], v[36:39], a[40:43]
  buffer_load_dwordx4 v[176:179], v5, s[16:19], s38 offen offset:0
  v_mfma_f32_16x16x32_bf16 a[60:63], v[44:47], v[40:43], a[60:63]
  v_mfma_f32_16x16x32_bf16 a[4:7], v[48:51], v[28:31], a[4:7]
  buffer_load_dwordx4 v[180:183], v6, s[16:19], s38 offen offset:0
  v_mfma_f32_16x16x32_bf16 a[24:27], v[48:51], v[32:35], a[24:27]
  v_mfma_f32_16x16x32_bf16 a[44:47], v[48:51], v[36:39], a[44:47]
  buffer_load_dwordx4 v[184:187], v7, s[16:19], s38 offen offset:0
  v_mfma_f32_16x16x32_bf16 a[64:67], v[48:51], v[40:43], a[64:67]
  v_mfma_f32_16x16x32_bf16 a[8:11], v[52:55], v[28:31], a[8:11]
  buffer_load_dwordx4 v[188:191], v8, s[16:19], s38 offen offset:0
  v_mfma_f32_16x16x32_bf16 a[28:31], v[52:55], v[32:35], a[28:31]
  v_mfma_f32_16x16x32_bf16 a[48:51], v[52:55], v[36:39], a[48:51]
  buffer_load_dwordx4 v[192:195], v9, s[16:19], s38 offen offset:0
  v_mfma_f32_16x16x32_bf16 a[68:71], v[52:55], v[40:43], a[68:71]
  v_mfma_f32_16x16x32_bf16 a[12:15], v[56:59], v[28:31], a[12:15]
  buffer_load_dwordx4 v[196:199], v10, s[16:19], s38 offen offset:0
  v_mfma_f32_16x16x32_bf16 a[32:35], v[56:59], v[32:35], a[32:35]
  v_mfma_f32_16x16x32_bf16 a[52:55], v[56:59], v[36:39], a[52:55]
  buffer_load_dwordx4 v[200:203], v11, s[16:19], s38 offen offset:0
  v_mfma_f32_16x16x32_bf16 a[72:75], v[56:59], v[40:43], a[72:75]
  v_mfma_f32_16x16x32_bf16 a[16:19], v[60:63], v[28:31], a[16:19]
  buffer_load_dwordx4 v[204:207], v12, s[16:19], s38 offen offset:0
  v_mfma_f32_16x16x32_bf16 a[36:39], v[60:63], v[32:35], a[36:39]
  v_mfma_f32_16x16x32_bf16 a[56:59], v[60:63], v[36:39], a[56:59]
  buffer_load_dwordx4 v[208:211], v4, s[16:19], s38 offen offset:1024
  v_mfma_f32_16x16x32_bf16 a[76:79], v[60:63], v[40:43], a[76:79]
  s_waitcnt vmcnt(28)
  v_mfma_f32_16x16x32_bf16 a[0:3], v[80:83], v[64:67], a[0:3]
  buffer_load_dwordx4 v[212:215], v5, s[16:19], s38 offen offset:1024
  v_mfma_f32_16x16x32_bf16 a[20:23], v[80:83], v[68:71], a[20:23]
  v_mfma_f32_16x16x32_bf16 a[40:43], v[80:83], v[72:75], a[40:43]
  buffer_load_dwordx4 v[216:219], v6, s[16:19], s38 offen offset:1024
  v_mfma_f32_16x16x32_bf16 a[60:63], v[80:83], v[76:79], a[60:63]
  v_mfma_f32_16x16x32_bf16 a[4:7], v[84:87], v[64:67], a[4:7]
  buffer_load_dwordx4 v[220:223], v7, s[16:19], s38 offen offset:1024
  v_mfma_f32_16x16x32_bf16 a[24:27], v[84:87], v[68:71], a[24:27]
  v_mfma_f32_16x16x32_bf16 a[44:47], v[84:87], v[72:75], a[44:47]
  buffer_load_dwordx4 v[224:227], v8, s[16:19], s38 offen offset:1024
  v_mfma_f32_16x16x32_bf16 a[64:67], v[84:87], v[76:79], a[64:67]
  v_mfma_f32_16x16x32_bf16 a[8:11], v[88:91], v[64:67], a[8:11]
  buffer_load_dwordx4 v[228:231], v9, s[16:19], s38 offen offset:1024
  v_mfma_f32_16x16x32_bf16 a[28:31], v[88:91], v[68:71], a[28:31]
  v_mfma_f32_16x16x32_bf16 a[48:51], v[88:91], v[72:75], a[48:51]
  buffer_load_dwordx4 v[232:235], v10, s[16:19], s38 offen offset:1024
  v_mfma_f32_16x16x32_bf16 a[68:71], v[88:91], v[76:79], a[68:71]
  v_mfma_f32_16x16x32_bf16 a[12:15], v[92:95], v[64:67], a[12:15]
  buffer_load_dwordx4 v[236:239], v11, s[16:19], s38 offen offset:1024
  v_mfma_f32_16x16x32_bf16 a[32:35], v[92:95], v[68:71], a[32:35]
  v_mfma_f32_16x16x32_bf16 a[52:55], v[92:95], v[72:75], a[52:55]
  buffer_load_dwordx4 v[240:243], v12, s[16:19], s38 offen offset:1024
  s_add_u32 s38, s38, 2048
  v_mfma_f32_16x16x32_bf16 a[72:75], v[92:95], v[76:79], a[72:75]
  v_mfma_f32_16x16x32_bf16 a[16:19], v[96:99], v[64:67], a[16:19]
  v_mfma_f32_16x16x32_bf16 a[36:39], v[96:99], v[68:71], a[36:39]
  v_mfma_f32_16x16x32_bf16 a[56:59], v[96:99], v[72:75], a[56:59]
  v_mfma_f32_16x16x32_bf16 a[76:79], v[96:99], v[76:79], a[76:79]
L2_p3:
  s_waitcnt vmcnt(27)
  v_mfma_f32_16x16x32_bf16 a[0:3], v[116:119], v[100:103], a[0:3]
  buffer_load_dwordx4 v[28:31], v4, s[16:19], s38 offen offset:0
  v_mfma_f32_16x16x32_bf16 a[20:23], v[116:119], v[104:107], a[20:23]
  v_mfma_f32_16x16x32_bf16 a[40:43], v[116:119], v[108:111], a[40:43]
  buffer_load_dwordx4 v[32:35], v5, s[16:19], s38 offen offset:0
  v_mfma_f32_16x16x32_bf16 a[60:63], v[116:119], v[112:115], a[60:63]
  v_mfma_f32_16x16x32_bf16 a[4:7], v[120:123], v[100:103], a[4:7]
  buffer_load_dwordx4 v[36:39], v6, s[16:19], s38 offen offset:0
  v_mfma_f32_16x16x32_bf16 a[24:27], v[120:123], v[104:107], a[24:27]
  v_mfma_f32_16x16x32_bf16 a[44:47], v[120:123], v[108:111], a[44:47]
  buffer_load_dwordx4 v[40:43], v7, s[16:19], s38 offen offset:0
  v_mfma_f32_16x16x32_bf16 a[64:67], v[120:123], v[112:115], a[64:67]
  v_mfma_f32_16x16x32_bf16 a[8:11], v[124:127], v[100:103], a[8:11]
  buffer_load_dwordx4 v[44:47], v8, s[16:19], s38 offen offset:0
  v_mfma_f32_16x16x32_bf16 a[28:31], v[124:127], v[104:107], a[28:31]
  v_mfma_f32_16x16x32_bf16 a[48:51], v[124:127], v[108:111], a[48:51]
  buffer_load_dwordx4 v[48:51], v9, s[16:19], s38 offen offset:0
  v_mfma_f32_16x16x32_bf16 a[68:71], v[124:127], v[112:115], a[68:71]
  v_mfma_f32_16x16x32_bf16 a[12:15], v[128:131], v[100:103], a[12:15]
  buffer_load_dwordx4 v[52:55], v10, s[16:19], s38 offen offset:0
  v_mfma_f32_16x16x32_bf16 a[32:35], v[128:131], v[104:107], a[32:35]
  v_mfma_f32_16x16x32_bf16 a[52:55], v[128:131], v[108:111], a[52:55]
  buffer_load_dwordx4 v[56:59], v11, s[16:19], s38 offen offset:0
  v_mfma_f32_16x16x32_bf16 a[72:75], v[128:131], v[112:115], a[72:75]
  v_mfma_f32_16x16x32_bf16 a[16:19], v[132:135], v[100:103], a[16:19]
  buffer_load_dwordx4 v[60:63], v12, s[16:19], s38 offen offset:0
  v_mfma_f32_16x16x32_bf16 a[36:39], v[132:135], v[104:107], a[36:39]
  v_mfma_f32_16x16x32_bf16 a[56:59], v[132:135], v[108:111], a[56:59]
  buffer_load_dwordx4 v[64:67], v4, s[16:19], s38 offen offset:1024
  v_mfma_f32_16x16x32_bf16 a[76:79], v[132:135], v[112:115], a[76:79]
  s_waitcnt vmcnt(28)
  v_mfma_f32_16x16x32_bf16 a[0:3], v[152:155], v[136:139], a[0:3]
  buffer_load_dwordx4 v[68:71], v5, s[16:19], s38 offen offset:1024
  v_mfma_f32_16x16x32_bf16 a[20:23], v[152:155], v[140:143], a[20:23]
  v_mfma_f32_16x16x32_bf16 a[40:43], v[152:155], v[144:147], a[40:43]
  buffer_load_dwordx4 v[72:75], v6, s[16:19], s38 offen offset:1024
  v_mfma_f32_16x16x32_bf16 a[60:63], v[152:155], v[148:151], a[60:63]
  v_mfma_f32_16x16x32_bf16 a[4:7], v[156:159], v[136:139], a[4:7]
  buffer_load_dwordx4 v[76:79], v7, s[16:19], s38 offen offset:1024
  v_mfma_f32_16x16x32_bf16 a[24:27], v[156:159], v[140:143], a[24:27]
  v_mfma_f32_16x16x32_bf16 a[44:47], v[156:159], v[144:147], a[44:47]
  buffer_load_dwordx4 v[80:83], v8, s[16:19], s38 offen offset:1024
  v_mfma_f32_16x16x32_bf16 a[64:67], v[156:159], v[148:151], a[64:67]
  v_mfma_f32_16x16x32_bf16 a[8:11], v[160:163], v[136:139], a[8:11]
  buffer_load_dwordx4 v[84:87], v9, s[16:19], s38 offen offset:1024
  v_mfma_f32_16x16x32_bf16 a[28:31], v[160:163], v[140:143], a[28:31]
  v_mfma_f32_16x16x32_bf16 a[48:51], v[160:163], v[144:147], a[48:51]
  buffer_load_dwordx4 v[88:91], v10, s[16:19], s38 offen offset:1024
  v_mfma_f32_16x16x32_bf16 a[68:71], v[160:163], v[148:151], a[68:71]
  v_mfma_f32_16x16x32_bf16 a[12:15], v[164:167], v[136:139], a[12:15]
  buffer_load_dwordx4 v[92:95], v11, s[16:19], s38 offen offset:1024
  v_mfma_f32_16x16x32_bf16 a[32:35], v[164:167], v[140:143], a[32:35]
  v_mfma_f32_16x16x32_bf16 a[52:55], v[164:167], v[144:147], a[52:55]
  buffer_load_dwordx4 v[96:99], v12, s[16:19], s38 offen offset:1024
  s_add_u32 s38, s38, 2048
  v_mfma_f32_16x16x32_bf16 a[72:75], v[164:167], v[148:151], a[72:75]
  v_mfma_f32_16x16x32_bf16 a[16:19], v[168:171], v[136:139], a[16:19]
  v_mfma_f32_16x16x32_bf16 a[36:39], v[168:171], v[140:143], a[36:39]
  v_mfma_f32_16x16x32_bf16 a[56:59], v[168:171], v[144:147], a[56:59]
  v_mfma_f32_16x16x32_bf16 a[76:79], v[168:171], v[148:151], a[76:79]
  s_waitcnt vmcnt(27)
  v_mfma_f32_16x16x32_bf16 a[0:3], v[188:191], v[172:175], a[0:3]
  buffer_load_dwordx4 v[100:103], v4, s[16:19], s38 offen offset:0
  v_mfma_f32_16x16x32_bf16 a[20:23], v[188:191], v[176:179], a[20:23]
  v_mfma_f32_16x16x32_bf16 a[40:43], v[188:191], v[180:183], a[40:43]
  buffer_load_dwordx4 v[104:107], v5, s[16:19], s38 offen offset:0
  v_mfma_f32_16x16x32_bf16 a[60:63], v[188:191], v[184:187], a[60:63]
  v_mfma_f32_16x16x32_bf16 a[4:7], v[192:195], v[172:175], a[4:7]
  buffer_load_dwordx4 v[108:111], v6, s[16:19], s38 offen offset:0
  v_mfma_f32_16x16x32_bf16 a[24:27], v[192:195], v[176:179], a[24:27]
  v_mfma_f32_16x16x32_bf16 a[44:47], v[192:195], v[180:183], a[44:47]
  buffer_load_dwordx4 v[112:115], v7, s[16:19], s38 offen offset:0
  v_mfma_f32_16x16x32_bf16 a[64:67], v[192:195], v[184:187], a[64:67]
  v_mfma_f32_16x16x32_bf16 a[8:11], v[196:199], v[172:175], a[8:11]
  buffer_load_dwordx4 v[116:119], v8, s[16:19], s38 offen offset:0
  v_mfma_f32_16x16x32_bf16 a[28:31], v[196:199], v[176:179], a[28:31]
  v_mfma_f32_16x16x32_bf16 a[48:51], v[196:199], v[180:183], a[48:51]
  buffer_load_dwordx4 v[120:123], v9, s[16:19], s38 offen offset:0
  v_mfma_f32_16x16x32_bf16 a[68:71], v[196:199], v[184:187], a[68:71]
  v_mfma_f32_16x16x32_bf16 a[12:15], v[200:203], v[172:175], a[12:15]
  buffer_load_dwordx4 v[124:127], v10, s[16:19], s38 offen offset:0
  v_mfma_f32_16x16x32_bf16 a[32:35], v[200:203], v[176:179], a[32:35]
  v_mfma_f32_16x16x32_bf16 a[52:55], v[200:203], v[180:183], a[52:55]
  buffer_load_dwordx4 v[128:131], v11, s[16:19], s38 offen offset:0
  v_mfma_f32_16x16x32_bf16 a[72:75], v[200:203], v[184:187], a[72:75]
  v_mfma_f32_16x16x32_bf16 a[16:19], v[204:207], v[172:175], a[16:19]
  buffer_load_dwordx4 v[132:135], v12, s[16:19], s38 offen offset:0
  v_mfma_f32_16x16x32_bf16 a[36:39], v[204:207], v[176:179], a[36:39]
  v_mfma_f32_16x16x32_bf16 a[56:59], v[204:207], v[180:183], a[56:59]
  buffer_load_dwordx4 v[136:139], v4, s[16:19], s38 offen offset:1024
  v_mfma_f32_16x16x32_bf16 a[76:79], v[204:207], v[184:187], a[76:79]
  s_waitcnt vmcnt(28)
  v_mfma_f32_16x16x32_bf16 a[0:3], v[224:227], v[208:211], a[0:3]
  buffer_load_dwordx4 v[140:143], v5, s[16:19], s38 offen offset:1024
  v_mfma_f32_16x16x32_bf16 a[20:23], v[224:227], v[212:215], a[20:23]
  v_mfma_f32_16x16x32_bf16 a[40:43], v[224:227], v[216:219], a[40:43]
  buffer_load_dwordx4 v[144:147], v6, s[16:19], s38 offen offset:1024
  v_mfma_f32_16x16x32_bf16 a[60:63], v[224:227], v[220:223], a[60:63]
  v_mfma_f32_16x16x32_bf16 a[4:7], v[228:231], v[208:211], a[4:7]
  buffer_load_dwordx4 v[148:151], v7, s[16:19], s38 offen offset:1024
  v_mfma_f32_16x16x32_bf16 a[24:27], v[228:231], v[212:215], a[24:27]
  v_mfma_f32_16x16x32_bf16 a[44:47], v[228:231], v[216:219], a[44:47]
  buffer_load_dwordx4 v[152:155], v8, s[16:19], s38 offen offset:1024
  v_mfma_f32_16x16x32_bf16 a[64:67], v[228:231], v[220:223], a[64:67]
  v_mfma_f32_16x16x32_bf16 a[8:11], v[232:235], v[208:211], a[8:11]
  buffer_load_dwordx4 v[156:159], v9, s[16:19], s38 offen offset:1024
  v_mfma_f32_16x16x32_bf16 a[28:31], v[232:235], v[212:215], a[28:31]
  v_mfma_f32_16x16x32_bf16 a[48:51], v[232:235], v[216:219], a[48:51]
  buffer_load_dwordx4 v[160:163], v10, s[16:19], s38 offen offset:1024
  v_mfma_f32_16x16x32_bf16 a[68:71], v[232:235], v[220:223], a[68:71]
  v_mfma_f32_16x16x32_bf16 a[12:15], v[236:239], v[208:211], a[12:15]
  buffer_load_dwordx4 v[164:167], v11, s[16:19], s38 offen offset:1024
  v_mfma_f32_16x16x32_bf16 a[32:35], v[236:239], v[212:215], a[32:35]
  v_mfma_f32_16x16x32_bf16 a[52:55], v[236:239], v[216:219], a[52:55]
  buffer_load_dwordx4 v[168:171], v12, s[16:19], s38 offen offset:1024
  s_add_u32 s38, s38, 2048
  v_mfma_f32_16x16x32_bf16 a[72:75], v[236:239], v[220:223], a[72:75]
  v_mfma_f32_16x16x32_bf16 a[16:19], v[240:243], v[208:211], a[16:19]
  v_mfma_f32_16x16x32_bf16 a[36:39], v[240:243], v[212:215], a[36:39]
  v_mfma_f32_16x16x32_bf16 a[56:59], v[240:243], v[216:219], a[56:59]
  v_mfma_f32_16x16x32_bf16 a[76:79], v[240:243], v[220:223], a[76:79]
  s_waitcnt vmcnt(27)
  v_mfma_f32_16x16x32_bf16 a[0:3], v[44:47], v[28:31], a[0:3]
  buffer_load_dwordx4 v[172:175], v4, s[16:19], s38 offen offset:0
  v_mfma_f32_16x16x32_bf16 a[20:23], v[44:47], v[32:35], a[20:23]
  v_mfma_f32_16x16x32_bf16 a[40:43], v[44:47], v[36:39], a[40:43]
  buffer_load_dwordx4 v[176:179], v5, s[16:19], s38 offen offset:0
  v_mfma_f32_16x16x32_bf16 a[60:63], v[44:47], v[40:43], a[60:63]
  v_mfma_f32_16x16x32_bf16 a[4:7], v[48:51], v[28:31], a[4:7]
  buffer_load_dwordx4 v[180:183], v6, s[16:19], s38 offen offset:0
  v_mfma_f32_16x16x32_bf16 a[24:27], v[48:51], v[32:35], a[24:27]
  v_mfma_f32_16x16x32_bf16 a[44:47], v[48:51], v[36:39], a[44:47]
  buffer_load_dwordx4 v[184:187], v7, s[16:19], s38 offen offset:0
  v_mfma_f32_16x16x32_bf16 a[64:67], v[48:51], v[40:43], a[64:67]
  v_mfma_f32_16x16x32_bf16 a[8:11], v[52:55], v[28:31], a[8:11]
  buffer_load_dwordx4 v[188:191], v8, s[16:19], s38 offen offset:0
  v_mfma_f32_16x16x32_bf16 a[28:31], v[52:55], v[32:35], a[28:31]
  v_mfma_f32_16x16x32_bf16 a[48:51], v[52:55], v[36:39], a[48:51]
  buffer_load_dwordx4 v[192:195], v9, s[16:19], s38 offen offset:0
  v_mfma_f32_16x16x32_bf16 a[68:71], v[52:55], v[40:43], a[68:71]
  v_mfma_f32_16x16x32_bf16 a[12:15], v[56:59], v[28:31], a[12:15]
  buffer_load_dwordx4 v[196:199], v10, s[16:19], s38 offen offset:0
  v_mfma_f32_16x16x32_bf16 a[32:35], v[56:59], v[32:35], a[32:35]
  v_mfma_f32_16x16x32_bf16 a[52:55], v[56:59], v[36:39], a[52:55]
  buffer_load_dwordx4 v[200:203], v11, s[16:19], s38 offen offset:0
  v_mfma_f32_16x16x32_bf16 a[72:75], v[56:59], v[40:43], a[72:75]
  v_mfma_f32_16x16x32_bf16 a[16:19], v[60:63], v[28:31], a[16:19]
  buffer_load_dwordx4 v[204:207], v12, s[16:19], s38 offen offset:0
  v_mfma_f32_16x16x32_bf16 a[36:39], v[60:63], v[32:35], a[36:39]
  v_mfma_f32_16x16x32_bf16 a[56:59], v[60:63], v[36:39], a[56:59]
  buffer_load_dwordx4 v[208:211], v4, s[16:19], s38 offen offset:1024
  v_mfma_f32_16x16x32_bf16 a[76:79], v[60:63], v[40:43], a[76:79]
  s_waitcnt vmcnt(28)
  v_mfma_f32_16x16x32_bf16 a[0:3], v[80:83], v[64:67], a[0:3]
  buffer_load_dwordx4 v[212:215], v5, s[16:19], s38 offen offset:1024
  v_mfma_f32_16x16x32_bf16 a[20:23], v[80:83], v[68:71], a[20:23]
  v_mfma_f32_16x16x32_bf16 a[40:43], v[80:83], v[72:75], a[40:43]
  buffer_load_dwordx4 v[216:219], v6, s[16:19], s38 offen offset:1024
  v_mfma_f32_16x16x32_bf16 a[60:63], v[80:83], v[76:79], a[60:63]
  v_mfma_f32_16x16x32_bf16 a[4:7], v[84:87], v[64:67], a[4:7]
  buffer_load_dwordx4 v[220:223], v7, s[16:19], s38 offen offset:1024
  v_mfma_f32_16x16x32_bf16 a[24:27], v[84:87], v[68:71], a[24:27]
  v_mfma_f32_16x16x32_bf16 a[44:47], v[84:87], v[72:75], a[44:47]
  buffer_load_dwordx4 v[224:227], v8, s[16:19], s38 offen offset:1024
  v_mfma_f32_16x16x32_bf16 a[64:67], v[84:87], v[76:79], a[64:67]
  v_mfma_f32_16x16x32_bf16 a[8:11], v[88:91], v[64:67], a[8:11]
  buffer_load_dwordx4 v[228:231], v9, s[16:19], s38 offen offset:1024
  v_mfma_f32_16x16x32_bf16 a[28:31], v[88:91], v[68:71], a[28:31]
  v_mfma_f32_16x16x32_bf16 a[48:51], v[88:91], v[72:75], a[48:51]
  buffer_load_dwordx4 v[232:235], v10, s[16:19], s38 offen offset:1024
  v_mfma_f32_16x16x32_bf16 a[68:71], v[88:91], v[76:79], a[68:71]
  v_mfma_f32_16x16x32_bf16 a[12:15], v[92:95], v[64:67], a[12:15]
  buffer_load_dwordx4 v[236:239], v11, s[16:19], s38 offen offset:1024
  v_mfma_f32_16x16x32_bf16 a[32:35], v[92:95], v[68:71], a[32:35]
  v_mfma_f32_16x16x32_bf16 a[52:55], v[92:95], v[72:75], a[52:55]
  buffer_load_dwordx4 v[240:243], v12, s[16:19], s38 offen offset:1024
  s_add_u32 s38, s38, 2048
  v_mfma_f32_16x16x32_bf16 a[72:75], v[92:95], v[76:79], a[72:75]
  v_mfma_f32_16x16x32_bf16 a[16:19], v[96:99], v[64:67], a[16:19]
  v_mfma_f32_16x16x32_bf16 a[36:39], v[96:99], v[68:71], a[36:39]
  v_mfma_f32_16x16x32_bf16 a[56:59], v[96:99], v[72:75], a[56:59]
  v_mfma_f32_16x16x32_bf16 a[76:79], v[96:99], v[76:79], a[76:79]
  s_waitcnt vmcnt(27)
  v_mfma_f32_16x16x32_bf16 a[0:3], v[116:119], v[100:103], a[0:3]
  buffer_load_dwordx4 v[28:31], v4, s[16:19], s38 offen offset:0
  v_mfma_f32_16x16x32_bf16 a[20:23], v[116:119], v[104:107], a[20:23]
  v_mfma_f32_16x16x32_bf16 a[40:43], v[116:119], v[108:111], a[40:43]
  buffer_load_dwordx4 v[32:35], v5, s[16:19], s38 offen offset:0
  v_mfma_f32_16x16x32_bf16 a[60:63], v[116:119], v[112:115], a[60:63]
  v_mfma_f32_16x16x32_bf16 a[4:7], v[120:123], v[100:103], a[4:7]
  buffer_load_dwordx4 v[36:39], v6, s[16:19], s38 offen offset:0
  v_mfma_f32_16x16x32_bf16 a[24:27], v[120:123], v[104:107], a[24:27]
  v_mfma_f32_16x16x32_bf16 a[44:47], v[120:123], v[108:111], a[44:47]
  buffer_load_dwordx4 v[40:43], v7, s[16:19], s38 offen offset:0
  v_mfma_f32_16x16x32_bf16 a[64:67], v[120:123], v[112:115], a[64:67]
  v_mfma_f32_16x16x32_bf16 a[8:11], v[124:127], v[100:103], a[8:11]
  buffer_load_dwordx4 v[44:47], v8, s[16:19], s38 offen offset:0
  v_mfma_f32_16x16x32_bf16 a[28:31], v[124:127], v[104:107], a[28:31]
  v_mfma_f32_16x16x32_bf16 a[48:51], v[124:127], v[108:111], a[48:51]
  buffer_load_dwordx4 v[48:51], v9, s[16:19], s38 offen offset:0
  v_mfma_f32_16x16x32_bf16 a[68:71], v[124:127], v[112:115], a[68:71]
  v_mfma_f32_16x16x32_bf16 a[12:15], v[128:131], v[100:103], a[12:15]
  buffer_load_dwordx4 v[52:55], v10, s[16:19], s38 offen offset:0
  v_mfma_f32_16x16x32_bf16 a[32:35], v[128:131], v[104:107], a[32:35]
  v_mfma_f32_16x16x32_bf16 a[52:55], v[128:131], v[108:111], a[52:55]
  buffer_load_dwordx4 v[56:59], v11, s[16:19], s38 offen offset:0
  v_mfma_f32_16x16x32_bf16 a[72:75], v[128:131], v[112:115], a[72:75]
  v_mfma_f32_16x16x32_bf16 a[16:19], v[132:135], v[100:103], a[16:19]
  buffer_load_dwordx4 v[60:63], v12, s[16:19], s38 offen offset:0
  v_mfma_f32_16x16x32_bf16 a[36:39], v[132:135], v[104:107], a[36:39]
  v_mfma_f32_16x16x32_bf16 a[56:59], v[132:135], v[108:111], a[56:59]
  buffer_load_dwordx4 v[64:67], v4, s[16:19], s38 offen offset:1024
  v_mfma_f32_16x16x32_bf16 a[76:79], v[132:135], v[112:115], a[76:79]
  s_waitcnt vmcnt(28)
  v_mfma_f32_16x16x32_bf16 a[0:3], v[152:155], v[136:139], a[0:3]
  buffer_load_dwordx4 v[68:71], v5, s[16:19], s38 offen offset:1024
  v_mfma_f32_16x16x32_bf16 a[20:23], v[152:155], v[140:143], a[20:23]
  v_mfma_f32_16x16x32_bf16 a[40:43], v[152:155], v[144:147], a[40:43]
  buffer_load_dwordx4 v[72:75], v6, s[16:19], s38 offen offset:1024
  v_mfma_f32_16x16x32_bf16 a[60:63], v[152:155], v[148:151], a[60:63]
  v_mfma_f32_16x16x32_bf16 a[4:7], v[156:159], v[136:139], a[4:7]
  buffer_load_dwordx4 v[76:79], v7, s[16:19], s38 offen offset:1024
  v_mfma_f32_16x16x32_bf16 a[24:27], v[156:159], v[140:143], a[24:27]
  v_mfma_f32_16x16x32_bf16 a[44:47], v[156:159], v[144:147], a[44:47]
  buffer_load_dwordx4 v[80:83], v8, s[16:19], s38 offen offset:1024
  v_mfma_f32_16x16x32_bf16 a[64:67], v[156:159], v[148:151], a[64:67]
  v_mfma_f32_16x16x32_bf16 a[8:11], v[160:163], v[136:139], a[8:11]
  buffer_load_dwordx4 v[84:87], v9, s[16:19], s38 offen offset:1024
  v_mfma_f32_16x16x32_bf16 a[28:31], v[160:163], v[140:143], a[28:31]
  v_mfma_f32_16x16x32_bf16 a[48:51], v[160:163], v[144:147], a[48:51]
  buffer_load_dwordx4 v[88:91], v10, s[16:19], s38 offen offset:1024
  v_mfma_f32_16x16x32_bf16 a[68:71], v[160:163], v[148:151], a[68:71]
  v_mfma_f32_16x16x32_bf16 a[12:15], v[164:167], v[136:139], a[12:15]
  buffer_load_dwordx4 v[92:95], v11, s[16:19], s38 offen offset:1024
  v_mfma_f32_16x16x32_bf16 a[32:35], v[164:167], v[140:143], a[32:35]
  v_mfma_f32_16x16x32_bf16 a[52:55], v[164:167], v[144:147], a[52:55]
  buffer_load_dwordx4 v[96:99], v12, s[16:19], s38 offen offset:1024
  s_add_u32 s38, s38, 2048
  v_mfma_f32_16x16x32_bf16 a[72:75], v[164:167], v[148:151], a[72:75]
  v_mfma_f32_16x16x32_bf16 a[16:19], v[168:171], v[136:139], a[16:19]
  v_mfma_f32_16x16x32_bf16 a[36:39], v[168:171], v[140:143], a[36:39]
  v_mfma_f32_16x16x32_bf16 a[56:59], v[168:171], v[144:147], a[56:59]
  v_mfma_f32_16x16x32_bf16 a[76:79], v[168:171], v[148:151], a[76:79]
  s_waitcnt vmcnt(27)
  v_mfma_f32_16x16x32_bf16 a[0:3], v[188:191], v[172:175], a[0:3]
  buffer_load_dwordx4 v[100:103], v4, s[16:19], s38 offen offset:0
  v_mfma_f32_16x16x32_bf16 a[20:23], v[188:191], v[176:179], a[20:23]
  v_mfma_f32_16x16x32_bf16 a[40:43], v[188:191], v[180:183], a[40:43]
  buffer_load_dwordx4 v[104:107], v5, s[16:19], s38 offen offset:0
  v_mfma_f32_16x16x32_bf16 a[60:63], v[188:191], v[184:187], a[60:63]
  v_mfma_f32_16x16x32_bf16 a[4:7], v[192:195], v[172:175], a[4:7]
  buffer_load_dwordx4 v[108:111], v6, s[16:19], s38 offen offset:0
  v_mfma_f32_16x16x32_bf16 a[24:27], v[192:195], v[176:179], a[24:27]
  v_mfma_f32_16x16x32_bf16 a[44:47], v[192:195], v[180:183], a[44:47]
  buffer_load_dwordx4 v[112:115], v7, s[16:19], s38 offen offset:0
  v_mfma_f32_16x16x32_bf16 a[64:67], v[192:195], v[184:187], a[64:67]
  v_mfma_f32_16x16x32_bf16 a[8:11], v[196:199], v[172:175], a[8:11]
  buffer_load_dwordx4 v[116:119], v8, s[16:19], s38 offen offset:0
  v_mfma_f32_16x16x32_bf16 a[28:31], v[196:199], v[176:179], a[28:31]
  v_mfma_f32_16x16x32_bf16 a[48:51], v[196:199], v[180:183], a[48:51]
  buffer_load_dwordx4 v[120:123], v9, s[16:19], s38 offen offset:0
  v_mfma_f32_16x16x32_bf16 a[68:71], v[196:199], v[184:187], a[68:71]
  v_mfma_f32_16x16x32_bf16 a[12:15], v[200:203], v[172:175], a[12:15]
  buffer_load_dwordx4 v[124:127], v10, s[16:19], s38 offen offset:0
  v_mfma_f32_16x16x32_bf16 a[32:35], v[200:203], v[176:179], a[32:35]
  v_mfma_f32_16x16x32_bf16 a[52:55], v[200:203], v[180:183], a[52:55]
  buffer_load_dwordx4 v[128:131], v11, s[16:19], s38 offen offset:0
  v_mfma_f32_16x16x32_bf16 a[72:75], v[200:203], v[184:187], a[72:75]
  v_mfma_f32_16x16x32_bf16 a[16:19], v[204:207], v[172:175], a[16:19]
  buffer_load_dwordx4 v[132:135], v12, s[16:19], s38 offen offset:0
  v_mfma_f32_16x16x32_bf16 a[36:39], v[204:207], v[176:179], a[36:39]
  v_mfma_f32_16x16x32_bf16 a[56:59], v[204:207], v[180:183], a[56:59]
  buffer_load_dwordx4 v[136:139], v4, s[16:19], s38 offen offset:1024
  v_mfma_f32_16x16x32_bf16 a[76:79], v[204:207], v[184:187], a[76:79]
  s_waitcnt vmcnt(28)
  v_mfma_f32_16x16x32_bf16 a[0:3], v[224:227], v[208:211], a[0:3]
  buffer_load_dwordx4 v[140:143], v5, s[16:19], s38 offen offset:1024
  v_mfma_f32_16x16x32_bf16 a[20:23], v[224:227], v[212:215], a[20:23]
  v_mfma_f32_16x16x32_bf16 a[40:43], v[224:227], v[216:219], a[40:43]
  buffer_load_dwordx4 v[144:147], v6, s[16:19], s38 offen offset:1024
  v_mfma_f32_16x16x32_bf16 a[60:63], v[224:227], v[220:223], a[60:63]
  v_mfma_f32_16x16x32_bf16 a[4:7], v[228:231], v[208:211], a[4:7]
  buffer_load_dwordx4 v[148:151], v7, s[16:19], s38 offen offset:1024
  v_mfma_f32_16x16x32_bf16 a[24:27], v[228:231], v[212:215], a[24:27]
  v_mfma_f32_16x16x32_bf16 a[44:47], v[228:231], v[216:219], a[44:47]
  buffer_load_dwordx4 v[152:155], v8, s[16:19], s38 offen offset:1024
  v_mfma_f32_16x16x32_bf16 a[64:67], v[228:231], v[220:223], a[64:67]
  v_mfma_f32_16x16x32_bf16 a[8:11], v[232:235], v[208:211], a[8:11]
  buffer_load_dwordx4 v[156:159], v9, s[16:19], s38 offen offset:1024
  v_mfma_f32_16x16x32_bf16 a[28:31], v[232:235], v[212:215], a[28:31]
  v_mfma_f32_16x16x32_bf16 a[48:51], v[232:235], v[216:219], a[48:51]
  buffer_load_dwordx4 v[160:163], v10, s[16:19], s38 offen offset:1024
  v_mfma_f32_16x16x32_bf16 a[68:71], v[232:235], v[220:223], a[68:71]
  v_mfma_f32_16x16x32_bf16 a[12:15], v[236:239], v[208:211], a[12:15]
  buffer_load_dwordx4 v[164:167], v11, s[16:19], s38 offen offset:1024
  v_mfma_f32_16x16x32_bf16 a[32:35], v[236:239], v[212:215], a[32:35]
  v_mfma_f32_16x16x32_bf16 a[52:55], v[236:239], v[216:219], a[52:55]
  buffer_load_dwordx4 v[168:171], v12, s[16:19], s38 offen offset:1024
  s_add_u32 s38, s38, 2048
  v_mfma_f32_16x16x32_bf16 a[72:75], v[236:239], v[220:223], a[72:75]
  v_mfma_f32_16x16x32_bf16 a[16:19], v[240:243], v[208:211], a[16:19]
  v_mfma_f32_16x16x32_bf16 a[36:39], v[240:243], v[212:215], a[36:39]
  v_mfma_f32_16x16x32_bf16 a[56:59], v[240:243], v[216:219], a[56:59]
  v_mfma_f32_16x16x32_bf16 a[76:79], v[240:243], v[220:223], a[76:79]
  s_waitcnt vmcnt(27)
  v_mfma_f32_16x16x32_bf16 a[0:3], v[44:47], v[28:31], a[0:3]
  buffer_load_dwordx4 v[172:175], v4, s[16:19], s38 offen offset:0
  v_mfma_f32_16x16x32_bf16 a[20:23], v[44:47], v[32:35], a[20:23]
  v_mfma_f32_16x16x32_bf16 a[40:43], v[44:47], v[36:39], a[40:43]
  buffer_load_dwordx4 v[176:179], v5, s[16:19], s38 offen offset:0
  v_mfma_f32_16x16x32_bf16 a[60:63], v[44:47], v[40:43], a[60:63]
  v_mfma_f32_16x16x32_bf16 a[4:7], v[48:51], v[28:31], a[4:7]
  buffer_load_dwordx4 v[180:183], v6, s[16:19], s38 offen offset:0
  v_mfma_f32_16x16x32_bf16 a[24:27], v[48:51], v[32:35], a[24:27]
  v_mfma_f32_16x16x32_bf16 a[44:47], v[48:51], v[36:39], a[44:47]
  buffer_load_dwordx4 v[184:187], v7, s[16:19], s38 offen offset:0
  v_mfma_f32_16x16x32_bf16 a[64:67], v[48:51], v[40:43], a[64:67]
  v_mfma_f32_16x16x32_bf16 a[8:11], v[52:55], v[28:31], a[8:11]
  buffer_load_dwordx4 v[188:191], v8, s[16:19], s38 offen offset:0
  v_mfma_f32_16x16x32_bf16 a[28:31], v[52:55], v[32:35], a[28:31]
  v_mfma_f32_16x16x32_bf16 a[48:51], v[52:55], v[36:39], a[48:51]
  buffer_load_dwordx4 v[192:195], v9, s[16:19], s38 offen offset:0
  v_mfma_f32_16x16x32_bf16 a[68:71], v[52:55], v[40:43], a[68:71]
  v_mfma_f32_16x16x32_bf16 a[12:15], v[56:59], v[28:31], a[12:15]
  buffer_load_dwordx4 v[196:199], v10, s[16:19], s38 offen offset:0
  v_mfma_f32_16x16x32_bf16 a[32:35], v[56:59], v[32:35], a[32:35]
  v_mfma_f32_16x16x32_bf16 a[52:55], v[56:59], v[36:39], a[52:55]
  buffer_load_dwordx4 v[200:203], v11, s[16:19], s38 offen offset:0
  v_mfma_f32_16x16x32_bf16 a[72:75], v[56:59], v[40:43], a[72:75]
  v_mfma_f32_16x16x32_bf16 a[16:19], v[60:63], v[28:31], a[16:19]
  buffer_load_dwordx4 v[204:207], v12, s[16:19], s38 offen offset:0
  v_mfma_f32_16x16x32_bf16 a[36:39], v[60:63], v[32:35], a[36:39]
  v_mfma_f32_16x16x32_bf16 a[56:59], v[60:63], v[36:39], a[56:59]
  buffer_load_dwordx4 v[208:211], v4, s[16:19], s38 offen offset:1024
  v_mfma_f32_16x16x32_bf16 a[76:79], v[60:63], v[40:43], a[76:79]
  s_waitcnt vmcnt(28)
  v_mfma_f32_16x16x32_bf16 a[0:3], v[80:83], v[64:67], a[0:3]
  buffer_load_dwordx4 v[212:215], v5, s[16:19], s38 offen offset:1024
  v_mfma_f32_16x16x32_bf16 a[20:23], v[80:83], v[68:71], a[20:23]
  v_mfma_f32_16x16x32_bf16 a[40:43], v[80:83], v[72:75], a[40:43]
  buffer_load_dwordx4 v[216:219], v6, s[16:19], s38 offen offset:1024
  v_mfma_f32_16x16x32_bf16 a[60:63], v[80:83], v[76:79], a[60:63]
  v_mfma_f32_16x16x32_bf16 a[4:7], v[84:87], v[64:67], a[4:7]
  buffer_load_dwordx4 v[220:223], v7, s[16:19], s38 offen offset:1024
  v_mfma_f32_16x16x32_bf16 a[24:27], v[84:87], v[68:71], a[24:27]
  v_mfma_f32_16x16x32_bf16 a[44:47], v[84:87], v[72:75], a[44:47]
  buffer_load_dwordx4 v[224:227], v8, s[16:19], s38 offen offset:1024
  v_mfma_f32_16x16x32_bf16 a[64:67], v[84:87], v[76:79], a[64:67]
  v_mfma_f32_16x16x32_bf16 a[8:11], v[88:91], v[64:67], a[8:11]
  buffer_load_dwordx4 v[228:231], v9, s[16:19], s38 offen offset:1024
  v_mfma_f32_16x16x32_bf16 a[28:31], v[88:91], v[68:71], a[28:31]
  v_mfma_f32_16x16x32_bf16 a[48:51], v[88:91], v[72:75], a[48:51]
  buffer_load_dwordx4 v[232:235], v10, s[16:19], s38 offen offset:1024
  v_mfma_f32_16x16x32_bf16 a[68:71], v[88:91], v[76:79], a[68:71]
  v_mfma_f32_16x16x32_bf16 a[12:15], v[92:95], v[64:67], a[12:15]
  buffer_load_dwordx4 v[236:239], v11, s[16:19], s38 offen offset:1024
  v_mfma_f32_16x16x32_bf16 a[32:35], v[92:95], v[68:71], a[32:35]
  v_mfma_f32_16x16x32_bf16 a[52:55], v[92:95], v[72:75], a[52:55]
  buffer_load_dwordx4 v[240:243], v12, s[16:19], s38 offen offset:1024
  s_add_u32 s38, s38, 2048
  v_mfma_f32_16x16x32_bf16 a[72:75], v[92:95], v[76:79], a[72:75]
  v_mfma_f32_16x16x32_bf16 a[16:19], v[96:99], v[64:67], a[16:19]
  v_mfma_f32_16x16x32_bf16 a[36:39], v[96:99], v[68:71], a[36:39]
  v_mfma_f32_16x16x32_bf16 a[56:59], v[96:99], v[72:75], a[56:59]
  v_mfma_f32_16x16x32_bf16 a[76:79], v[96:99], v[76:79], a[76:79]
  s_waitcnt vmcnt(27)
  v_mfma_f32_16x16x32_bf16 a[0:3], v[116:119], v[100:103], a[0:3]
  buffer_load_dwordx4 v[28:31], v4, s[16:19], s38 offen offset:0
  v_mfma_f32_16x16x32_bf16 a[20:23], v[116:119], v[104:107], a[20:23]
  v_mfma_f32_16x16x32_bf16 a[40:43], v[116:119], v[108:111], a[40:43]
  buffer_load_dwordx4 v[32:35], v5, s[16:19], s38 offen offset:0
  v_mfma_f32_16x16x32_bf16 a[60:63], v[116:119], v[112:115], a[60:63]
  v_mfma_f32_16x16x32_bf16 a[4:7], v[120:123], v[100:103], a[4:7]
  buffer_load_dwordx4 v[36:39], v6, s[16:19], s38 offen offset:0
  v_mfma_f32_16x16x32_bf16 a[24:27], v[120:123], v[104:107], a[24:27]
  v_mfma_f32_16x16x32_bf16 a[44:47], v[120:123], v[108:111], a[44:47]
  buffer_load_dwordx4 v[40:43], v7, s[16:19], s38 offen offset:0
  v_mfma_f32_16x16x32_bf16 a[64:67], v[120:123], v[112:115], a[64:67]
  v_mfma_f32_16x16x32_bf16 a[8:11], v[124:127], v[100:103], a[8:11]
  buffer_load_dwordx4 v[44:47], v8, s[16:19], s38 offen offset:0
  v_mfma_f32_16x16x32_bf16 a[28:31], v[124:127], v[104:107], a[28:31]
  v_mfma_f32_16x16x32_bf16 a[48:51], v[124:127], v[108:111], a[48:51]
  buffer_load_dwordx4 v[48:51], v9, s[16:19], s38 offen offset:0
  v_mfma_f32_16x16x32_bf16 a[68:71], v[124:127], v[112:115], a[68:71]
  v_mfma_f32_16x16x32_bf16 a[12:15], v[128:131], v[100:103], a[12:15]
  buffer_load_dwordx4 v[52:55], v10, s[16:19], s38 offen offset:0
  v_mfma_f32_16x16x32_bf16 a[32:35], v[128:131], v[104:107], a[32:35]
  v_mfma_f32_16x16x32_bf16 a[52:55], v[128:131], v[108:111], a[52:55]
  buffer_load_dwordx4 v[56:59], v11, s[16:19], s38 offen offset:0
  v_mfma_f32_16x16x32_bf16 a[72:75], v[128:131], v[112:115], a[72:75]
  v_mfma_f32_16x16x32_bf16 a[16:19], v[132:135], v[100:103], a[16:19]
  buffer_load_dwordx4 v[60:63], v12, s[16:19], s38 offen offset:0
  v_mfma_f32_16x16x32_bf16 a[36:39], v[132:135], v[104:107], a[36:39]
  v_mfma_f32_16x16x32_bf16 a[56:59], v[132:135], v[108:111], a[56:59]
  buffer_load_dwordx4 v[64:67], v4, s[16:19], s38 offen offset:1024
  v_mfma_f32_16x16x32_bf16 a[76:79], v[132:135], v[112:115], a[76:79]
  s_waitcnt vmcnt(28)
  v_mfma_f32_16x16x32_bf16 a[0:3], v[152:155], v[136:139], a[0:3]
  buffer_load_dwordx4 v[68:71], v5, s[16:19], s38 offen offset:1024
  v_mfma_f32_16x16x32_bf16 a[20:23], v[152:155], v[140:143], a[20:23]
  v_mfma_f32_16x16x32_bf16 a[40:43], v[152:155], v[144:147], a[40:43]
  buffer_load_dwordx4 v[72:75], v6, s[16:19], s38 offen offset:1024
  v_mfma_f32_16x16x32_bf16 a[60:63], v[152:155], v[148:151], a[60:63]
  v_mfma_f32_16x16x32_bf16 a[4:7], v[156:159], v[136:139], a[4:7]
  buffer_load_dwordx4 v[76:79], v7, s[16:19], s38 offen offset:1024
  v_mfma_f32_16x16x32_bf16 a[24:27], v[156:159], v[140:143], a[24:27]
  v_mfma_f32_16x16x32_bf16 a[44:47], v[156:159], v[144:147], a[44:47]
  buffer_load_dwordx4 v[80:83], v8, s[16:19], s38 offen offset:1024
  v_mfma_f32_16x16x32_bf16 a[64:67], v[156:159], v[148:151], a[64:67]
  v_mfma_f32_16x16x32_bf16 a[8:11], v[160:163], v[136:139], a[8:11]
  buffer_load_dwordx4 v[84:87], v9, s[16:19], s38 offen offset:1024
  v_mfma_f32_16x16x32_bf16 a[28:31], v[160:163], v[140:143], a[28:31]
  v_mfma_f32_16x16x32_bf16 a[48:51], v[160:163], v[144:147], a[48:51]
  buffer_load_dwordx4 v[88:91], v10, s[16:19], s38 offen offset:1024
  v_mfma_f32_16x16x32_bf16 a[68:71], v[160:163], v[148:151], a[68:71]
  v_mfma_f32_16x16x32_bf16 a[12:15], v[164:167], v[136:139], a[12:15]
  buffer_load_dwordx4 v[92:95], v11, s[16:19], s38 offen offset:1024
  v_mfma_f32_16x16x32_bf16 a[32:35], v[164:167], v[140:143], a[32:35]
  v_mfma_f32_16x16x32_bf16 a[52:55], v[164:167], v[144:147], a[52:55]
  buffer_load_dwordx4 v[96:99], v12, s[16:19], s38 offen offset:1024
  s_add_u32 s38, s38, 2048
  v_mfma_f32_16x16x32_bf16 a[72:75], v[164:167], v[148:151], a[72:75]
  v_mfma_f32_16x16x32_bf16 a[16:19], v[168:171], v[136:139], a[16:19]
  v_mfma_f32_16x16x32_bf16 a[36:39], v[168:171], v[140:143], a[36:39]
  v_mfma_f32_16x16x32_bf16 a[56:59], v[168:171], v[144:147], a[56:59]
  v_mfma_f32_16x16x32_bf16 a[76:79], v[168:171], v[148:151], a[76:79]
  s_waitcnt vmcnt(27)
  v_mfma_f32_16x16x32_bf16 a[0:3], v[188:191], v[172:175], a[0:3]
  buffer_load_dwordx4 v[100:103], v20, s[24:27], 0 offen
  v_mfma_f32_16x16x32_bf16 a[20:23], v[188:191], v[176:179], a[20:23]
  v_mfma_f32_16x16x32_bf16 a[40:43], v[188:191], v[180:183], a[40:43]
  buffer_load_dwordx4 v[104:107], v21, s[24:27], 0 offen
  v_mfma_f32_16x16x32_bf16 a[60:63], v[188:191], v[184:187], a[60:63]
  v_mfma_f32_16x16x32_bf16 a[4:7], v[192:195], v[172:175], a[4:7]
  buffer_load_dwordx4 v[108:111], v22, s[24:27], 0 offen
  v_mfma_f32_16x16x32_bf16 a[24:27], v[192:195], v[176:179], a[24:27]
  v_mfma_f32_16x16x32_bf16 a[44:47], v[192:195], v[180:183], a[44:47]
  v_mfma_f32_16x16x32_bf16 a[64:67], v[192:195], v[184:187], a[64:67]
  v_mfma_f32_16x16x32_bf16 a[8:11], v[196:199], v[172:175], a[8:11]
  v_mfma_f32_16x16x32_bf16 a[28:31], v[196:199], v[176:179], a[28:31]
  v_mfma_f32_16x16x32_bf16 a[48:51], v[196:199], v[180:183], a[48:51]
  v_mfma_f32_16x16x32_bf16 a[68:71], v[196:199], v[184:187], a[68:71]
  v_mfma_f32_16x16x32_bf16 a[12:15], v[200:203], v[172:175], a[12:15]
  v_mfma_f32_16x16x32_bf16 a[32:35], v[200:203], v[176:179], a[32:35]
  v_mfma_f32_16x16x32_bf16 a[52:55], v[200:203], v[180:183], a[52:55]
  v_mfma_f32_16x16x32_bf16 a[72:75], v[200:203], v[184:187], a[72:75]
  v_mfma_f32_16x16x32_bf16 a[16:19], v[204:207], v[172:175], a[16:19]
  v_mfma_f32_16x16x32_bf16 a[36:39], v[204:207], v[176:179], a[36:39]
  v_mfma_f32_16x16x32_bf16 a[56:59], v[204:207], v[180:183], a[56:59]
  v_mfma_f32_16x16x32_bf16 a[76:79], v[204:207], v[184:187], a[76:79]
  s_waitcnt vmcnt(21)
  v_mfma_f32_16x16x32_bf16 a[0:3], v[224:227], v[208:211], a[0:3]
  v_mfma_f32_16x16x32_bf16 a[20:23], v[224:227], v[212:215], a[20:23]
  v_mfma_f32_16x16x32_bf16 a[40:43], v[224:227], v[216:219], a[40:43]
  v_mfma_f32_16x16x32_bf16 a[60:63], v[224:227], v[220:223], a[60:63]
  v_mfma_f32_16x16x32_bf16 a[4:7], v[228:231], v[208:211], a[4:7]
  v_mfma_f32_16x16x32_bf16 a[24:27], v[228:231], v[212:215], a[24:27]
  v_mfma_f32_16x16x32_bf16 a[44:47], v[228:231], v[216:219], a[44:47]
  v_mfma_f32_16x16x32_bf16 a[64:67], v[228:231], v[220:223], a[64:67]
  v_mfma_f32_16x16x32_bf16 a[8:11], v[232:235], v[208:211], a[8:11]
  v_mfma_f32_16x16x32_bf16 a[28:31], v[232:235], v[212:215], a[28:31]
  v_mfma_f32_16x16x32_bf16 a[48:51], v[232:235], v[216:219], a[48:51]
  v_mfma_f32_16x16x32_bf16 a[68:71], v[232:235], v[220:223], a[68:71]
  v_mfma_f32_16x16x32_bf16 a[12:15], v[236:239], v[208:211], a[12:15]
  v_mfma_f32_16x16x32_bf16 a[32:35], v[236:239], v[212:215], a[32:35]
  v_mfma_f32_16x16x32_bf16 a[52:55], v[236:239], v[216:219], a[52:55]
  v_mfma_f32_16x16x32_bf16 a[72:75], v[236:239], v[220:223], a[72:75]
  v_mfma_f32_16x16x32_bf16 a[16:19], v[240:243], v[208:211], a[16:19]
  v_mfma_f32_16x16x32_bf16 a[36:39], v[240:243], v[212:215], a[36:39]
  v_mfma_f32_16x16x32_bf16 a[56:59], v[240:243], v[216:219], a[56:59]
  v_mfma_f32_16x16x32_bf16 a[76:79], v[240:243], v[220:223], a[76:79]
  s_waitcnt vmcnt(12)
  v_mfma_f32_16x16x32_bf16 a[0:3], v[44:47], v[28:31], a[0:3]
  v_mfma_f32_16x16x32_bf16 a[20:23], v[44:47], v[32:35], a[20:23]
  v_mfma_f32_16x16x32_bf16 a[40:43], v[44:47], v[36:39], a[40:43]
  v_mfma_f32_16x16x32_bf16 a[60:63], v[44:47], v[40:43], a[60:63]
  v_mfma_f32_16x16x32_bf16 a[4:7], v[48:51], v[28:31], a[4:7]
  v_mfma_f32_16x16x32_bf16 a[24:27], v[48:51], v[32:35], a[24:27]
  v_mfma_f32_16x16x32_bf16 a[44:47], v[48:51], v[36:39], a[44:47]
  v_mfma_f32_16x16x32_bf16 a[64:67], v[48:51], v[40:43], a[64:67]
  v_mfma_f32_16x16x32_bf16 a[8:11], v[52:55], v[28:31], a[8:11]
  v_mfma_f32_16x16x32_bf16 a[28:31], v[52:55], v[32:35], a[28:31]
  v_mfma_f32_16x16x32_bf16 a[48:51], v[52:55], v[36:39], a[48:51]
  v_mfma_f32_16x16x32_bf16 a[68:71], v[52:55], v[40:43], a[68:71]
  v_mfma_f32_16x16x32_bf16 a[12:15], v[56:59], v[28:31], a[12:15]
  v_mfma_f32_16x16x32_bf16 a[32:35], v[56:59], v[32:35], a[32:35]
  v_mfma_f32_16x16x32_bf16 a[52:55], v[56:59], v[36:39], a[52:55]
  v_mfma_f32_16x16x32_bf16 a[72:75], v[56:59], v[40:43], a[72:75]
  v_mfma_f32_16x16x32_bf16 a[16:19], v[60:63], v[28:31], a[16:19]
  v_mfma_f32_16x16x32_bf16 a[36:39], v[60:63], v[32:35], a[36:39]
  v_mfma_f32_16x16x32_bf16 a[56:59], v[60:63], v[36:39], a[56:59]
  v_mfma_f32_16x16x32_bf16 a[76:79], v[60:63], v[40:43], a[76:79]
  s_waitcnt vmcnt(3)
  v_mfma_f32_16x16x32_bf16 a[0:3], v[80:83], v[64:67], a[0:3]
  v_mfma_f32_16x16x32_bf16 a[20:23], v[80:83], v[68:71], a[20:23]
  v_mfma_f32_16x16x32_bf16 a[40:43], v[80:83], v[72:75], a[40:43]
  v_mfma_f32_16x16x32_bf16 a[60:63], v[80:83], v[76:79], a[60:63]
  v_mfma_f32_16x16x32_bf16 a[4:7], v[84:87], v[64:67], a[4:7]
  v_mfma_f32_16x16x32_bf16 a[24:27], v[84:87], v[68:71], a[24:27]
  v_mfma_f32_16x16x32_bf16 a[44:47], v[84:87], v[72:75], a[44:47]
  v_mfma_f32_16x16x32_bf16 a[64:67], v[84:87], v[76:79], a[64:67]
  v_mfma_f32_16x16x32_bf16 a[8:11], v[88:91], v[64:67], a[8:11]
  v_mfma_f32_16x16x32_bf16 a[28:31], v[88:91], v[68:71], a[28:31]
  v_mfma_f32_16x16x32_bf16 a[48:51], v[88:91], v[72:75], a[48:51]
  v_mfma_f32_16x16x32_bf16 a[68:71], v[88:91], v[76:79], a[68:71]
  v_mfma_f32_16x16x32_bf16 a[12:15], v[92:95], v[64:67], a[12:15]
  v_mfma_f32_16x16x32_bf16 a[32:35], v[92:95], v[68:71], a[32:35]
  v_mfma_f32_16x16x32_bf16 a[52:55], v[92:95], v[72:75], a[52:55]
  v_mfma_f32_16x16x32_bf16 a[72:75], v[92:95], v[76:79], a[72:75]
  v_mfma_f32_16x16x32_bf16 a[16:19], v[96:99], v[64:67], a[16:19]
  v_mfma_f32_16x16x32_bf16 a[36:39], v[96:99], v[68:71], a[36:39]
  v_mfma_f32_16x16x32_bf16 a[56:59], v[96:99], v[72:75], a[56:59]
  v_mfma_f32_16x16x32_bf16 a[76:79], v[96:99], v[76:79], a[76:79]
  s_mul_i32 s39, s3, 21504
  v_mul_u32_u24 v13, 336, v2
  v_lshl_add_u32 v13, v3, 4, v13
  v_add_u32 v13, s39, v13
  s_nop 4
  ds_write_b128 v13, a[0:3] offset:0
  ds_write_b128 v13, a[20:23] offset:5376
  ds_write_b128 v13, a[40:43] offset:10752
  ds_write_b128 v13, a[60:63] offset:16128
  ds_write_b128 v13, a[4:7] offset:64
  ds_write_b128 v13, a[24:27] offset:5440
  ds_write_b128 v13, a[44:47] offset:10816
  ds_write_b128 v13, a[64:67] offset:16192
  ds_write_b128 v13, a[8:11] offset:128
  ds_write_b128 v13, a[28:31] offset:5504
  ds_write_b128 v13, a[48:51] offset:10880
  ds_write_b128 v13, a[68:71] offset:16256
  ds_write_b128 v13, a[12:15] offset:192
  ds_write_b128 v13, a[32:35] offset:5568
  ds_write_b128 v13, a[52:55] offset:10944
  ds_write_b128 v13, a[72:75] offset:16320
  ds_write_b128 v13, a[16:19] offset:256
  ds_write_b128 v13, a[36:39] offset:5632
  ds_write_b128 v13, a[56:59] offset:11008
  ds_write_b128 v13, a[76:79] offset:16384
  s_waitcnt lgkmcnt(0)
  s_barrier
  ds_read_b128 v[28:31], v23 offset:0
  ds_read_b128 v[32:35], v23 offset:16
  ds_read_b128 v[36:39], v23 offset:21504
  ds_read_b128 v[40:43], v23 offset:21520
  ds_read_b128 v[44:47], v23 offset:43008
  ds_read_b128 v[48:51], v23 offset:43024
  ds_read_b128 v[52:55], v23 offset:64512
  ds_read_b128 v[56:59], v23 offset:64528
  ds_read_b128 v[60:63], v24 offset:0
  ds_read_b128 v[64:67], v24 offset:16
  ds_read_b128 v[68:71], v24 offset:21504
  ds_read_b128 v[72:75], v24 offset:21520
  ds_read_b128 v[76:79], v24 offset:43008
  ds_read_b128 v[80:83], v24 offset:43024
  ds_read_b128 v[84:87], v24 offset:64512
  ds_read_b128 v[88:91], v24 offset:64528
  ds_read_b128 v[172:175], v25 offset:0
  ds_read_b128 v[176:179], v25 offset:16
  ds_read_b128 v[180:183], v25 offset:21504
  ds_read_b128 v[184:187], v25 offset:21520
  ds_read_b128 v[188:191], v25 offset:43008
  ds_read_b128 v[192:195], v25 offset:43024
  ds_read_b128 v[196:199], v25 offset:64512
  ds_read_b128 v[200:203], v25 offset:64528
  s_waitcnt lgkmcnt(15) vmcnt(0)
  v_pk_add_f32 v[28:29], v[28:29], v[36:37]
  v_pk_add_f32 v[30:31], v[30:31], v[38:39]
  v_pk_add_f32 v[32:33], v[32:33], v[40:41]
  v_pk_add_f32 v[34:35], v[34:35], v[42:43]
  v_pk_add_f32 v[28:29], v[28:29], v[44:45]
  v_pk_add_f32 v[30:31], v[30:31], v[46:47]
  v_pk_add_f32 v[32:33], v[32:33], v[48:49]
  v_pk_add_f32 v[34:35], v[34:35], v[50:51]
  v_pk_add_f32 v[28:29], v[28:29], v[52:53]
  v_pk_add_f32 v[30:31], v[30:31], v[54:55]
  v_pk_add_f32 v[32:33], v[32:33], v[56:57]
  v_pk_add_f32 v[34:35], v[34:35], v[58:59]
  v_lshlrev_b32 v13, 16, v100
  v_and_b32 v14, 0xffff0000, v100
  v_add_f32 v28, v28, v13
  v_add_f32 v29, v29, v14
  v_cvt_pk_bf16_f32 v204, v28, v29
  v_lshlrev_b32 v13, 16, v101
  v_and_b32 v14, 0xffff0000, v101
  v_add_f32 v30, v30, v13
  v_add_f32 v31, v31, v14
  v_cvt_pk_bf16_f32 v205, v30, v31
  v_lshlrev_b32 v13, 16, v102
  v_and_b32 v14, 0xffff0000, v102
  v_add_f32 v32, v32, v13
  v_add_f32 v33, v33, v14
  v_cvt_pk_bf16_f32 v206, v32, v33
  v_lshlrev_b32 v13, 16, v103
  v_and_b32 v14, 0xffff0000, v103
  v_add_f32 v34, v34, v13
  v_add_f32 v35, v35, v14
  v_cvt_pk_bf16_f32 v207, v34, v35
  buffer_store_dwordx4 v[204:207], v20, s[28:31], 0 offen
  s_waitcnt lgkmcnt(8)
  v_pk_add_f32 v[60:61], v[60:61], v[68:69]
  v_pk_add_f32 v[62:63], v[62:63], v[70:71]
  v_pk_add_f32 v[64:65], v[64:65], v[72:73]
  v_pk_add_f32 v[66:67], v[66:67], v[74:75]
  v_pk_add_f32 v[60:61], v[60:61], v[76:77]
  v_pk_add_f32 v[62:63], v[62:63], v[78:79]
  v_pk_add_f32 v[64:65], v[64:65], v[80:81]
  v_pk_add_f32 v[66:67], v[66:67], v[82:83]
  v_pk_add_f32 v[60:61], v[60:61], v[84:85]
  v_pk_add_f32 v[62:63], v[62:63], v[86:87]
  v_pk_add_f32 v[64:65], v[64:65], v[88:89]
  v_pk_add_f32 v[66:67], v[66:67], v[90:91]
  v_lshlrev_b32 v13, 16, v104
  v_and_b32 v14, 0xffff0000, v104
  v_add_f32 v60, v60, v13
  v_add_f32 v61, v61, v14
  v_cvt_pk_bf16_f32 v208, v60, v61
  v_lshlrev_b32 v13, 16, v105
  v_and_b32 v14, 0xffff0000, v105
  v_add_f32 v62, v62, v13
  v_add_f32 v63, v63, v14
  v_cvt_pk_bf16_f32 v209, v62, v63
  v_lshlrev_b32 v13, 16, v106
  v_and_b32 v14, 0xffff0000, v106
  v_add_f32 v64, v64, v13
  v_add_f32 v65, v65, v14
  v_cvt_pk_bf16_f32 v210, v64, v65
  v_lshlrev_b32 v13, 16, v107
  v_and_b32 v14, 0xffff0000, v107
  v_add_f32 v66, v66, v13
  v_add_f32 v67, v67, v14
  v_cvt_pk_bf16_f32 v211, v66, v67
  buffer_store_dwordx4 v[208:211], v21, s[28:31], 0 offen
  s_waitcnt lgkmcnt(0)
  v_pk_add_f32 v[172:173], v[172:173], v[180:181]
  v_pk_add_f32 v[174:175], v[174:175], v[182:183]
  v_pk_add_f32 v[176:177], v[176:177], v[184:185]
  v_pk_add_f32 v[178:179], v[178:179], v[186:187]
  v_pk_add_f32 v[172:173], v[172:173], v[188:189]
  v_pk_add_f32 v[174:175], v[174:175], v[190:191]
  v_pk_add_f32 v[176:177], v[176:177], v[192:193]
  v_pk_add_f32 v[178:179], v[178:179], v[194:195]
  v_pk_add_f32 v[172:173], v[172:173], v[196:197]
  v_pk_add_f32 v[174:175], v[174:175], v[198:199]
  v_pk_add_f32 v[176:177], v[176:177], v[200:201]
  v_pk_add_f32 v[178:179], v[178:179], v[202:203]
  v_lshlrev_b32 v13, 16, v108
  v_and_b32 v14, 0xffff0000, v108
  v_add_f32 v172, v172, v13
  v_add_f32 v173, v173, v14
  v_cvt_pk_bf16_f32 v212, v172, v173
  v_lshlrev_b32 v13, 16, v109
  v_and_b32 v14, 0xffff0000, v109
  v_add_f32 v174, v174, v13
  v_add_f32 v175, v175, v14
  v_cvt_pk_bf16_f32 v213, v174, v175
  v_lshlrev_b32 v13, 16, v110
  v_and_b32 v14, 0xffff0000, v110
  v_add_f32 v176, v176, v13
  v_add_f32 v177, v177, v14
  v_cvt_pk_bf16_f32 v214, v176, v177
  v_lshlrev_b32 v13, 16, v111
  v_and_b32 v14, 0xffff0000, v111
  v_add_f32 v178, v178, v13
  v_add_f32 v179, v179, v14
  v_cvt_pk_bf16_f32 v215, v178, v179
  buffer_store_dwordx4 v[212:215], v22, s[28:31], 0 offen
L2_exit:
  s_endpgm
.section .rodata,"a"
.p2align 6
.amdhsa_kernel k1_kernel
  .amdhsa_next_free_vgpr 256
  .amdhsa_next_free_sgpr 100
  .amdhsa_accum_offset 256
  .amdhsa_group_segment_fixed_size 0
  .amdhsa_kernarg_size 80
  .amdhsa_user_sgpr_count 2
  .amdhsa_user_sgpr_kernarg_segment_ptr 1
  .amdhsa_system_sgpr_workgroup_id_x 1
.end_amdhsa_kernel

.p2align 6
.amdhsa_kernel k2_kernel
  .amdhsa_next_free_vgpr 324
  .amdhsa_next_free_sgpr 96
  .amdhsa_accum_offset 244
  .amdhsa_group_segment_fixed_size 0
  .amdhsa_kernarg_size 80
  .amdhsa_user_sgpr_count 2
  .amdhsa_user_sgpr_kernarg_segment_ptr 1
  .amdhsa_system_sgpr_workgroup_id_x 1
.end_amdhsa_kernel
```
